```python
import torch

def _softmax(x, axis=-1):
    return torch.softmax(x, dim=axis)
def _gelu(x):
    return torch.nn.functional.gelu(x, approximate="tanh")
def _silu(x):
    return torch.nn.functional.silu(x)
def _sigmoid(x):
    return torch.sigmoid(x)
def _layernorm(x, axis=-1, eps=1e-5):
    m = x.mean(dim=axis, keepdim=True)
    v = x.var(dim=axis, keepdim=True, unbiased=False)
    return (x - m) / torch.sqrt(v + eps)
def _scatter_add(tgt, idx, src, axis=0):
    return tgt.clone().index_add_(axis, idx, src)
def _segment_sum(src, seg, n):
    out = torch.zeros((n,) + src.shape[1:], dtype=src.dtype)
    return out.index_add_(0, seg, src)
def _pad(x, pw):
    flat = tuple(v for pair in reversed(pw) for v in pair)
    return torch.nn.functional.pad(x, flat)

kernel_name = 'interleave_layers__ssm_conv_h3__glu_gated_bilinear__prompt'

def setup_inputs():

    _w = (lambda a: (lambda t: t.to(torch.bfloat16) if t.is_floating_point() else t)(torch.as_tensor(a)))
    def _A_setup():
        B, S, D = 1, 2048, 448
        ks = 4
        return {
            "q": _w((lambda *s: torch.randn(*s, dtype=torch.bfloat16) * 0.05)(B, S, D)),
            "k": _w((lambda *s: torch.randn(*s, dtype=torch.bfloat16) * 0.4)(B, S, D)),
            "v": _w((lambda *s: torch.randn(*s, dtype=torch.bfloat16) * 0.4)(B, S, D)),
            "shift_k": _w((lambda *s: torch.randn(*s, dtype=torch.bfloat16) * 0.4)(D, ks) * 0.5),
            "ssm_k": _w((lambda *s: torch.randn(*s, dtype=torch.bfloat16) * 0.4)(D, S) * (1.0 / S ** 0.5)),
            "ssm_D": _w((lambda *s: torch.randn(*s, dtype=torch.bfloat16) * 0.4)(D)),
        }
    _A_in = _A_setup()

    def _B_setup():
        B, S, D, F = 1, 2048, 448, 1792
        return {
            "x": _w((lambda *s: torch.randn(*s, dtype=torch.bfloat16) * 0.05)(B, S, D)),
            "w_gate": _w((lambda *s: torch.randn(*s, dtype=torch.bfloat16) * 0.8)(D, F) * (D ** -0.5)),
            "w_up": _w((lambda *s: torch.randn(*s, dtype=torch.bfloat16) * 0.8)(D, F) * (D ** -0.5)),
            "w_down": _w((lambda *s: torch.randn(*s, dtype=torch.bfloat16) * 0.8)(F, D) * (F ** -0.5)),
        }
    _B_in = _B_setup()

    return {
        "A_q": _A_in["q"],
        "A_k": _A_in["k"],
        "A_v": _A_in["v"],
        "A_shift_k": _A_in["shift_k"],
        "A_ssm_k": _A_in["ssm_k"],
        "A_ssm_D": _A_in["ssm_D"],
        "B_x": _B_in["x"],
        "B_w_gate": _B_in["w_gate"],
        "B_w_up": _B_in["w_up"],
        "B_w_down": _B_in["w_down"],
    }

def reference(A_q, A_k, A_v, A_shift_k, A_ssm_k, A_ssm_D, B_x, B_w_gate, B_w_up, B_w_down):
    def _A_ref(q, k, v, shift_k, ssm_k, ssm_D):
        B, S, D = q.shape
        ks = shift_k.shape[-1]
        k_pad = _pad(k, ((0, 0), (ks - 1, 0), (0, 0)))
        k_shift = torch.zeros_like(k)
        for t in range(ks):
            k_shift = k_shift + k_pad[:, t:t + S, :] * shift_k[:, ks - 1 - t][None, None, :]
        kv = k_shift * v
        L = 2 * S
        kv_pad = _pad(kv, ((0, 0), (0, S), (0, 0)))
        kf_pad = _pad(ssm_k, ((0, 0), (0, S)))
        kv_f = (lambda x, axes=(-2,-1): torch.fft.rfft2(x.float(), dim=axes))(kv_pad[:, None, :, :], axes=(1, 2))
        kf_f = (lambda x, axes=(-2,-1): torch.fft.rfft2(x.float(), dim=axes))(kf_pad[:, None, :], axes=(1, 2))
        kf_f = (lambda x, *d: x.permute(*d))(kf_f, 1, 2, 0)
        y_f = kv_f * kf_f[None, :, :, :]
        y = (lambda x, s, axes=(-2,-1): torch.fft.irfft2(x, s=s, dim=axes).to(torch.bfloat16))(y_f, (1, L), axes=(1, 2))[:, 0, :S, :]
        y = y + kv * ssm_D[None, None, :]
        return q * y

    def _B_ref(x, w_gate, w_up, w_down):
        g = torch.einsum("bsd,df->bsf", x, w_gate)
        u = torch.einsum("bsd,df->bsf", x, w_up)
        h = g * u
        return torch.einsum("bsf,fd->bsd", h, w_down)

    x = A_q
    x = x + _A_ref(_layernorm(x, axis=-1), A_k, A_v, A_shift_k, A_ssm_k, A_ssm_D)
    x = x + _B_ref(_layernorm(x, axis=-1), B_w_gate, B_w_up, B_w_down)
    x = x + _A_ref(_layernorm(x, axis=-1), A_k, A_v, A_shift_k, A_ssm_k, A_ssm_D)
    x = x + _B_ref(_layernorm(x, axis=-1), B_w_gate, B_w_up, B_w_down)
    return x
```

```asm
; @launch grid=(256,1,1) block=(256,1,1) lds=163328
.amdgcn_target "amdgcn-amd-amdhsa--gfx950"
    .text
    .globl interleave_layers__ssm_conv_h3__glu_gated_bilinear__prompt_kernel
    .p2align 8
    .type interleave_layers__ssm_conv_h3__glu_gated_bilinear__prompt_kernel,@function
interleave_layers__ssm_conv_h3__glu_gated_bilinear__prompt_kernel:
    s_cmp_ge_u32 s2, 256
    s_cbranch_scc1 L_end
    s_load_dwordx8 s[28:35], s[0:1], 8
    s_load_dwordx2 s[8:9], s[0:1], 96
    s_load_dwordx2 s[56:57], s[0:1], 0
    s_load_dwordx2 s[38:39], s[0:1], 40
    s_load_dwordx4 s[44:47], s[0:1], 56
    s_load_dwordx4 s[52:55], s[0:1], 72
    s_getpc_b64 s[4:5]
L_pc:
    s_sub_u32 s4, s4, L_pc-interleave_layers__ssm_conv_h3__glu_gated_bilinear__prompt_kernel
    s_subb_u32 s5, s5, 0
    s_mov_b32 s6, L_code_end-interleave_layers__ssm_conv_h3__glu_gated_bilinear__prompt_kernel
    s_mov_b32 s7, 0x20000
    s_lshr_b32 s3, s2, 3
    s_lshl_b32 s3, s3, 7
    v_lshrrev_b32 v48, 4, v0
    v_lshl_add_u32 v48, v48, 12, s3
    buffer_load_dword v46, v48, s[4:7], 0 offen
    s_getreg_b32 s23, hwreg(HW_REG_XCC_ID, 0, 4)
    s_add_u32 s23, s23, 1
    v_lshrrev_b32 v48, 6, v0
    v_mov_b32 v49, v0
    v_and_b32 v0, 63, v0
    v_readfirstlane_b32 s22, v48
    v_lshlrev_b32 v1, 4, v0
    s_and_b32 s24, s2, 7
    s_lshr_b32 s25, s2, 3
    s_lshl_b32 s20, s24, 2
    s_lshr_b32 s21, s2, 6
    s_add_u32 s20, s20, s21
    s_and_b32 s21, s25, 7
    s_mov_b32 s10, 50331648
    s_mov_b32 s11, 0x20000
    s_mov_b32 s7, 0x20000
    s_mov_b32 s15, 0x20000
    s_mov_b32 s19, 0x20000
    s_cmp_eq_u32 s24, 5
    s_cbranch_scc1 L_spare
    s_cmp_gt_u32 s24, 5
    s_subb_u32 s24, s24, 0
    v_and_b32 v50, 31, v0
    v_lshrrev_b32 v51, 5, v49
    s_lshl_b32 s26, s25, 6
    v_lshl_add_u32 v52, v51, 3, s26
    s_lshl_b32 s26, s24, 7
    v_lshl_add_u32 v53, v50, 2, s26
    v_mul_u32_u24 v54, 896, v52
    v_add_u32 v54, v54, v53
    v_subrev_u32 v55, 2688, v54
    v_mov_b32 v56, 2147483648
    v_cmp_eq_u32 vcc, 0, v52
    v_lshlrev_b32 v57, 2, v53
    s_nop 0
    v_cndmask_b32 v55, v55, v56, vcc
    s_movk_i32 s26, 4480
    s_mov_b32 s14, 1835008
    s_mov_b32 s18, 1835008
    s_movk_i32 s6, 3584
    s_waitcnt lgkmcnt(0)
    s_mov_b32 s12, s28
    s_mov_b32 s13, s29
    s_mov_b32 s16, s30
    s_mov_b32 s17, s31
    s_mov_b32 s4, s32
    s_mov_b32 s5, s33
    buffer_load_dword v64, v55, s[12:15], 0 offen offset:0 nt
    buffer_load_dword v65, v55, s[12:15], 0 offen offset:896 nt
    buffer_load_dword v66, v55, s[12:15], 0 offen offset:1792 nt
    buffer_load_dword v67, v54, s[12:15], 0 offen offset:0 nt
    buffer_load_dword v68, v54, s[12:15], 0 offen offset:896 nt
    buffer_load_dword v69, v54, s[12:15], 0 offen offset:1792 nt
    buffer_load_dword v70, v54, s[12:15], 0 offen offset:2688 nt
    buffer_load_dword v71, v54, s[12:15], 0 offen offset:3584 nt
    buffer_load_dword v72, v54, s[12:15], s26 offen offset:0 nt
    buffer_load_dword v73, v54, s[12:15], s26 offen offset:896 nt
    buffer_load_dword v74, v54, s[12:15], s26 offen offset:1792 nt
    buffer_load_dwordx4 v[60:63], v57, s[4:7], 0 offen
    buffer_load_dword v76, v54, s[16:19], 0 offen offset:0 nt
    buffer_load_dword v77, v54, s[16:19], 0 offen offset:896 nt
    buffer_load_dword v78, v54, s[16:19], 0 offen offset:1792 nt
    buffer_load_dword v79, v54, s[16:19], 0 offen offset:2688 nt
    buffer_load_dword v80, v54, s[16:19], 0 offen offset:3584 nt
    buffer_load_dword v81, v54, s[16:19], s26 offen offset:0 nt
    buffer_load_dword v82, v54, s[16:19], s26 offen offset:896 nt
    buffer_load_dword v83, v54, s[16:19], s26 offen offset:1792 nt
    s_load_dword s43, s[8:9], 0x0
    s_lshl_b32 s26, s24, 5
    s_add_u32 s26, s26, s25
    s_lshl_b32 s26, s26, 2
    s_load_dword s58, s[38:39], s26
    s_and_b32 s51, s22, 1
    s_lshr_b32 s27, s22, 1
    s_lshl_b32 s30, s24, 5
    s_add_u32 s30, s30, s25
    s_lshl_b32 s30, s30, 1
    s_add_u32 s30, s30, s51
    s_lshl_b32 s30, s30, 12
    s_mul_i32 s28, s51, 4608
    s_mul_i32 s29, s51, 35328
    s_add_u32 s29, s29, 9472
    s_lshl_b32 s37, s24, 18
    s_lshl_b32 s3, s25, 7
    s_sub_u32 s37, s37, s3
    s_add_u32 s37, s37, 3968
    s_lshl_b32 s3, s51, 17
    s_add_u32 s37, s37, s3
    v_mul_u32_u24 v59, 288, v50
    v_lshlrev_b32 v58, 4, v51
    v_sub_u32 v59, v59, v58
    v_add_u32 v59, 96368, v59
    s_cmp_eq_u32 s27, 0
    s_cbranch_scc0 L_hw
    s_lshl_b32 s26, s24, 5
    s_add_u32 s26, s26, s25
    s_and_b32 s48, s26, 3
    s_lshl_b32 s48, s48, 1
    s_add_u32 s48, s48, s51
    s_lshr_b32 s50, s26, 2
    s_mul_i32 s59, s50, 28672
    s_mul_i32 s3, s48, 448
    s_add_u32 s59, s59, s3
    s_mov_b32 s12, s44
    s_mov_b32 s13, s45
    s_mov_b32 s44, s46
    s_mov_b32 s45, s47
    s_mov_b32 s14, 1605632
    s_mov_b32 s46, s14
    s_mov_b32 s47, 0x20000
    v_lshlrev_b32 v222, 4, v0
    v_add_u32 v213, 3136, v222
    v_cmp_gt_u32 vcc, 28, v0
    s_nop 1
    v_cndmask_b32 v222, v213, v222, vcc
    v_cmp_gt_u32 vcc, 56, v0
    s_nop 1
    v_cndmask_b32 v222, v56, v222, vcc
    s_lshl_b32 s49, s51, 13
    s_add_u32 s49, s49, 120832
    s_mov_b32 s19, s49
    s_mov_b32 m0, s19
    s_add_u32 s19, s19, 4096
    buffer_load_dwordx4 v222, s[12:15], s59 offen nt lds
    s_mov_b32 m0, s19
    s_sub_u32 s19, s19, 3072
    buffer_load_dwordx4 v222, s[44:47], s59 offen nt lds
    s_add_u32 s59, s59, 7168
    s_mov_b32 m0, s19
    s_add_u32 s19, s19, 4096
    buffer_load_dwordx4 v222, s[12:15], s59 offen nt lds
    s_mov_b32 m0, s19
    s_sub_u32 s19, s19, 3072
    buffer_load_dwordx4 v222, s[44:47], s59 offen nt lds
    s_add_u32 s59, s59, 7168
    s_mov_b32 m0, s19
    s_add_u32 s19, s19, 4096
    buffer_load_dwordx4 v222, s[12:15], s59 offen nt lds
    s_mov_b32 m0, s19
    s_sub_u32 s19, s19, 3072
    buffer_load_dwordx4 v222, s[44:47], s59 offen nt lds
    s_add_u32 s59, s59, 7168
    s_mov_b32 m0, s19
    s_add_u32 s19, s19, 4096
    buffer_load_dwordx4 v222, s[12:15], s59 offen nt lds
    s_mov_b32 m0, s19
    s_sub_u32 s19, s19, 3072
    buffer_load_dwordx4 v222, s[44:47], s59 offen nt lds
    v_lshrrev_b32 v140, 3, v0
    v_and_b32 v142, 7, v0
    v_lshlrev_b32 v142, 4, v142
    v_lshl_add_u32 v141, v140, 12, v142
    v_mul_u32_u24 v140, 144, v140
    v_add_u32 v140, v140, v142
    s_mul_i32 s26, s51, 4608
    s_add_u32 s26, s26, 96256
    v_add_u32 v140, s26, v140
    s_waitcnt vmcnt(16)
    v_lshlrev_b32 v88, 16, v60
    v_lshlrev_b32 v89, 16, v62
    v_and_b32 v90, 0xffff0000, v60
    v_and_b32 v91, 0xffff0000, v62
    v_lshlrev_b32 v92, 16, v61
    v_lshlrev_b32 v93, 16, v63
    v_and_b32 v94, 0xffff0000, v61
    v_and_b32 v95, 0xffff0000, v63
    v_lshlrev_b32 v96, 16, v64
    v_and_b32 v97, 0xffff0000, v64
    v_lshlrev_b32 v98, 16, v65
    v_and_b32 v99, 0xffff0000, v65
    v_lshlrev_b32 v100, 16, v66
    v_and_b32 v101, 0xffff0000, v66
    v_lshlrev_b32 v102, 16, v67
    v_and_b32 v103, 0xffff0000, v67
    v_lshlrev_b32 v104, 16, v68
    v_and_b32 v105, 0xffff0000, v68
    v_lshlrev_b32 v106, 16, v69
    v_and_b32 v107, 0xffff0000, v69
    v_lshlrev_b32 v108, 16, v70
    v_and_b32 v109, 0xffff0000, v70
    v_lshlrev_b32 v110, 16, v71
    v_and_b32 v111, 0xffff0000, v71
    v_lshlrev_b32 v112, 16, v72
    v_and_b32 v113, 0xffff0000, v72
    v_lshlrev_b32 v114, 16, v73
    v_and_b32 v115, 0xffff0000, v73
    v_lshlrev_b32 v116, 16, v74
    v_and_b32 v117, 0xffff0000, v74
    v_pk_mul_f32 v[120:121], v[102:103], v[88:89]
    v_pk_fma_f32 v[120:121], v[100:101], v[90:91], v[120:121]
    v_pk_fma_f32 v[120:121], v[98:99], v[92:93], v[120:121]
    v_pk_fma_f32 v[120:121], v[96:97], v[94:95], v[120:121]
    v_pk_mul_f32 v[122:123], v[104:105], v[88:89]
    v_pk_fma_f32 v[122:123], v[102:103], v[90:91], v[122:123]
    v_pk_fma_f32 v[122:123], v[100:101], v[92:93], v[122:123]
    v_pk_fma_f32 v[122:123], v[98:99], v[94:95], v[122:123]
    v_pk_mul_f32 v[124:125], v[106:107], v[88:89]
    v_pk_fma_f32 v[124:125], v[104:105], v[90:91], v[124:125]
    v_pk_fma_f32 v[124:125], v[102:103], v[92:93], v[124:125]
    v_pk_fma_f32 v[124:125], v[100:101], v[94:95], v[124:125]
    v_pk_mul_f32 v[126:127], v[108:109], v[88:89]
    v_pk_fma_f32 v[126:127], v[106:107], v[90:91], v[126:127]
    v_pk_fma_f32 v[126:127], v[104:105], v[92:93], v[126:127]
    v_pk_fma_f32 v[126:127], v[102:103], v[94:95], v[126:127]
    v_pk_mul_f32 v[128:129], v[110:111], v[88:89]
    v_pk_fma_f32 v[128:129], v[108:109], v[90:91], v[128:129]
    v_pk_fma_f32 v[128:129], v[106:107], v[92:93], v[128:129]
    v_pk_fma_f32 v[128:129], v[104:105], v[94:95], v[128:129]
    v_pk_mul_f32 v[130:131], v[112:113], v[88:89]
    v_pk_fma_f32 v[130:131], v[110:111], v[90:91], v[130:131]
    v_pk_fma_f32 v[130:131], v[108:109], v[92:93], v[130:131]
    v_pk_fma_f32 v[130:131], v[106:107], v[94:95], v[130:131]
    v_pk_mul_f32 v[132:133], v[114:115], v[88:89]
    v_pk_fma_f32 v[132:133], v[112:113], v[90:91], v[132:133]
    v_pk_fma_f32 v[132:133], v[110:111], v[92:93], v[132:133]
    v_pk_fma_f32 v[132:133], v[108:109], v[94:95], v[132:133]
    v_pk_mul_f32 v[134:135], v[116:117], v[88:89]
    v_pk_fma_f32 v[134:135], v[114:115], v[90:91], v[134:135]
    v_pk_fma_f32 v[134:135], v[112:113], v[92:93], v[134:135]
    v_pk_fma_f32 v[134:135], v[110:111], v[94:95], v[134:135]
    s_waitcnt vmcnt(15)
    v_lshlrev_b32 v118, 16, v76
    v_and_b32 v119, 0xffff0000, v76
    v_pk_mul_f32 v[120:121], v[120:121], v[118:119]
    s_waitcnt vmcnt(14)
    v_lshlrev_b32 v118, 16, v77
    v_and_b32 v119, 0xffff0000, v77
    v_pk_mul_f32 v[122:123], v[122:123], v[118:119]
    s_waitcnt vmcnt(13)
    v_lshlrev_b32 v118, 16, v78
    v_and_b32 v119, 0xffff0000, v78
    v_pk_mul_f32 v[124:125], v[124:125], v[118:119]
    s_waitcnt vmcnt(12)
    v_lshlrev_b32 v118, 16, v79
    v_and_b32 v119, 0xffff0000, v79
    v_pk_mul_f32 v[126:127], v[126:127], v[118:119]
    s_waitcnt vmcnt(11)
    v_lshlrev_b32 v118, 16, v80
    v_and_b32 v119, 0xffff0000, v80
    v_pk_mul_f32 v[128:129], v[128:129], v[118:119]
    s_waitcnt vmcnt(10)
    v_lshlrev_b32 v118, 16, v81
    v_and_b32 v119, 0xffff0000, v81
    v_pk_mul_f32 v[130:131], v[130:131], v[118:119]
    s_waitcnt vmcnt(9)
    v_lshlrev_b32 v118, 16, v82
    v_and_b32 v119, 0xffff0000, v82
    v_pk_mul_f32 v[132:133], v[132:133], v[118:119]
    s_waitcnt vmcnt(8)
    v_lshlrev_b32 v118, 16, v83
    v_and_b32 v119, 0xffff0000, v83
    v_pk_mul_f32 v[134:135], v[134:135], v[118:119]
    v_cvt_pk_bf16_f32 v64, v134, v132
    v_cvt_pk_bf16_f32 v65, v130, v128
    v_cvt_pk_bf16_f32 v66, v126, v124
    v_cvt_pk_bf16_f32 v67, v122, v120
    v_cvt_pk_bf16_f32 v68, v135, v133
    v_cvt_pk_bf16_f32 v69, v131, v129
    v_cvt_pk_bf16_f32 v70, v127, v125
    v_cvt_pk_bf16_f32 v71, v123, v121
    ds_write_b128 v59, v[64:67]
    ds_write_b128 v59, v[68:71] offset:144
    s_waitcnt lgkmcnt(0)
    s_barrier
    ds_read_b128 v[224:227], v140 offset:0
    ds_read_b128 v[228:231], v140 offset:1152
    ds_read_b128 v[232:235], v140 offset:2304
    ds_read_b128 v[236:239], v140 offset:3456
    s_mul_i32 s42, s43, 0x9E3779B1
    s_add_u32 s42, s42, 0x7F4A7C15
    s_and_b32 s42, s42, -16
    s_or_b32 s23, s23, s42
    v_mov_b32 v43, s23
    s_add_u32 s26, s37, 262144
    s_waitcnt lgkmcnt(3)
    buffer_store_dwordx4 v[224:227], v141, s[8:11], s26 offen
    s_add_u32 s26, s26, 0x8000
    s_waitcnt lgkmcnt(2)
    buffer_store_dwordx4 v[228:231], v141, s[8:11], s26 offen
    s_add_u32 s26, s26, 0x8000
    s_waitcnt lgkmcnt(1)
    buffer_store_dwordx4 v[232:235], v141, s[8:11], s26 offen
    s_add_u32 s26, s26, 0x8000
    s_waitcnt lgkmcnt(0)
    buffer_store_dwordx4 v[236:239], v141, s[8:11], s26 offen
    v_and_b32 v198, 7, v0
    s_mov_b32 s26, 3380953356
    v_lshlrev_b32 v199, 2, v198
    v_lshrrev_b32 v199, v199, s26
    v_and_b32 v199, 15, v199
    v_mul_u32_u24 v194, 4352, v198
    v_lshl_add_u32 v194, v199, 4, v194
    v_add_u32 v194, s29, v194
    v_and_b32 v195, 15, v0
    v_add_u32 v197, 1, v195
    v_and_b32 v198, 7, v197
    s_mov_b32 s26, 3380953356
    v_lshlrev_b32 v199, 2, v198
    v_lshrrev_b32 v199, v199, s26
    v_and_b32 v199, 15, v199
    v_mul_u32_u24 v192, 4352, v198
    v_lshl_add_u32 v192, v199, 4, v192
    v_add_u32 v192, s29, v192
    v_lshrrev_b32 v197, 3, v197
    v_lshrrev_b32 v196, 4, v0
    v_add_u32 v197, v197, v196
    v_lshl_add_u32 v192, v197, 4, v192
    v_subrev_u32 v192, 32, v192
    v_lshlrev_b32 v193, 4, v196
    v_lshlrev_b32 v197, 5, v195
    v_sub_u32 v193, v193, v197
    s_lshl_b32 s3, s27, 6
    v_add_u32 v192, s3, v192
    s_add_u32 s26, s28, s3
    s_add_u32 s26, s26, 480
    v_add_u32 v193, s26, v193
    s_lshl_b32 s26, s24, 8
    s_lshl_b32 s3, s25, 3
    s_add_u32 s3, s3, s26
    s_lshl_b32 s33, s51, 2
    s_add_u32 s3, s3, s33
    v_mov_b32 v14, s3
    v_lshl_add_u32 v15, v0, 2, s26
    v_mov_b32 v200, 0
    v_mov_b32 v201, 0
    v_mov_b32 v202, 0
    v_mov_b32 v203, 0
    v_subrev_u32 v197, 32, v194
    v_bfe_u32 v198, v0, 3, 1
    v_lshl_add_u32 v197, v198, 4, v197
    s_add_u32 s26, s28, 4096
    v_add_u32 v198, s26, v1
    v_cmp_gt_u32 vcc, 32, v0
    s_nop 1
    v_cndmask_b32 v197, v197, v198, vcc
    s_mov_b32 exec_lo, 0x3fffffff
    s_mov_b32 exec_hi, 0x1ff
    ds_write_b128 v197, v[200:203]
    s_mov_b64 exec, -1
    s_mov_b32 s33, 4096
    s_waitcnt vmcnt(0)
    s_mov_b64 exec, 1
    buffer_store_dword v43, v14, s[8:11], s33 offen offset:0
    s_mov_b64 exec, -1
    v_lshrrev_b32 v213, 4, v0
    v_mul_u32_u24 v221, 112, v213
    v_bfe_u32 v214, v0, 3, 1
    v_lshl_add_u32 v221, v214, 10, v221
    v_bfe_u32 v214, v0, 2, 1
    v_mul_u32_u24 v214, 448, v214
    v_add3_u32 v221, v221, v214, s49
    v_and_b32 v214, 1, v0
    v_lshl_add_u32 v220, v214, 3, v221
    v_bfe_u32 v214, v0, 1, 1
    v_lshl_add_u32 v220, v214, 12, v220
    v_and_b32 v214, 3, v0
    v_lshl_add_u32 v221, v214, 3, v221
    s_lshl_b32 s32, s48, 14
    s_lshl_b32 s3, s50, 7
    s_add_u32 s32, s32, s3
    s_add_u32 s32, s32, 65536
    s_mul_i32 s48, s48, 602112
    s_lshr_b32 s3, s50, 2
    s_mul_i32 s3, s3, 7168
    s_add_u32 s48, s48, s3
    s_and_b32 s3, s50, 3
    s_lshl_b32 s3, s3, 8
    s_add_u32 s48, s48, s3
    s_add_u32 s48, s48, 7602176
    s_add_u32 s49, s48, 4096
    s_mov_b32 s3, 150528
    v_mul_lo_u32 v215, v213, s3
    v_and_b32 v214, 15, v0
    v_lshl_add_u32 v215, v214, 4, v215
    v_mov_b32 v223, 2147483648
    v_writelane_b32 v223, s32, 0
    ds_read_b64_tr_b16 a[200:201], v221 offset:0
    ds_read_b64_tr_b16 a[202:203], v221 offset:2048
    ds_read_b64_tr_b16 a[204:205], v221 offset:4096
    ds_read_b64_tr_b16 a[206:207], v221 offset:6144
    ds_read_b64_tr_b16 a[208:209], v221 offset:32
    ds_read_b64_tr_b16 a[210:211], v221 offset:2080
    ds_read_b64_tr_b16 a[212:213], v221 offset:4128
    ds_read_b64_tr_b16 a[214:215], v221 offset:6176
    ds_read_b64_tr_b16 a[216:217], v221 offset:64
    ds_read_b64_tr_b16 a[218:219], v221 offset:2112
    ds_read_b64_tr_b16 a[220:221], v221 offset:4160
    ds_read_b64_tr_b16 a[222:223], v221 offset:6208
    ds_read_b64_tr_b16 a[224:225], v220 offset:96
    ds_read_b64_tr_b16 a[226:227], v220 offset:2144
    v_lshrrev_b32 v204, 4, v0
    v_bfe_u32 v205, v0, 2, 2
    v_and_b32 v206, 3, v0
    s_lshl_b32 s26, s22, 2
    v_add_u32 v207, s26, v204
    v_cmp_gt_u32 vcc, 14, v207
    v_mov_b32 v208, 2147483648
    s_lshl_b32 s26, s20, 6
    s_lshl_b32 s3, s21, 3
    s_add_u32 s26, s26, s3
    s_mov_b64 s[16:17], vcc
    v_lshl_add_u32 v209, v204, 1, s26
    v_mul_u32_u24 v210, 896, v209
    v_and_b32 v209, 15, v0
    v_lshl_add_u32 v210, v209, 4, v210
    s_lshl_b32 s3, s22, 8
    v_add_u32 v210, s3, v210
    s_lshl_b32 s3, s22, 2
    v_add_u32 v209, s3, v205
    v_cmp_gt_u32 vcc, 14, v209
    s_nop 1
    v_cndmask_b32 v12, v208, v210, vcc
    s_mov_b64 vcc, s[16:17]
    s_mul_i32 s26, s26, 1792
    v_and_b32 v210, 15, v0
    v_lshlrev_b32 v210, 4, v210
    v_lshl_add_u32 v210, v207, 10, v210
    v_add_u32 v210, s26, v210
    v_cndmask_b32 v216, v208, v210, vcc
    s_lshl_b32 s26, s22, 2
    s_add_u32 s26, s26, 145920
    v_lshlrev_b32 v210, 6, v206
    v_lshl_add_u32 v40, v204, 4, v210
    v_add_u32 v40, s26, v40
    v_add_u32 v41, 145920, v210
    v_mov_b32 v44, 925353388
    s_mov_b32 s36, 991054117
    s_mov_b32 s34, 0
    s_mov_b32 s35, 262144
    s_lshl_b32 s18, s24, 18
    s_add_u32 s18, s18, 262144
    s_lshr_b32 s3, s20, 2
    s_mul_i32 s3, s3, 229376
    s_sub_u32 s18, s18, s3
L_pu:
    s_mov_b32 s33, 4096
    buffer_load_dword v78, v15, s[8:11], s33 offen sc1
    s_waitcnt vmcnt(0)
    v_cmp_ne_u32 vcc, s23, v78
    s_cbranch_vccz L_pu_x
    s_add_u32 s34, s34, 1
    s_cmp_lt_u32 s34, 24
    s_cbranch_scc1 L_pu
    s_cmp_eq_u32 s34, 24
    s_cbranch_scc0 L_pu_n
    s_add_u32 s26, s37, 12451840
    buffer_store_dwordx4 v[224:227], v141, s[8:11], s26 offen sc1
    s_add_u32 s26, s26, 0x8000
    buffer_store_dwordx4 v[228:231], v141, s[8:11], s26 offen sc1
    s_add_u32 s26, s26, 0x8000
    buffer_store_dwordx4 v[232:235], v141, s[8:11], s26 offen sc1
    s_add_u32 s26, s26, 0x8000
    buffer_store_dwordx4 v[236:239], v141, s[8:11], s26 offen sc1
    s_mov_b32 s33, 8192
    s_waitcnt vmcnt(0)
    s_mov_b64 exec, 1
    buffer_store_dword v43, v14, s[8:11], s33 offen offset:0 sc1
    s_mov_b64 exec, -1
L_pu_n:
    s_cmp_gt_u32 s34, 1048576
    s_cbranch_scc1 L_pu_x
    s_mov_b32 s33, 8192
    buffer_load_dword v78, v15, s[8:11], s33 offen sc1
    s_waitcnt vmcnt(0)
    v_and_b32 v79, -16, v78
    v_cmp_ne_u32 vcc, s42, v79
    s_cbranch_vccnz L_pu
    s_mov_b32 s35, 12451840
    v_cmp_ne_u32 vcc, s23, v78
    s_cbranch_vccz L_pu_x
    s_mov_b32 s18, 2097152
L_pu_x:
    s_waitcnt vmcnt(0)
L_pu_y:
    s_add_u32 s3, s30, s35
    s_mov_b32 s26, s28
    s_mov_b32 m0, s26
    s_add_u32 s26, s26, 1024
    buffer_load_dwordx4 v1, s[8:11], s3 offen sc1 lds
    s_add_u32 s3, s3, 1024
    s_mov_b32 m0, s26
    s_add_u32 s26, s26, 1024
    buffer_load_dwordx4 v1, s[8:11], s3 offen sc1 lds
    s_add_u32 s3, s3, 1024
    s_mov_b32 m0, s26
    s_add_u32 s26, s26, 1024
    buffer_load_dwordx4 v1, s[8:11], s3 offen sc1 lds
    s_add_u32 s3, s3, 1024
    s_mov_b32 m0, s26
    s_add_u32 s26, s26, 1024
    buffer_load_dwordx4 v1, s[8:11], s3 offen sc1 lds
    s_add_u32 s3, s3, 1024
    v_mov_b32 v80, s18
    v_mov_b32 v79, 145664
    ds_write_b32 v79, v80
    s_waitcnt vmcnt(0)
    s_waitcnt lgkmcnt(0)
    s_barrier
    ds_read_b128 v[112:115], v193 offset:3584
    ds_read_b128 v[48:51], v192 offset:0
    ds_read_b128 v[116:119], v193 offset:3072
    ds_read_b128 v[120:123], v193 offset:2560
    ds_read_b128 v[124:127], v193 offset:2048
    ds_read_b128 v[128:131], v193 offset:1536
    ds_read_b128 v[132:135], v193 offset:1024
    ds_read_b128 v[136:139], v193 offset:512
    ds_read_b128 v[140:143], v193 offset:0
    ds_read_b128 v[52:55], v192 offset:512
    ds_read_b128 v[56:59], v192 offset:1024
    ds_read_b128 v[60:63], v192 offset:1536
    ds_read_b128 v[64:67], v192 offset:2048
    ds_read_b128 v[68:71], v192 offset:2560
    ds_read_b128 v[72:75], v192 offset:3072
    ds_read_b128 v[76:79], v192 offset:3584
    buffer_store_dwordx4 a[200:203], v215, s[8:11], s48 offen offset:0 sc1
    buffer_store_dwordx4 a[204:207], v215, s[8:11], s48 offen offset:1024 sc1
    buffer_store_dwordx4 a[208:211], v215, s[8:11], s48 offen offset:2048 sc1
    buffer_store_dwordx4 a[212:215], v215, s[8:11], s48 offen offset:3072 sc1
    buffer_store_dwordx4 a[216:219], v215, s[8:11], s49 offen offset:0 sc1
    buffer_store_dwordx4 a[220:223], v215, s[8:11], s49 offen offset:1024 sc1
    buffer_store_dwordx4 a[224:227], v215, s[8:11], s49 offen offset:2048 sc1
    s_mov_b32 s4, s56
    s_mov_b32 s5, s57
    s_mov_b32 s6, 1835008
    buffer_load_dwordx4 v[32:35], v12, s[4:7], 0 offen offset:0
    buffer_load_dwordx4 v[36:39], v12, s[4:7], 0 offen offset:896
    s_waitcnt lgkmcnt(14)
    v_mfma_f32_16x16x32_bf16 v[224:227], v[48:51], v[112:115], 0
    ds_read_b128 v[144:147], v193 offset:3712
    s_waitcnt lgkmcnt(14)
    v_mfma_f32_16x16x32_bf16 v[228:231], v[48:51], v[116:119], 0
    s_waitcnt lgkmcnt(13)
    v_mfma_f32_16x16x32_bf16 v[232:235], v[48:51], v[120:123], 0
    ds_read_b128 v[80:83], v192 offset:128
    s_waitcnt lgkmcnt(13)
    v_mfma_f32_16x16x32_bf16 v[236:239], v[48:51], v[124:127], 0
    s_waitcnt lgkmcnt(12)
    v_mfma_f32_16x16x32_bf16 v[240:243], v[48:51], v[128:131], 0
    ds_read_b128 v[148:151], v193 offset:3200
    s_waitcnt lgkmcnt(12)
    v_mfma_f32_16x16x32_bf16 v[244:247], v[48:51], v[132:135], 0
    s_waitcnt lgkmcnt(11)
    v_mfma_f32_16x16x32_bf16 v[248:251], v[48:51], v[136:139], 0
    ds_read_b128 v[152:155], v193 offset:2688
    s_waitcnt lgkmcnt(11)
    v_mfma_f32_16x16x32_bf16 v[252:255], v[48:51], v[140:143], 0
    s_waitcnt lgkmcnt(10)
    v_mfma_f32_16x16x32_bf16 v[228:231], v[52:55], v[112:115], v[228:231]
    ds_read_b128 v[156:159], v193 offset:2176
    v_mfma_f32_16x16x32_bf16 v[232:235], v[52:55], v[116:119], v[232:235]
    v_mfma_f32_16x16x32_bf16 v[236:239], v[52:55], v[120:123], v[236:239]
    ds_read_b128 v[160:163], v193 offset:1664
    v_mfma_f32_16x16x32_bf16 v[240:243], v[52:55], v[124:127], v[240:243]
    v_mfma_f32_16x16x32_bf16 v[244:247], v[52:55], v[128:131], v[244:247]
    ds_read_b128 v[164:167], v193 offset:1152
    v_mfma_f32_16x16x32_bf16 v[248:251], v[52:55], v[132:135], v[248:251]
    v_mfma_f32_16x16x32_bf16 v[252:255], v[52:55], v[136:139], v[252:255]
    ds_read_b128 v[168:171], v193 offset:640
    s_waitcnt lgkmcnt(13)
    v_mfma_f32_16x16x32_bf16 v[232:235], v[56:59], v[112:115], v[232:235]
    v_mfma_f32_16x16x32_bf16 v[236:239], v[56:59], v[116:119], v[236:239]
    ds_read_b128 v[172:175], v193 offset:128
    v_mfma_f32_16x16x32_bf16 v[240:243], v[56:59], v[120:123], v[240:243]
    v_mfma_f32_16x16x32_bf16 v[244:247], v[56:59], v[124:127], v[244:247]
    ds_read_b128 v[84:87], v192 offset:640
    v_mfma_f32_16x16x32_bf16 v[248:251], v[56:59], v[128:131], v[248:251]
    v_mfma_f32_16x16x32_bf16 v[252:255], v[56:59], v[132:135], v[252:255]
    ds_read_b128 v[88:91], v192 offset:1152
    s_waitcnt lgkmcnt(15)
    v_mfma_f32_16x16x32_bf16 v[236:239], v[60:63], v[112:115], v[236:239]
    v_mfma_f32_16x16x32_bf16 v[240:243], v[60:63], v[116:119], v[240:243]
    ds_read_b128 v[92:95], v192 offset:1664
    v_mfma_f32_16x16x32_bf16 v[244:247], v[60:63], v[120:123], v[244:247]
    v_mfma_f32_16x16x32_bf16 v[248:251], v[60:63], v[124:127], v[248:251]
    ds_read_b128 v[96:99], v192 offset:2176
    v_mfma_f32_16x16x32_bf16 v[252:255], v[60:63], v[128:131], v[252:255]
    s_waitcnt lgkmcnt(15)
    v_mfma_f32_16x16x32_bf16 v[240:243], v[64:67], v[112:115], v[240:243]
    ds_read_b128 v[100:103], v192 offset:2688
    v_mfma_f32_16x16x32_bf16 v[244:247], v[64:67], v[116:119], v[244:247]
    v_mfma_f32_16x16x32_bf16 v[248:251], v[64:67], v[120:123], v[248:251]
    ds_read_b128 v[104:107], v192 offset:3200
    v_mfma_f32_16x16x32_bf16 v[252:255], v[64:67], v[124:127], v[252:255]
    v_mfma_f32_16x16x32_bf16 v[244:247], v[68:71], v[112:115], v[244:247]
    ds_read_b128 v[108:111], v192 offset:3712
    v_mfma_f32_16x16x32_bf16 v[248:251], v[68:71], v[116:119], v[248:251]
    v_mfma_f32_16x16x32_bf16 v[252:255], v[68:71], v[120:123], v[252:255]
    s_waitcnt lgkmcnt(15)
    v_mfma_f32_16x16x32_bf16 v[248:251], v[72:75], v[112:115], v[248:251]
    v_mfma_f32_16x16x32_bf16 v[252:255], v[72:75], v[116:119], v[252:255]
    v_mfma_f32_16x16x32_bf16 v[252:255], v[76:79], v[112:115], v[252:255]
    s_waitcnt lgkmcnt(14)
    v_mfma_f32_16x16x32_bf16 v[224:227], v[80:83], v[144:147], v[224:227]
    ds_read_b128 v[112:115], v193 offset:3840
    s_waitcnt lgkmcnt(14)
    v_mfma_f32_16x16x32_bf16 v[228:231], v[80:83], v[148:151], v[228:231]
    s_waitcnt lgkmcnt(13)
    v_mfma_f32_16x16x32_bf16 v[232:235], v[80:83], v[152:155], v[232:235]
    ds_read_b128 v[48:51], v192 offset:256
    s_waitcnt lgkmcnt(13)
    v_mfma_f32_16x16x32_bf16 v[236:239], v[80:83], v[156:159], v[236:239]
    s_waitcnt lgkmcnt(12)
    v_mfma_f32_16x16x32_bf16 v[240:243], v[80:83], v[160:163], v[240:243]
    ds_read_b128 v[116:119], v193 offset:3328
    s_waitcnt lgkmcnt(12)
    v_mfma_f32_16x16x32_bf16 v[244:247], v[80:83], v[164:167], v[244:247]
    s_waitcnt lgkmcnt(11)
    v_mfma_f32_16x16x32_bf16 v[248:251], v[80:83], v[168:171], v[248:251]
    ds_read_b128 v[120:123], v193 offset:2816
    s_waitcnt lgkmcnt(11)
    v_mfma_f32_16x16x32_bf16 v[252:255], v[80:83], v[172:175], v[252:255]
    s_waitcnt lgkmcnt(10)
    v_mfma_f32_16x16x32_bf16 v[228:231], v[84:87], v[144:147], v[228:231]
    ds_read_b128 v[124:127], v193 offset:2304
    v_mfma_f32_16x16x32_bf16 v[232:235], v[84:87], v[148:151], v[232:235]
    v_mfma_f32_16x16x32_bf16 v[236:239], v[84:87], v[152:155], v[236:239]
    ds_read_b128 v[128:131], v193 offset:1792
    v_mfma_f32_16x16x32_bf16 v[240:243], v[84:87], v[156:159], v[240:243]
    v_mfma_f32_16x16x32_bf16 v[244:247], v[84:87], v[160:163], v[244:247]
    ds_read_b128 v[132:135], v193 offset:1280
    v_mfma_f32_16x16x32_bf16 v[248:251], v[84:87], v[164:167], v[248:251]
    v_mfma_f32_16x16x32_bf16 v[252:255], v[84:87], v[168:171], v[252:255]
    ds_read_b128 v[136:139], v193 offset:768
    s_waitcnt lgkmcnt(13)
    v_mfma_f32_16x16x32_bf16 v[232:235], v[88:91], v[144:147], v[232:235]
    v_mfma_f32_16x16x32_bf16 v[236:239], v[88:91], v[148:151], v[236:239]
    ds_read_b128 v[140:143], v193 offset:256
    v_mfma_f32_16x16x32_bf16 v[240:243], v[88:91], v[152:155], v[240:243]
    v_mfma_f32_16x16x32_bf16 v[244:247], v[88:91], v[156:159], v[244:247]
    ds_read_b128 v[52:55], v192 offset:768
    v_mfma_f32_16x16x32_bf16 v[248:251], v[88:91], v[160:163], v[248:251]
    v_mfma_f32_16x16x32_bf16 v[252:255], v[88:91], v[164:167], v[252:255]
    ds_read_b128 v[56:59], v192 offset:1280
    s_waitcnt lgkmcnt(15)
    v_mfma_f32_16x16x32_bf16 v[236:239], v[92:95], v[144:147], v[236:239]
    v_mfma_f32_16x16x32_bf16 v[240:243], v[92:95], v[148:151], v[240:243]
    ds_read_b128 v[60:63], v192 offset:1792
    v_mfma_f32_16x16x32_bf16 v[244:247], v[92:95], v[152:155], v[244:247]
    v_mfma_f32_16x16x32_bf16 v[248:251], v[92:95], v[156:159], v[248:251]
    ds_read_b128 v[64:67], v192 offset:2304
    v_mfma_f32_16x16x32_bf16 v[252:255], v[92:95], v[160:163], v[252:255]
    s_waitcnt lgkmcnt(15)
    v_mfma_f32_16x16x32_bf16 v[240:243], v[96:99], v[144:147], v[240:243]
    ds_read_b128 v[68:71], v192 offset:2816
    v_mfma_f32_16x16x32_bf16 v[244:247], v[96:99], v[148:151], v[244:247]
    v_mfma_f32_16x16x32_bf16 v[248:251], v[96:99], v[152:155], v[248:251]
    ds_read_b128 v[72:75], v192 offset:3328
    v_mfma_f32_16x16x32_bf16 v[252:255], v[96:99], v[156:159], v[252:255]
    v_mfma_f32_16x16x32_bf16 v[244:247], v[100:103], v[144:147], v[244:247]
    ds_read_b128 v[76:79], v192 offset:3840
    v_mfma_f32_16x16x32_bf16 v[248:251], v[100:103], v[148:151], v[248:251]
    v_mfma_f32_16x16x32_bf16 v[252:255], v[100:103], v[152:155], v[252:255]
    s_waitcnt lgkmcnt(15)
    v_mfma_f32_16x16x32_bf16 v[248:251], v[104:107], v[144:147], v[248:251]
    v_mfma_f32_16x16x32_bf16 v[252:255], v[104:107], v[148:151], v[252:255]
    v_mfma_f32_16x16x32_bf16 v[252:255], v[108:111], v[144:147], v[252:255]
    s_waitcnt lgkmcnt(14)
    v_mfma_f32_16x16x32_bf16 v[224:227], v[48:51], v[112:115], v[224:227]
    ds_read_b128 v[144:147], v193 offset:3968
    s_waitcnt lgkmcnt(14)
    v_mfma_f32_16x16x32_bf16 v[228:231], v[48:51], v[116:119], v[228:231]
    s_waitcnt lgkmcnt(13)
    v_mfma_f32_16x16x32_bf16 v[232:235], v[48:51], v[120:123], v[232:235]
    ds_read_b128 v[80:83], v192 offset:384
    s_waitcnt lgkmcnt(13)
    v_mfma_f32_16x16x32_bf16 v[236:239], v[48:51], v[124:127], v[236:239]
    s_waitcnt lgkmcnt(12)
    v_mfma_f32_16x16x32_bf16 v[240:243], v[48:51], v[128:131], v[240:243]
    ds_read_b128 v[148:151], v193 offset:3456
    s_waitcnt lgkmcnt(12)
    v_mfma_f32_16x16x32_bf16 v[244:247], v[48:51], v[132:135], v[244:247]
    s_waitcnt lgkmcnt(11)
    v_mfma_f32_16x16x32_bf16 v[248:251], v[48:51], v[136:139], v[248:251]
    ds_read_b128 v[152:155], v193 offset:2944
    s_waitcnt lgkmcnt(11)
    v_mfma_f32_16x16x32_bf16 v[252:255], v[48:51], v[140:143], v[252:255]
    s_waitcnt lgkmcnt(10)
    v_mfma_f32_16x16x32_bf16 v[228:231], v[52:55], v[112:115], v[228:231]
    ds_read_b128 v[156:159], v193 offset:2432
    v_mfma_f32_16x16x32_bf16 v[232:235], v[52:55], v[116:119], v[232:235]
    v_mfma_f32_16x16x32_bf16 v[236:239], v[52:55], v[120:123], v[236:239]
    ds_read_b128 v[160:163], v193 offset:1920
    v_mfma_f32_16x16x32_bf16 v[240:243], v[52:55], v[124:127], v[240:243]
    v_mfma_f32_16x16x32_bf16 v[244:247], v[52:55], v[128:131], v[244:247]
    ds_read_b128 v[164:167], v193 offset:1408
    v_mfma_f32_16x16x32_bf16 v[248:251], v[52:55], v[132:135], v[248:251]
    s_waitcnt vmcnt(2)
    buffer_store_dword v43, v223, s[8:11], 0 offen sc1
    v_mfma_f32_16x16x32_bf16 v[252:255], v[52:55], v[136:139], v[252:255]
    ds_read_b128 v[168:171], v193 offset:896
    s_waitcnt lgkmcnt(13)
    v_mfma_f32_16x16x32_bf16 v[232:235], v[56:59], v[112:115], v[232:235]
    v_mfma_f32_16x16x32_bf16 v[236:239], v[56:59], v[116:119], v[236:239]
    ds_read_b128 v[172:175], v193 offset:384
    v_mfma_f32_16x16x32_bf16 v[240:243], v[56:59], v[120:123], v[240:243]
    v_mfma_f32_16x16x32_bf16 v[244:247], v[56:59], v[124:127], v[244:247]
    ds_read_b128 v[84:87], v192 offset:896
    v_mfma_f32_16x16x32_bf16 v[248:251], v[56:59], v[128:131], v[248:251]
    v_mfma_f32_16x16x32_bf16 v[252:255], v[56:59], v[132:135], v[252:255]
    ds_read_b128 v[88:91], v192 offset:1408
    s_waitcnt lgkmcnt(15)
    v_mfma_f32_16x16x32_bf16 v[236:239], v[60:63], v[112:115], v[236:239]
    v_mfma_f32_16x16x32_bf16 v[240:243], v[60:63], v[116:119], v[240:243]
    ds_read_b128 v[92:95], v192 offset:1920
    v_mfma_f32_16x16x32_bf16 v[244:247], v[60:63], v[120:123], v[244:247]
    v_mfma_f32_16x16x32_bf16 v[248:251], v[60:63], v[124:127], v[248:251]
    ds_read_b128 v[96:99], v192 offset:2432
    v_mfma_f32_16x16x32_bf16 v[252:255], v[60:63], v[128:131], v[252:255]
    s_waitcnt lgkmcnt(15)
    v_mfma_f32_16x16x32_bf16 v[240:243], v[64:67], v[112:115], v[240:243]
    ds_read_b128 v[100:103], v192 offset:2944
    v_mfma_f32_16x16x32_bf16 v[244:247], v[64:67], v[116:119], v[244:247]
    v_mfma_f32_16x16x32_bf16 v[248:251], v[64:67], v[120:123], v[248:251]
    ds_read_b128 v[104:107], v192 offset:3456
    v_mfma_f32_16x16x32_bf16 v[252:255], v[64:67], v[124:127], v[252:255]
    v_mfma_f32_16x16x32_bf16 v[244:247], v[68:71], v[112:115], v[244:247]
    ds_read_b128 v[108:111], v192 offset:3968
    v_mfma_f32_16x16x32_bf16 v[248:251], v[68:71], v[116:119], v[248:251]
    v_mfma_f32_16x16x32_bf16 v[252:255], v[68:71], v[120:123], v[252:255]
    s_waitcnt lgkmcnt(15)
    v_mfma_f32_16x16x32_bf16 v[248:251], v[72:75], v[112:115], v[248:251]
    v_mfma_f32_16x16x32_bf16 v[252:255], v[72:75], v[116:119], v[252:255]
    v_mfma_f32_16x16x32_bf16 v[252:255], v[76:79], v[112:115], v[252:255]
    s_waitcnt lgkmcnt(14)
    v_mfma_f32_16x16x32_bf16 v[224:227], v[80:83], v[144:147], v[224:227]
    s_mul_i32 s26, s22, 10240
    s_add_u32 s26, s26, 79872
    s_waitcnt lgkmcnt(13)
    v_mfma_f32_16x16x32_bf16 v[228:231], v[80:83], v[148:151], v[228:231]
    v_mul_u32_u24 v198, 80, v195
    v_lshl_add_u32 v198, v196, 4, v198
    s_waitcnt lgkmcnt(12)
    v_mfma_f32_16x16x32_bf16 v[232:235], v[80:83], v[152:155], v[232:235]
    v_add_u32 v198, s26, v198
    s_lshl_b32 s26, s22, 10
    s_waitcnt lgkmcnt(11)
    v_mfma_f32_16x16x32_bf16 v[236:239], v[80:83], v[156:159], v[236:239]
    s_sub_u32 s26, 3324, s26
    v_lshlrev_b32 v197, 2, v0
    s_waitcnt lgkmcnt(10)
    v_mfma_f32_16x16x32_bf16 v[240:243], v[80:83], v[160:163], v[240:243]
    v_sub_u32 v197, s26, v197
    ds_read_b32 v48, v197 offset:768
    ds_write_b128 v198, v[224:227] offset:0
    s_waitcnt lgkmcnt(11)
    v_mfma_f32_16x16x32_bf16 v[244:247], v[80:83], v[164:167], v[244:247]
    ds_read_b32 v56, v197 offset:5376
    ds_read_b32 v50, v197 offset:512
    s_waitcnt lgkmcnt(12)
    v_mfma_f32_16x16x32_bf16 v[248:251], v[80:83], v[168:171], v[248:251]
    ds_read_b32 v58, v197 offset:5120
    ds_read_b32 v52, v197 offset:256
    s_waitcnt lgkmcnt(13)
    v_mfma_f32_16x16x32_bf16 v[252:255], v[80:83], v[172:175], v[252:255]
    ds_read_b32 v60, v197 offset:4864
    ds_read_b32 v54, v197 offset:0
    s_waitcnt lgkmcnt(14)
    v_mfma_f32_16x16x32_bf16 v[228:231], v[84:87], v[144:147], v[228:231]
    ds_read_b32 v62, v197 offset:4608
    s_mul_i32 s26, s22, 2560
    v_mfma_f32_16x16x32_bf16 v[232:235], v[84:87], v[148:151], v[232:235]
    s_add_u32 s26, s26, 79872
    v_lshrrev_b32 v72, 3, v0
    v_mfma_f32_16x16x32_bf16 v[236:239], v[84:87], v[152:155], v[236:239]
    v_lshlrev_b32 v72, 4, v72
    v_lshl_add_u32 v199, v0, 3, v72
    v_mfma_f32_16x16x32_bf16 v[240:243], v[84:87], v[156:159], v[240:243]
    v_add_u32 v199, s26, v199
    s_and_b32 s59, s58, 0xffff0000
    v_mfma_f32_16x16x32_bf16 v[244:247], v[84:87], v[160:163], v[244:247]
    s_lshl_b32 s58, s58, 16
    v_lshrrev_b32 v72, 2, v0
    ds_write_b128 v198, v[228:231] offset:1280
    v_mfma_f32_16x16x32_bf16 v[248:251], v[84:87], v[164:167], v[248:251]
    v_mul_u32_u24 v72, 14336, v72
    v_and_b32 v73, 3, v0
    v_mfma_f32_16x16x32_bf16 v[252:255], v[84:87], v[168:171], v[252:255]
    v_lshl_add_u32 v72, v73, 4, v72
    s_and_b32 s26, s25, 3
    s_waitcnt lgkmcnt(15)
    v_mfma_f32_16x16x32_bf16 v[232:235], v[88:91], v[144:147], v[232:235]
    s_lshl_b32 s26, s26, 2
    s_bfe_u32 s3, s25, 0x20002
    v_mfma_f32_16x16x32_bf16 v[236:239], v[88:91], v[148:151], v[236:239]
    s_add_u32 s26, s26, s3
    s_and_b32 s3, s25, 16
    v_mfma_f32_16x16x32_bf16 v[240:243], v[88:91], v[152:155], v[240:243]
    s_add_u32 s26, s26, s3
    s_lshl_b32 s3, s24, 5
    v_mfma_f32_16x16x32_bf16 v[244:247], v[88:91], v[156:159], v[244:247]
    s_add_u32 s26, s26, s3
    s_lshl_b32 s26, s26, 6
    v_mfma_f32_16x16x32_bf16 v[248:251], v[88:91], v[160:163], v[248:251]
    s_mul_i32 s3, s22, 917504
    s_add_u32 s26, s26, s3
    ds_write_b128 v198, v[232:235] offset:2560
    v_mfma_f32_16x16x32_bf16 v[252:255], v[88:91], v[164:167], v[252:255]
    s_add_u32 s26, s26, 3932160
    s_waitcnt lgkmcnt(2)
    v_lshlrev_b32 v49, 16, v48
    v_mfma_f32_16x16x32_bf16 v[236:239], v[92:95], v[144:147], v[236:239]
    v_and_b32 v48, 0xffff0000, v48
    v_lshlrev_b32 v57, 16, v56
    v_mfma_f32_16x16x32_bf16 v[240:243], v[92:95], v[148:151], v[240:243]
    v_and_b32 v56, 0xffff0000, v56
    v_lshlrev_b32 v51, 16, v50
    v_mfma_f32_16x16x32_bf16 v[244:247], v[92:95], v[152:155], v[244:247]
    v_and_b32 v50, 0xffff0000, v50
    v_lshlrev_b32 v59, 16, v58
    v_mfma_f32_16x16x32_bf16 v[248:251], v[92:95], v[156:159], v[248:251]
    v_and_b32 v58, 0xffff0000, v58
    v_lshlrev_b32 v53, 16, v52
    v_mfma_f32_16x16x32_bf16 v[252:255], v[92:95], v[160:163], v[252:255]
    v_and_b32 v52, 0xffff0000, v52
    v_lshlrev_b32 v61, 16, v60
    ds_write_b128 v198, v[236:239] offset:3840
    v_mfma_f32_16x16x32_bf16 v[240:243], v[96:99], v[144:147], v[240:243]
    v_and_b32 v60, 0xffff0000, v60
    v_lshlrev_b32 v55, 16, v54
    v_mfma_f32_16x16x32_bf16 v[244:247], v[96:99], v[148:151], v[244:247]
    v_and_b32 v54, 0xffff0000, v54
    v_lshlrev_b32 v63, 16, v62
    v_mfma_f32_16x16x32_bf16 v[248:251], v[96:99], v[152:155], v[248:251]
    v_and_b32 v62, 0xffff0000, v62
    s_waitcnt vmcnt(1)
    v_mfma_f32_16x16x32_bf16 v[252:255], v[96:99], v[156:159], v[252:255]
    v_mfma_f32_16x16x32_bf16 v[244:247], v[100:103], v[144:147], v[244:247]
    ds_write_b128 v198, v[240:243] offset:5120
    v_mfma_f32_16x16x32_bf16 v[248:251], v[100:103], v[148:151], v[248:251]
    v_mfma_f32_16x16x32_bf16 v[252:255], v[100:103], v[152:155], v[252:255]
    v_mfma_f32_16x16x32_bf16 v[248:251], v[104:107], v[144:147], v[248:251]
    v_mfma_f32_16x16x32_bf16 v[252:255], v[104:107], v[148:151], v[252:255]
    s_nop 2
    ds_write_b128 v198, v[244:247] offset:6400
    v_mfma_f32_16x16x32_bf16 v[252:255], v[108:111], v[144:147], v[252:255]
    s_nop 1
    ds_write_b128 v198, v[248:251] offset:7680
    s_nop 4
    ds_write_b128 v198, v[252:255] offset:8960
    s_branch L_epi
L_hw:
    s_mov_b32 s4, s34
    s_mov_b32 s5, s35
    s_mov_b32 s6, 1835008
    v_add_u32 v140, s30, v1
    v_subrev_u32 v141, 16, v140
    v_cmp_eq_u32 vcc, 0, v0
    s_nop 1
    v_cndmask_b32 v142, v141, v56, vcc
    buffer_load_dwordx4 v[144:147], v142, s[4:7], 0 offen offset:0 nt
    buffer_load_dwordx4 v[148:151], v140, s[4:7], 0 offen offset:0 nt
    buffer_load_dwordx4 v[152:155], v141, s[4:7], 0 offen offset:1024 nt
    buffer_load_dwordx4 v[156:159], v140, s[4:7], 0 offen offset:1024 nt
    buffer_load_dwordx4 v[160:163], v141, s[4:7], 0 offen offset:2048 nt
    buffer_load_dwordx4 v[164:167], v140, s[4:7], 0 offen offset:2048 nt
    buffer_load_dwordx4 v[168:171], v141, s[4:7], 0 offen offset:3072 nt
    buffer_load_dwordx4 v[172:175], v140, s[4:7], 0 offen offset:3072 nt
    s_lshl_b32 s26, s20, 8
    s_add_u32 s26, s26, 20480
    v_mov_b32 v211, s26
    s_lshl_b32 s26, s20, 7
    s_add_u32 s26, s26, 28672
    v_writelane_b32 v211, s26, 1
    s_lshl_b32 s26, s20, 7
    s_add_u32 s26, s26, 32768
    v_writelane_b32 v211, s26, 2
    s_lshl_b32 s26, s20, 7
    s_add_u32 s26, s26, 36864
    v_writelane_b32 v211, s26, 3
    s_lshl_b32 s26, s24, 8
    s_add_u32 s26, s26, 4096
    v_writelane_b32 v211, s26, 4
    s_add_u32 s26, s26, 128
    v_writelane_b32 v211, s26, 5
    s_add_u32 s26, s26, 128
    buffer_load_dword v46, v211, s[8:11], 0 offen sc1
    v_and_b32 v198, 7, v0
    s_mov_b32 s26, 3380953356
    v_lshlrev_b32 v199, 2, v198
    v_lshrrev_b32 v199, v199, s26
    v_and_b32 v199, 15, v199
    v_mul_u32_u24 v194, 4352, v198
    v_lshl_add_u32 v194, v199, 4, v194
    v_add_u32 v194, s29, v194
    v_and_b32 v195, 15, v0
    v_add_u32 v197, 1, v195
    v_and_b32 v198, 7, v197
    s_mov_b32 s26, 3380953356
    v_lshlrev_b32 v199, 2, v198
    v_lshrrev_b32 v199, v199, s26
    v_and_b32 v199, 15, v199
    v_mul_u32_u24 v192, 4352, v198
    v_lshl_add_u32 v192, v199, 4, v192
    v_add_u32 v192, s29, v192
    v_lshrrev_b32 v197, 3, v197
    v_lshrrev_b32 v196, 4, v0
    v_add_u32 v197, v197, v196
    v_lshl_add_u32 v192, v197, 4, v192
    v_subrev_u32 v192, 32, v192
    v_lshlrev_b32 v193, 4, v196
    v_lshlrev_b32 v197, 5, v195
    v_sub_u32 v193, v193, v197
    s_lshl_b32 s3, s27, 6
    v_add_u32 v192, s3, v192
    s_add_u32 s26, s28, s3
    s_add_u32 s26, s26, 480
    v_add_u32 v193, s26, v193
    s_waitcnt vmcnt(17)
    v_lshlrev_b32 v88, 16, v60
    v_lshlrev_b32 v89, 16, v62
    v_and_b32 v90, 0xffff0000, v60
    v_and_b32 v91, 0xffff0000, v62
    v_lshlrev_b32 v92, 16, v61
    v_lshlrev_b32 v93, 16, v63
    v_and_b32 v94, 0xffff0000, v61
    v_and_b32 v95, 0xffff0000, v63
    v_lshlrev_b32 v96, 16, v64
    v_and_b32 v97, 0xffff0000, v64
    v_lshlrev_b32 v98, 16, v65
    v_and_b32 v99, 0xffff0000, v65
    v_lshlrev_b32 v100, 16, v66
    v_and_b32 v101, 0xffff0000, v66
    v_lshlrev_b32 v102, 16, v67
    v_and_b32 v103, 0xffff0000, v67
    v_lshlrev_b32 v104, 16, v68
    v_and_b32 v105, 0xffff0000, v68
    v_lshlrev_b32 v106, 16, v69
    v_and_b32 v107, 0xffff0000, v69
    v_lshlrev_b32 v108, 16, v70
    v_and_b32 v109, 0xffff0000, v70
    v_lshlrev_b32 v110, 16, v71
    v_and_b32 v111, 0xffff0000, v71
    v_lshlrev_b32 v112, 16, v72
    v_and_b32 v113, 0xffff0000, v72
    v_lshlrev_b32 v114, 16, v73
    v_and_b32 v115, 0xffff0000, v73
    v_lshlrev_b32 v116, 16, v74
    v_and_b32 v117, 0xffff0000, v74
    v_pk_mul_f32 v[120:121], v[102:103], v[88:89]
    v_pk_fma_f32 v[120:121], v[100:101], v[90:91], v[120:121]
    v_pk_fma_f32 v[120:121], v[98:99], v[92:93], v[120:121]
    v_pk_fma_f32 v[120:121], v[96:97], v[94:95], v[120:121]
    v_pk_mul_f32 v[122:123], v[104:105], v[88:89]
    v_pk_fma_f32 v[122:123], v[102:103], v[90:91], v[122:123]
    v_pk_fma_f32 v[122:123], v[100:101], v[92:93], v[122:123]
    v_pk_fma_f32 v[122:123], v[98:99], v[94:95], v[122:123]
    v_pk_mul_f32 v[124:125], v[106:107], v[88:89]
    v_pk_fma_f32 v[124:125], v[104:105], v[90:91], v[124:125]
    v_pk_fma_f32 v[124:125], v[102:103], v[92:93], v[124:125]
    v_pk_fma_f32 v[124:125], v[100:101], v[94:95], v[124:125]
    v_pk_mul_f32 v[126:127], v[108:109], v[88:89]
    v_pk_fma_f32 v[126:127], v[106:107], v[90:91], v[126:127]
    v_pk_fma_f32 v[126:127], v[104:105], v[92:93], v[126:127]
    v_pk_fma_f32 v[126:127], v[102:103], v[94:95], v[126:127]
    v_pk_mul_f32 v[128:129], v[110:111], v[88:89]
    v_pk_fma_f32 v[128:129], v[108:109], v[90:91], v[128:129]
    v_pk_fma_f32 v[128:129], v[106:107], v[92:93], v[128:129]
    v_pk_fma_f32 v[128:129], v[104:105], v[94:95], v[128:129]
    v_pk_mul_f32 v[130:131], v[112:113], v[88:89]
    v_pk_fma_f32 v[130:131], v[110:111], v[90:91], v[130:131]
    v_pk_fma_f32 v[130:131], v[108:109], v[92:93], v[130:131]
    v_pk_fma_f32 v[130:131], v[106:107], v[94:95], v[130:131]
    v_pk_mul_f32 v[132:133], v[114:115], v[88:89]
    v_pk_fma_f32 v[132:133], v[112:113], v[90:91], v[132:133]
    v_pk_fma_f32 v[132:133], v[110:111], v[92:93], v[132:133]
    v_pk_fma_f32 v[132:133], v[108:109], v[94:95], v[132:133]
    v_pk_mul_f32 v[134:135], v[116:117], v[88:89]
    v_pk_fma_f32 v[134:135], v[114:115], v[90:91], v[134:135]
    v_pk_fma_f32 v[134:135], v[112:113], v[92:93], v[134:135]
    v_pk_fma_f32 v[134:135], v[110:111], v[94:95], v[134:135]
    s_waitcnt vmcnt(16)
    v_lshlrev_b32 v118, 16, v76
    v_and_b32 v119, 0xffff0000, v76
    v_pk_mul_f32 v[120:121], v[120:121], v[118:119]
    s_waitcnt vmcnt(15)
    v_lshlrev_b32 v118, 16, v77
    v_and_b32 v119, 0xffff0000, v77
    v_pk_mul_f32 v[122:123], v[122:123], v[118:119]
    s_waitcnt vmcnt(14)
    v_lshlrev_b32 v118, 16, v78
    v_and_b32 v119, 0xffff0000, v78
    v_pk_mul_f32 v[124:125], v[124:125], v[118:119]
    s_waitcnt vmcnt(13)
    v_lshlrev_b32 v118, 16, v79
    v_and_b32 v119, 0xffff0000, v79
    v_pk_mul_f32 v[126:127], v[126:127], v[118:119]
    s_waitcnt vmcnt(12)
    v_lshlrev_b32 v118, 16, v80
    v_and_b32 v119, 0xffff0000, v80
    v_pk_mul_f32 v[128:129], v[128:129], v[118:119]
    s_waitcnt vmcnt(11)
    v_lshlrev_b32 v118, 16, v81
    v_and_b32 v119, 0xffff0000, v81
    v_pk_mul_f32 v[130:131], v[130:131], v[118:119]
    s_waitcnt vmcnt(10)
    v_lshlrev_b32 v118, 16, v82
    v_and_b32 v119, 0xffff0000, v82
    v_pk_mul_f32 v[132:133], v[132:133], v[118:119]
    s_waitcnt vmcnt(9)
    v_lshlrev_b32 v118, 16, v83
    v_and_b32 v119, 0xffff0000, v83
    v_pk_mul_f32 v[134:135], v[134:135], v[118:119]
    v_cvt_pk_bf16_f32 v64, v134, v132
    v_cvt_pk_bf16_f32 v65, v130, v128
    v_cvt_pk_bf16_f32 v66, v126, v124
    v_cvt_pk_bf16_f32 v67, v122, v120
    v_cvt_pk_bf16_f32 v68, v135, v133
    v_cvt_pk_bf16_f32 v69, v131, v129
    v_cvt_pk_bf16_f32 v70, v127, v125
    v_cvt_pk_bf16_f32 v71, v123, v121
    ds_write_b128 v59, v[64:67]
    ds_write_b128 v59, v[68:71] offset:144
    s_waitcnt lgkmcnt(0)
    s_barrier
    s_add_u32 s26, s37, 262144
    v_and_b32 v143, 31, v0
    v_lshlrev_b32 v143, 12, v143
    buffer_load_dword v47, v143, s[8:11], s26 offen sc1
    s_mul_i32 s42, s43, 0x9E3779B1
    s_add_u32 s42, s42, 0x7F4A7C15
    s_and_b32 s42, s42, -16
    s_or_b32 s23, s23, s42
    v_mov_b32 v43, s23
    v_add_u32 v140, s29, v1
    s_waitcnt vmcnt(8)
    ds_write_b128 v140, v[148:151] offset:192
    v_mov_b32 v96, v145
    v_mov_b32 v97, v146
    v_mov_b32 v98, v147
    ds_write_b128 v140, v[146:149] offset:17472
    v_mov_b32 v99, v148
    v_mov_b32 v100, v149
    v_mov_b32 v101, v150
    ds_write_b128 v140, v[96:99] offset:8704
    v_alignbit_b32 v88, v145, v144, 16
    v_alignbit_b32 v89, v146, v145, 16
    v_alignbit_b32 v90, v147, v146, 16
    ds_write_b128 v140, v[98:101] offset:26240
    v_alignbit_b32 v91, v148, v147, 16
    v_alignbit_b32 v92, v149, v148, 16
    v_alignbit_b32 v93, v150, v149, 16
    ds_write_b128 v140, v[88:91] offset:4336
    v_alignbit_b32 v104, v146, v145, 16
    v_alignbit_b32 v105, v147, v146, 16
    v_alignbit_b32 v106, v148, v147, 16
    ds_write_b128 v140, v[90:93] offset:21872
    v_alignbit_b32 v107, v149, v148, 16
    v_alignbit_b32 v108, v150, v149, 16
    v_alignbit_b32 v109, v151, v150, 16
    ds_write_b128 v140, v[104:107] offset:13104
    ds_write_b128 v140, v[106:109] offset:30640
    s_waitcnt vmcnt(6)
    ds_write_b128 v140, v[156:159] offset:1216
    v_mov_b32 v96, v153
    v_mov_b32 v97, v154
    v_mov_b32 v98, v155
    ds_write_b128 v140, v[154:157] offset:18496
    v_mov_b32 v99, v156
    v_mov_b32 v100, v157
    v_mov_b32 v101, v158
    ds_write_b128 v140, v[96:99] offset:9728
    v_alignbit_b32 v88, v153, v152, 16
    v_alignbit_b32 v89, v154, v153, 16
    v_alignbit_b32 v90, v155, v154, 16
    ds_write_b128 v140, v[98:101] offset:27264
    v_alignbit_b32 v91, v156, v155, 16
    v_alignbit_b32 v92, v157, v156, 16
    v_alignbit_b32 v93, v158, v157, 16
    ds_write_b128 v140, v[88:91] offset:5360
    v_alignbit_b32 v104, v154, v153, 16
    v_alignbit_b32 v105, v155, v154, 16
    v_alignbit_b32 v106, v156, v155, 16
    ds_write_b128 v140, v[90:93] offset:22896
    v_alignbit_b32 v107, v157, v156, 16
    v_alignbit_b32 v108, v158, v157, 16
    v_alignbit_b32 v109, v159, v158, 16
    ds_write_b128 v140, v[104:107] offset:14128
    ds_write_b128 v140, v[106:109] offset:31664
    s_waitcnt vmcnt(4)
    ds_write_b128 v140, v[164:167] offset:2240
    v_mov_b32 v96, v161
    v_mov_b32 v97, v162
    v_mov_b32 v98, v163
    ds_write_b128 v140, v[162:165] offset:19520
    v_mov_b32 v99, v164
    v_mov_b32 v100, v165
    v_mov_b32 v101, v166
    ds_write_b128 v140, v[96:99] offset:10752
    v_alignbit_b32 v88, v161, v160, 16
    v_alignbit_b32 v89, v162, v161, 16
    v_alignbit_b32 v90, v163, v162, 16
    ds_write_b128 v140, v[98:101] offset:28288
    v_alignbit_b32 v91, v164, v163, 16
    v_alignbit_b32 v92, v165, v164, 16
    v_alignbit_b32 v93, v166, v165, 16
    ds_write_b128 v140, v[88:91] offset:6384
    v_alignbit_b32 v104, v162, v161, 16
    v_alignbit_b32 v105, v163, v162, 16
    v_alignbit_b32 v106, v164, v163, 16
    ds_write_b128 v140, v[90:93] offset:23920
    v_alignbit_b32 v107, v165, v164, 16
    v_alignbit_b32 v108, v166, v165, 16
    v_alignbit_b32 v109, v167, v166, 16
    ds_write_b128 v140, v[104:107] offset:15152
    ds_write_b128 v140, v[106:109] offset:32688
    s_waitcnt vmcnt(2)
    ds_write_b128 v140, v[172:175] offset:3264
    v_mov_b32 v96, v169
    v_mov_b32 v97, v170
    v_mov_b32 v98, v171
    ds_write_b128 v140, v[170:173] offset:20544
    v_mov_b32 v99, v172
    v_mov_b32 v100, v173
    v_mov_b32 v101, v174
    ds_write_b128 v140, v[96:99] offset:11776
    v_alignbit_b32 v88, v169, v168, 16
    v_alignbit_b32 v89, v170, v169, 16
    v_alignbit_b32 v90, v171, v170, 16
    ds_write_b128 v140, v[98:101] offset:29312
    v_alignbit_b32 v91, v172, v171, 16
    v_alignbit_b32 v92, v173, v172, 16
    v_alignbit_b32 v93, v174, v173, 16
    ds_write_b128 v140, v[88:91] offset:7408
    v_alignbit_b32 v104, v170, v169, 16
    v_alignbit_b32 v105, v171, v170, 16
    v_alignbit_b32 v106, v172, v171, 16
    ds_write_b128 v140, v[90:93] offset:24944
    v_alignbit_b32 v107, v173, v172, 16
    v_alignbit_b32 v108, v174, v173, 16
    v_alignbit_b32 v109, v175, v174, 16
    ds_write_b128 v140, v[104:107] offset:16176
    ds_write_b128 v140, v[106:109] offset:33712
    s_waitcnt lgkmcnt(0)
    s_barrier
    ds_read_b128 v[112:115], v193 offset:3584
    ds_read_b128 v[48:51], v192 offset:0
    ds_read_b128 v[116:119], v193 offset:3072
    ds_read_b128 v[120:123], v193 offset:2560
    ds_read_b128 v[124:127], v193 offset:2048
    ds_read_b128 v[128:131], v193 offset:1536
    ds_read_b128 v[132:135], v193 offset:1024
    ds_read_b128 v[136:139], v193 offset:512
    ds_read_b128 v[140:143], v193 offset:0
    ds_read_b128 v[52:55], v192 offset:512
    ds_read_b128 v[56:59], v192 offset:1024
    ds_read_b128 v[60:63], v192 offset:1536
    ds_read_b128 v[64:67], v192 offset:2048
    ds_read_b128 v[68:71], v192 offset:2560
    ds_read_b128 v[72:75], v192 offset:3072
    ds_read_b128 v[76:79], v192 offset:3584
    v_lshrrev_b32 v204, 4, v0
    v_bfe_u32 v205, v0, 2, 2
    v_and_b32 v206, 3, v0
    s_lshl_b32 s26, s22, 2
    v_add_u32 v207, s26, v204
    v_cmp_gt_u32 vcc, 14, v207
    v_mov_b32 v208, 2147483648
    s_lshl_b32 s26, s20, 6
    s_lshl_b32 s3, s21, 3
    s_add_u32 s26, s26, s3
    s_mov_b64 s[16:17], vcc
    v_lshl_add_u32 v209, v204, 1, s26
    v_mul_u32_u24 v210, 896, v209
    v_and_b32 v209, 15, v0
    v_lshl_add_u32 v210, v209, 4, v210
    s_lshl_b32 s3, s22, 8
    v_add_u32 v210, s3, v210
    s_lshl_b32 s3, s22, 2
    v_add_u32 v209, s3, v205
    v_cmp_gt_u32 vcc, 14, v209
    s_nop 1
    v_cndmask_b32 v12, v208, v210, vcc
    s_mov_b64 vcc, s[16:17]
    s_mov_b32 s4, s56
    s_mov_b32 s5, s57
    s_mov_b32 s6, 1835008
    buffer_load_dwordx4 v[32:35], v12, s[4:7], 0 offen offset:0
    buffer_load_dwordx4 v[36:39], v12, s[4:7], 0 offen offset:896
    s_waitcnt lgkmcnt(14)
    v_mfma_f32_16x16x32_bf16 v[224:227], v[48:51], v[112:115], 0
    ds_read_b128 v[144:147], v193 offset:3712
    s_mul_i32 s26, s26, 1792
    s_waitcnt lgkmcnt(14)
    v_mfma_f32_16x16x32_bf16 v[228:231], v[48:51], v[116:119], 0
    v_and_b32 v210, 15, v0
    v_lshlrev_b32 v210, 4, v210
    s_waitcnt lgkmcnt(13)
    v_mfma_f32_16x16x32_bf16 v[232:235], v[48:51], v[120:123], 0
    ds_read_b128 v[80:83], v192 offset:128
    v_lshl_add_u32 v210, v207, 10, v210
    s_waitcnt lgkmcnt(13)
    v_mfma_f32_16x16x32_bf16 v[236:239], v[48:51], v[124:127], 0
    v_add_u32 v210, s26, v210
    v_cndmask_b32 v216, v208, v210, vcc
    s_waitcnt lgkmcnt(12)
    v_mfma_f32_16x16x32_bf16 v[240:243], v[48:51], v[128:131], 0
    ds_read_b128 v[148:151], v193 offset:3200
    s_lshl_b32 s26, s22, 2
    s_waitcnt lgkmcnt(12)
    v_mfma_f32_16x16x32_bf16 v[244:247], v[48:51], v[132:135], 0
    s_add_u32 s26, s26, 145920
    v_lshlrev_b32 v210, 6, v206
    s_waitcnt lgkmcnt(11)
    v_mfma_f32_16x16x32_bf16 v[248:251], v[48:51], v[136:139], 0
    ds_read_b128 v[152:155], v193 offset:2688
    v_lshl_add_u32 v40, v204, 4, v210
    s_waitcnt lgkmcnt(11)
    v_mfma_f32_16x16x32_bf16 v[252:255], v[48:51], v[140:143], 0
    v_add_u32 v40, s26, v40
    v_add_u32 v41, 145920, v210
    s_waitcnt lgkmcnt(10)
    v_mfma_f32_16x16x32_bf16 v[228:231], v[52:55], v[112:115], v[228:231]
    ds_read_b128 v[156:159], v193 offset:2176
    v_mov_b32 v44, 925353388
    v_mfma_f32_16x16x32_bf16 v[232:235], v[52:55], v[116:119], v[232:235]
    s_mov_b32 s36, 991054117
    v_mov_b32 v204, 145664
    v_mfma_f32_16x16x32_bf16 v[236:239], v[52:55], v[120:123], v[236:239]
    ds_read_b128 v[160:163], v193 offset:1664
    ds_read_b32 v204, v204
    v_mfma_f32_16x16x32_bf16 v[240:243], v[52:55], v[124:127], v[240:243]
    s_waitcnt lgkmcnt(0)
    s_nop 0
    v_readfirstlane_b32 s18, v204
    v_mfma_f32_16x16x32_bf16 v[244:247], v[52:55], v[128:131], v[244:247]
    ds_read_b128 v[164:167], v193 offset:1152
    v_mfma_f32_16x16x32_bf16 v[248:251], v[52:55], v[132:135], v[248:251]
    v_mfma_f32_16x16x32_bf16 v[252:255], v[52:55], v[136:139], v[252:255]
    ds_read_b128 v[168:171], v193 offset:640
    v_mfma_f32_16x16x32_bf16 v[232:235], v[56:59], v[112:115], v[232:235]
    v_mfma_f32_16x16x32_bf16 v[236:239], v[56:59], v[116:119], v[236:239]
    ds_read_b128 v[172:175], v193 offset:128
    v_mfma_f32_16x16x32_bf16 v[240:243], v[56:59], v[120:123], v[240:243]
    v_mfma_f32_16x16x32_bf16 v[244:247], v[56:59], v[124:127], v[244:247]
    ds_read_b128 v[84:87], v192 offset:640
    v_mfma_f32_16x16x32_bf16 v[248:251], v[56:59], v[128:131], v[248:251]
    v_mfma_f32_16x16x32_bf16 v[252:255], v[56:59], v[132:135], v[252:255]
    ds_read_b128 v[88:91], v192 offset:1152
    v_mfma_f32_16x16x32_bf16 v[236:239], v[60:63], v[112:115], v[236:239]
    v_mfma_f32_16x16x32_bf16 v[240:243], v[60:63], v[116:119], v[240:243]
    ds_read_b128 v[92:95], v192 offset:1664
    v_mfma_f32_16x16x32_bf16 v[244:247], v[60:63], v[120:123], v[244:247]
    v_mfma_f32_16x16x32_bf16 v[248:251], v[60:63], v[124:127], v[248:251]
    ds_read_b128 v[96:99], v192 offset:2176
    v_mfma_f32_16x16x32_bf16 v[252:255], v[60:63], v[128:131], v[252:255]
    v_mfma_f32_16x16x32_bf16 v[240:243], v[64:67], v[112:115], v[240:243]
    ds_read_b128 v[100:103], v192 offset:2688
    v_mfma_f32_16x16x32_bf16 v[244:247], v[64:67], v[116:119], v[244:247]
    v_mfma_f32_16x16x32_bf16 v[248:251], v[64:67], v[120:123], v[248:251]
    ds_read_b128 v[104:107], v192 offset:3200
    v_mfma_f32_16x16x32_bf16 v[252:255], v[64:67], v[124:127], v[252:255]
    v_mfma_f32_16x16x32_bf16 v[244:247], v[68:71], v[112:115], v[244:247]
    ds_read_b128 v[108:111], v192 offset:3712
    v_mfma_f32_16x16x32_bf16 v[248:251], v[68:71], v[116:119], v[248:251]
    v_mfma_f32_16x16x32_bf16 v[252:255], v[68:71], v[120:123], v[252:255]
    v_mfma_f32_16x16x32_bf16 v[248:251], v[72:75], v[112:115], v[248:251]
    v_mfma_f32_16x16x32_bf16 v[252:255], v[72:75], v[116:119], v[252:255]
    v_mfma_f32_16x16x32_bf16 v[252:255], v[76:79], v[112:115], v[252:255]
    v_mfma_f32_16x16x32_bf16 v[224:227], v[80:83], v[144:147], v[224:227]
    ds_read_b128 v[112:115], v193 offset:3840
    v_mfma_f32_16x16x32_bf16 v[228:231], v[80:83], v[148:151], v[228:231]
    v_mfma_f32_16x16x32_bf16 v[232:235], v[80:83], v[152:155], v[232:235]
    ds_read_b128 v[48:51], v192 offset:256
    v_mfma_f32_16x16x32_bf16 v[236:239], v[80:83], v[156:159], v[236:239]
    v_mfma_f32_16x16x32_bf16 v[240:243], v[80:83], v[160:163], v[240:243]
    ds_read_b128 v[116:119], v193 offset:3328
    s_waitcnt lgkmcnt(12)
    v_mfma_f32_16x16x32_bf16 v[244:247], v[80:83], v[164:167], v[244:247]
    s_waitcnt lgkmcnt(11)
    v_mfma_f32_16x16x32_bf16 v[248:251], v[80:83], v[168:171], v[248:251]
    ds_read_b128 v[120:123], v193 offset:2816
    s_waitcnt lgkmcnt(11)
    v_mfma_f32_16x16x32_bf16 v[252:255], v[80:83], v[172:175], v[252:255]
    s_waitcnt lgkmcnt(10)
    v_mfma_f32_16x16x32_bf16 v[228:231], v[84:87], v[144:147], v[228:231]
    ds_read_b128 v[124:127], v193 offset:2304
    v_mfma_f32_16x16x32_bf16 v[232:235], v[84:87], v[148:151], v[232:235]
    v_mfma_f32_16x16x32_bf16 v[236:239], v[84:87], v[152:155], v[236:239]
    ds_read_b128 v[128:131], v193 offset:1792
    v_mfma_f32_16x16x32_bf16 v[240:243], v[84:87], v[156:159], v[240:243]
    v_mfma_f32_16x16x32_bf16 v[244:247], v[84:87], v[160:163], v[244:247]
    ds_read_b128 v[132:135], v193 offset:1280
    v_mfma_f32_16x16x32_bf16 v[248:251], v[84:87], v[164:167], v[248:251]
    v_mfma_f32_16x16x32_bf16 v[252:255], v[84:87], v[168:171], v[252:255]
    ds_read_b128 v[136:139], v193 offset:768
    s_waitcnt lgkmcnt(13)
    v_mfma_f32_16x16x32_bf16 v[232:235], v[88:91], v[144:147], v[232:235]
    v_mfma_f32_16x16x32_bf16 v[236:239], v[88:91], v[148:151], v[236:239]
    ds_read_b128 v[140:143], v193 offset:256
    v_mfma_f32_16x16x32_bf16 v[240:243], v[88:91], v[152:155], v[240:243]
    v_mfma_f32_16x16x32_bf16 v[244:247], v[88:91], v[156:159], v[244:247]
    ds_read_b128 v[52:55], v192 offset:768
    v_mfma_f32_16x16x32_bf16 v[248:251], v[88:91], v[160:163], v[248:251]
    v_mfma_f32_16x16x32_bf16 v[252:255], v[88:91], v[164:167], v[252:255]
    ds_read_b128 v[56:59], v192 offset:1280
    s_waitcnt lgkmcnt(15)
    v_mfma_f32_16x16x32_bf16 v[236:239], v[92:95], v[144:147], v[236:239]
    v_mfma_f32_16x16x32_bf16 v[240:243], v[92:95], v[148:151], v[240:243]
    ds_read_b128 v[60:63], v192 offset:1792
    v_mfma_f32_16x16x32_bf16 v[244:247], v[92:95], v[152:155], v[244:247]
    v_mfma_f32_16x16x32_bf16 v[248:251], v[92:95], v[156:159], v[248:251]
    ds_read_b128 v[64:67], v192 offset:2304
    v_mfma_f32_16x16x32_bf16 v[252:255], v[92:95], v[160:163], v[252:255]
    s_waitcnt lgkmcnt(15)
    v_mfma_f32_16x16x32_bf16 v[240:243], v[96:99], v[144:147], v[240:243]
    ds_read_b128 v[68:71], v192 offset:2816
    v_mfma_f32_16x16x32_bf16 v[244:247], v[96:99], v[148:151], v[244:247]
    v_mfma_f32_16x16x32_bf16 v[248:251], v[96:99], v[152:155], v[248:251]
    ds_read_b128 v[72:75], v192 offset:3328
    v_mfma_f32_16x16x32_bf16 v[252:255], v[96:99], v[156:159], v[252:255]
    v_mfma_f32_16x16x32_bf16 v[244:247], v[100:103], v[144:147], v[244:247]
    ds_read_b128 v[76:79], v192 offset:3840
    v_mfma_f32_16x16x32_bf16 v[248:251], v[100:103], v[148:151], v[248:251]
    v_mfma_f32_16x16x32_bf16 v[252:255], v[100:103], v[152:155], v[252:255]
    s_waitcnt lgkmcnt(15)
    v_mfma_f32_16x16x32_bf16 v[248:251], v[104:107], v[144:147], v[248:251]
    v_mfma_f32_16x16x32_bf16 v[252:255], v[104:107], v[148:151], v[252:255]
    v_mfma_f32_16x16x32_bf16 v[252:255], v[108:111], v[144:147], v[252:255]
    s_waitcnt lgkmcnt(14)
    v_mfma_f32_16x16x32_bf16 v[224:227], v[48:51], v[112:115], v[224:227]
    ds_read_b128 v[144:147], v193 offset:3968
    s_waitcnt lgkmcnt(14)
    v_mfma_f32_16x16x32_bf16 v[228:231], v[48:51], v[116:119], v[228:231]
    s_waitcnt lgkmcnt(13)
    v_mfma_f32_16x16x32_bf16 v[232:235], v[48:51], v[120:123], v[232:235]
    ds_read_b128 v[80:83], v192 offset:384
    s_waitcnt lgkmcnt(13)
    v_mfma_f32_16x16x32_bf16 v[236:239], v[48:51], v[124:127], v[236:239]
    s_waitcnt lgkmcnt(12)
    v_mfma_f32_16x16x32_bf16 v[240:243], v[48:51], v[128:131], v[240:243]
    ds_read_b128 v[148:151], v193 offset:3456
    s_waitcnt lgkmcnt(12)
    v_mfma_f32_16x16x32_bf16 v[244:247], v[48:51], v[132:135], v[244:247]
    s_waitcnt lgkmcnt(11)
    v_mfma_f32_16x16x32_bf16 v[248:251], v[48:51], v[136:139], v[248:251]
    ds_read_b128 v[152:155], v193 offset:2944
    s_waitcnt lgkmcnt(11)
    v_mfma_f32_16x16x32_bf16 v[252:255], v[48:51], v[140:143], v[252:255]
    s_waitcnt lgkmcnt(10)
    v_mfma_f32_16x16x32_bf16 v[228:231], v[52:55], v[112:115], v[228:231]
    ds_read_b128 v[156:159], v193 offset:2432
    v_mfma_f32_16x16x32_bf16 v[232:235], v[52:55], v[116:119], v[232:235]
    v_mfma_f32_16x16x32_bf16 v[236:239], v[52:55], v[120:123], v[236:239]
    ds_read_b128 v[160:163], v193 offset:1920
    v_mfma_f32_16x16x32_bf16 v[240:243], v[52:55], v[124:127], v[240:243]
    v_mfma_f32_16x16x32_bf16 v[244:247], v[52:55], v[128:131], v[244:247]
    ds_read_b128 v[164:167], v193 offset:1408
    v_mfma_f32_16x16x32_bf16 v[248:251], v[52:55], v[132:135], v[248:251]
    v_mfma_f32_16x16x32_bf16 v[252:255], v[52:55], v[136:139], v[252:255]
    ds_read_b128 v[168:171], v193 offset:896
    s_waitcnt lgkmcnt(13)
    v_mfma_f32_16x16x32_bf16 v[232:235], v[56:59], v[112:115], v[232:235]
    v_mfma_f32_16x16x32_bf16 v[236:239], v[56:59], v[116:119], v[236:239]
    ds_read_b128 v[172:175], v193 offset:384
    v_mfma_f32_16x16x32_bf16 v[240:243], v[56:59], v[120:123], v[240:243]
    v_mfma_f32_16x16x32_bf16 v[244:247], v[56:59], v[124:127], v[244:247]
    ds_read_b128 v[84:87], v192 offset:896
    v_mfma_f32_16x16x32_bf16 v[248:251], v[56:59], v[128:131], v[248:251]
    v_mfma_f32_16x16x32_bf16 v[252:255], v[56:59], v[132:135], v[252:255]
    ds_read_b128 v[88:91], v192 offset:1408
    s_waitcnt lgkmcnt(15)
    v_mfma_f32_16x16x32_bf16 v[236:239], v[60:63], v[112:115], v[236:239]
    v_mfma_f32_16x16x32_bf16 v[240:243], v[60:63], v[116:119], v[240:243]
    ds_read_b128 v[92:95], v192 offset:1920
    v_mfma_f32_16x16x32_bf16 v[244:247], v[60:63], v[120:123], v[244:247]
    v_mfma_f32_16x16x32_bf16 v[248:251], v[60:63], v[124:127], v[248:251]
    ds_read_b128 v[96:99], v192 offset:2432
    v_mfma_f32_16x16x32_bf16 v[252:255], v[60:63], v[128:131], v[252:255]
    s_waitcnt lgkmcnt(15)
    v_mfma_f32_16x16x32_bf16 v[240:243], v[64:67], v[112:115], v[240:243]
    ds_read_b128 v[100:103], v192 offset:2944
    v_mfma_f32_16x16x32_bf16 v[244:247], v[64:67], v[116:119], v[244:247]
    v_mfma_f32_16x16x32_bf16 v[248:251], v[64:67], v[120:123], v[248:251]
    ds_read_b128 v[104:107], v192 offset:3456
    v_mfma_f32_16x16x32_bf16 v[252:255], v[64:67], v[124:127], v[252:255]
    v_mfma_f32_16x16x32_bf16 v[244:247], v[68:71], v[112:115], v[244:247]
    ds_read_b128 v[108:111], v192 offset:3968
    v_mfma_f32_16x16x32_bf16 v[248:251], v[68:71], v[116:119], v[248:251]
    v_mfma_f32_16x16x32_bf16 v[252:255], v[68:71], v[120:123], v[252:255]
    s_waitcnt lgkmcnt(15)
    v_mfma_f32_16x16x32_bf16 v[248:251], v[72:75], v[112:115], v[248:251]
    v_mfma_f32_16x16x32_bf16 v[252:255], v[72:75], v[116:119], v[252:255]
    v_mfma_f32_16x16x32_bf16 v[252:255], v[76:79], v[112:115], v[252:255]
    s_waitcnt lgkmcnt(14)
    v_mfma_f32_16x16x32_bf16 v[224:227], v[80:83], v[144:147], v[224:227]
    s_mul_i32 s26, s22, 10240
    s_add_u32 s26, s26, 79872
    s_waitcnt lgkmcnt(13)
    v_mfma_f32_16x16x32_bf16 v[228:231], v[80:83], v[148:151], v[228:231]
    v_mul_u32_u24 v198, 80, v195
    v_lshl_add_u32 v198, v196, 4, v198
    s_waitcnt lgkmcnt(12)
    v_mfma_f32_16x16x32_bf16 v[232:235], v[80:83], v[152:155], v[232:235]
    v_add_u32 v198, s26, v198
    s_lshl_b32 s26, s22, 10
    s_waitcnt lgkmcnt(11)
    v_mfma_f32_16x16x32_bf16 v[236:239], v[80:83], v[156:159], v[236:239]
    s_sub_u32 s26, 3324, s26
    v_lshlrev_b32 v197, 2, v0
    s_waitcnt lgkmcnt(10)
    v_mfma_f32_16x16x32_bf16 v[240:243], v[80:83], v[160:163], v[240:243]
    v_sub_u32 v197, s26, v197
    ds_read_b32 v48, v197 offset:768
    ds_write_b128 v198, v[224:227] offset:0
    s_waitcnt lgkmcnt(11)
    v_mfma_f32_16x16x32_bf16 v[244:247], v[80:83], v[164:167], v[244:247]
    ds_read_b32 v56, v197 offset:5376
    ds_read_b32 v50, v197 offset:512
    s_waitcnt lgkmcnt(12)
    v_mfma_f32_16x16x32_bf16 v[248:251], v[80:83], v[168:171], v[248:251]
    ds_read_b32 v58, v197 offset:5120
    ds_read_b32 v52, v197 offset:256
    s_waitcnt lgkmcnt(13)
    v_mfma_f32_16x16x32_bf16 v[252:255], v[80:83], v[172:175], v[252:255]
    ds_read_b32 v60, v197 offset:4864
    ds_read_b32 v54, v197 offset:0
    s_waitcnt lgkmcnt(14)
    v_mfma_f32_16x16x32_bf16 v[228:231], v[84:87], v[144:147], v[228:231]
    ds_read_b32 v62, v197 offset:4608
    s_mul_i32 s26, s22, 2560
    v_mfma_f32_16x16x32_bf16 v[232:235], v[84:87], v[148:151], v[232:235]
    s_add_u32 s26, s26, 79872
    v_lshrrev_b32 v72, 3, v0
    v_mfma_f32_16x16x32_bf16 v[236:239], v[84:87], v[152:155], v[236:239]
    v_lshlrev_b32 v72, 4, v72
    v_lshl_add_u32 v199, v0, 3, v72
    v_mfma_f32_16x16x32_bf16 v[240:243], v[84:87], v[156:159], v[240:243]
    v_add_u32 v199, s26, v199
    s_and_b32 s59, s58, 0xffff0000
    v_mfma_f32_16x16x32_bf16 v[244:247], v[84:87], v[160:163], v[244:247]
    s_lshl_b32 s58, s58, 16
    v_lshrrev_b32 v72, 2, v0
    ds_write_b128 v198, v[228:231] offset:1280
    v_mfma_f32_16x16x32_bf16 v[248:251], v[84:87], v[164:167], v[248:251]
    v_mul_u32_u24 v72, 14336, v72
    v_and_b32 v73, 3, v0
    v_mfma_f32_16x16x32_bf16 v[252:255], v[84:87], v[168:171], v[252:255]
    v_lshl_add_u32 v72, v73, 4, v72
    s_and_b32 s26, s25, 3
    s_waitcnt lgkmcnt(15)
    v_mfma_f32_16x16x32_bf16 v[232:235], v[88:91], v[144:147], v[232:235]
    s_lshl_b32 s26, s26, 2
    s_bfe_u32 s3, s25, 0x20002
    v_mfma_f32_16x16x32_bf16 v[236:239], v[88:91], v[148:151], v[236:239]
    s_add_u32 s26, s26, s3
    s_and_b32 s3, s25, 16
    v_mfma_f32_16x16x32_bf16 v[240:243], v[88:91], v[152:155], v[240:243]
    s_add_u32 s26, s26, s3
    s_lshl_b32 s3, s24, 5
    v_mfma_f32_16x16x32_bf16 v[244:247], v[88:91], v[156:159], v[244:247]
    s_add_u32 s26, s26, s3
    s_lshl_b32 s26, s26, 6
    v_mfma_f32_16x16x32_bf16 v[248:251], v[88:91], v[160:163], v[248:251]
    s_mul_i32 s3, s22, 917504
    s_add_u32 s26, s26, s3
    ds_write_b128 v198, v[232:235] offset:2560
    v_mfma_f32_16x16x32_bf16 v[252:255], v[88:91], v[164:167], v[252:255]
    s_add_u32 s26, s26, 3932160
    s_waitcnt lgkmcnt(2)
    v_lshlrev_b32 v49, 16, v48
    v_mfma_f32_16x16x32_bf16 v[236:239], v[92:95], v[144:147], v[236:239]
    v_and_b32 v48, 0xffff0000, v48
    v_lshlrev_b32 v57, 16, v56
    v_mfma_f32_16x16x32_bf16 v[240:243], v[92:95], v[148:151], v[240:243]
    v_and_b32 v56, 0xffff0000, v56
    v_lshlrev_b32 v51, 16, v50
    v_mfma_f32_16x16x32_bf16 v[244:247], v[92:95], v[152:155], v[244:247]
    v_and_b32 v50, 0xffff0000, v50
    v_lshlrev_b32 v59, 16, v58
    v_mfma_f32_16x16x32_bf16 v[248:251], v[92:95], v[156:159], v[248:251]
    v_and_b32 v58, 0xffff0000, v58
    v_lshlrev_b32 v53, 16, v52
    v_mfma_f32_16x16x32_bf16 v[252:255], v[92:95], v[160:163], v[252:255]
    v_and_b32 v52, 0xffff0000, v52
    v_lshlrev_b32 v61, 16, v60
    ds_write_b128 v198, v[236:239] offset:3840
    v_mfma_f32_16x16x32_bf16 v[240:243], v[96:99], v[144:147], v[240:243]
    v_and_b32 v60, 0xffff0000, v60
    v_lshlrev_b32 v55, 16, v54
    v_mfma_f32_16x16x32_bf16 v[244:247], v[96:99], v[148:151], v[244:247]
    v_and_b32 v54, 0xffff0000, v54
    v_lshlrev_b32 v63, 16, v62
    v_mfma_f32_16x16x32_bf16 v[248:251], v[96:99], v[152:155], v[248:251]
    v_and_b32 v62, 0xffff0000, v62
    v_mfma_f32_16x16x32_bf16 v[252:255], v[96:99], v[156:159], v[252:255]
    v_mfma_f32_16x16x32_bf16 v[244:247], v[100:103], v[144:147], v[244:247]
    ds_write_b128 v198, v[240:243] offset:5120
    v_mfma_f32_16x16x32_bf16 v[248:251], v[100:103], v[148:151], v[248:251]
    v_mfma_f32_16x16x32_bf16 v[252:255], v[100:103], v[152:155], v[252:255]
    v_mfma_f32_16x16x32_bf16 v[248:251], v[104:107], v[144:147], v[248:251]
    v_mfma_f32_16x16x32_bf16 v[252:255], v[104:107], v[148:151], v[252:255]
    s_nop 2
    ds_write_b128 v198, v[244:247] offset:6400
    v_mfma_f32_16x16x32_bf16 v[252:255], v[108:111], v[144:147], v[252:255]
    s_nop 1
    ds_write_b128 v198, v[248:251] offset:7680
    s_nop 4
    ds_write_b128 v198, v[252:255] offset:8960
    s_waitcnt vmcnt(0)
L_epi:
    s_lshl_b32 s19, s21, 14
    s_add_u32 s19, s19, 65536
    v_min_u32 v212, 55, v0
    v_lshl_add_u32 v212, v212, 7, s19
    buffer_load_dword v211, v212, s[8:11], 0 offen sc1
    s_waitcnt lgkmcnt(0)
    s_barrier
    ds_read_b64 v[76:77], v199 offset:0
    ds_read_b64 v[78:79], v199 offset:20480
    ds_read_b64 v[80:81], v199 offset:10240
    ds_read_b64 v[82:83], v199 offset:30720
    ds_read_b64 v[84:85], v199 offset:640
    ds_read_b64 v[86:87], v199 offset:21120
    ds_read_b64 v[88:89], v199 offset:10880
    ds_read_b64 v[90:91], v199 offset:31360
    ds_read_b64 v[92:93], v199 offset:1280
    ds_read_b64 v[94:95], v199 offset:21760
    ds_read_b64 v[96:97], v199 offset:11520
    ds_read_b64 v[98:99], v199 offset:32000
    ds_read_b64 v[100:101], v199 offset:1920
    ds_read_b64 v[102:103], v199 offset:22400
    ds_read_b64 v[104:105], v199 offset:12160
    ds_read_b64 v[106:107], v199 offset:32640
    s_waitcnt lgkmcnt(14)
    v_pk_add_f32 v[76:77], v[76:77], v[78:79]
    v_pk_fma_f32 v[76:77], v[48:49], s[58:59], v[76:77] op_sel_hi:[1,0,1]
    s_waitcnt lgkmcnt(12)
    v_pk_add_f32 v[80:81], v[80:81], v[82:83]
    v_pk_fma_f32 v[80:81], v[56:57], s[58:59], v[80:81] op_sel:[0,1,0] op_sel_hi:[1,1,1]
    v_cvt_pk_bf16_f32 v76, v76, v77
    v_cvt_pk_bf16_f32 v78, v80, v81
    v_mov_b32 v77, s42
    v_mov_b32 v79, s42
    buffer_store_dwordx4 v[76:79], v72, s[8:11], s26 offen sc1
    s_add_u32 s26, s26, 229376
    s_waitcnt lgkmcnt(10)
    v_pk_add_f32 v[84:85], v[84:85], v[86:87]
    v_pk_fma_f32 v[84:85], v[50:51], s[58:59], v[84:85] op_sel_hi:[1,0,1]
    s_waitcnt lgkmcnt(8)
    v_pk_add_f32 v[88:89], v[88:89], v[90:91]
    v_pk_fma_f32 v[88:89], v[58:59], s[58:59], v[88:89] op_sel:[0,1,0] op_sel_hi:[1,1,1]
    v_cvt_pk_bf16_f32 v84, v84, v85
    v_cvt_pk_bf16_f32 v86, v88, v89
    v_mov_b32 v85, s42
    v_mov_b32 v87, s42
    buffer_store_dwordx4 v[84:87], v72, s[8:11], s26 offen sc1
    s_add_u32 s26, s26, 229376
    s_waitcnt lgkmcnt(6)
    v_pk_add_f32 v[92:93], v[92:93], v[94:95]
    v_pk_fma_f32 v[92:93], v[52:53], s[58:59], v[92:93] op_sel_hi:[1,0,1]
    s_waitcnt lgkmcnt(4)
    v_pk_add_f32 v[96:97], v[96:97], v[98:99]
    v_pk_fma_f32 v[96:97], v[60:61], s[58:59], v[96:97] op_sel:[0,1,0] op_sel_hi:[1,1,1]
    v_cvt_pk_bf16_f32 v92, v92, v93
    v_cvt_pk_bf16_f32 v94, v96, v97
    v_mov_b32 v93, s42
    v_mov_b32 v95, s42
    buffer_store_dwordx4 v[92:95], v72, s[8:11], s26 offen sc1
    s_add_u32 s26, s26, 229376
    s_waitcnt lgkmcnt(2)
    v_pk_add_f32 v[100:101], v[100:101], v[102:103]
    v_pk_fma_f32 v[100:101], v[54:55], s[58:59], v[100:101] op_sel_hi:[1,0,1]
    s_waitcnt lgkmcnt(0)
    v_pk_add_f32 v[104:105], v[104:105], v[106:107]
    v_pk_fma_f32 v[104:105], v[62:63], s[58:59], v[104:105] op_sel:[0,1,0] op_sel_hi:[1,1,1]
    v_cvt_pk_bf16_f32 v100, v100, v101
    v_cvt_pk_bf16_f32 v102, v104, v105
    v_mov_b32 v101, s42
    v_mov_b32 v103, s42
    buffer_store_dwordx4 v[100:103], v72, s[8:11], s26 offen sc1
    s_lshl_b32 s26, s21, 2
    s_add_u32 s26, s26, s22
    s_mul_i32 s26, s26, 150528
    v_add_u32 v13, s26, v1
    v_add_u32 v219, 4096, v13
    s_mov_b32 s60, 7602176
    s_mov_b32 s61, 7609344
    s_mov_b32 s62, 7616512
    s_mov_b32 s63, 7623680
    s_mov_b32 s64, 7630848
    s_mov_b32 s65, 7638016
    s_mov_b32 s66, 7645184
    s_mov_b32 s67, 7652352
    s_mov_b32 s68, 7659520
    s_mov_b32 s69, 7666688
    s_mov_b32 s70, 7673856
    s_mov_b32 s71, 7681024
    s_mov_b32 s72, 7688192
    s_mov_b32 s73, 7695360
    s_waitcnt vmcnt(4)
    v_and_b32 v211, -16, v211
    v_cmp_ne_u32 vcc, s42, v211
    s_cbranch_vccz L_wa_ok
    s_mov_b32 s34, 0
L_wa_1:
    buffer_load_dword v42, v212, s[8:11], 0 offen sc1
    s_waitcnt vmcnt(0)
    v_and_b32 v46, -16, v42
    v_cmp_ne_u32 vcc, s42, v46
    s_cbranch_vccz L_wa_1_x
    s_add_u32 s34, s34, 1
    s_cmp_lt_u32 s34, 1048576
    s_cbranch_scc1 L_wa_1
L_wa_1_x:
    s_waitcnt vmcnt(0)
L_wa_ok:
    s_branch L_join
L_spare:
    s_waitcnt lgkmcnt(0)
    s_load_dword s43, s[8:9], 0x0
    v_lshrrev_b32 v204, 4, v0
    v_bfe_u32 v205, v0, 2, 2
    v_and_b32 v206, 3, v0
    s_lshl_b32 s26, s22, 2
    v_add_u32 v207, s26, v204
    v_cmp_gt_u32 vcc, 14, v207
    v_mov_b32 v208, 2147483648
    s_lshl_b32 s26, s20, 6
    s_lshl_b32 s3, s21, 3
    s_add_u32 s26, s26, s3
    s_mov_b64 s[16:17], vcc
    v_lshl_add_u32 v209, v204, 1, s26
    v_mul_u32_u24 v210, 896, v209
    v_and_b32 v209, 15, v0
    v_lshl_add_u32 v210, v209, 4, v210
    s_lshl_b32 s3, s22, 8
    v_add_u32 v210, s3, v210
    s_lshl_b32 s3, s22, 2
    v_add_u32 v209, s3, v205
    v_cmp_gt_u32 vcc, 14, v209
    s_nop 1
    v_cndmask_b32 v12, v208, v210, vcc
    s_mov_b64 vcc, s[16:17]
    s_mul_i32 s26, s26, 1792
    v_and_b32 v210, 15, v0
    v_lshlrev_b32 v210, 4, v210
    v_lshl_add_u32 v210, v207, 10, v210
    v_add_u32 v210, s26, v210
    v_cndmask_b32 v216, v208, v210, vcc
    s_mul_i32 s33, s20, 57344
    s_lshr_b32 s26, s21, 2
    s_mul_i32 s26, s26, 28672
    s_add_u32 s26, s26, s33
    s_and_b32 s3, s21, 3
    s_lshl_b32 s3, s3, 6
    s_add_u32 s26, s26, s3
    v_lshlrev_b32 v210, 10, v207
    v_lshl_add_u32 v210, v205, 8, v210
    v_lshl_add_u32 v210, v206, 4, v210
    v_add_u32 v210, s26, v210
    v_cndmask_b32 v11, v208, v210, vcc
    s_lshl_b32 s26, s22, 2
    s_add_u32 s26, s26, 145920
    v_lshlrev_b32 v210, 6, v206
    v_lshl_add_u32 v40, v204, 4, v210
    v_add_u32 v40, s26, v40
    v_add_u32 v41, 145920, v210
    v_mov_b32 v44, 925353388
    s_mov_b32 s36, 991054117
    s_lshl_b32 s26, s20, 8
    s_add_u32 s26, s26, 20480
    v_mov_b32 v211, s26
    s_lshl_b32 s26, s20, 7
    s_add_u32 s26, s26, 28672
    v_writelane_b32 v211, s26, 1
    s_lshl_b32 s26, s20, 7
    s_add_u32 s26, s26, 32768
    v_writelane_b32 v211, s26, 2
    s_lshl_b32 s26, s20, 7
    s_add_u32 s26, s26, 36864
    v_writelane_b32 v211, s26, 3
    s_lshl_b32 s26, s24, 8
    s_add_u32 s26, s26, 4096
    v_writelane_b32 v211, s26, 4
    s_add_u32 s26, s26, 128
    v_writelane_b32 v211, s26, 5
    s_add_u32 s26, s26, 128
    buffer_load_dword v46, v211, s[8:11], 0 offen sc1
    s_mov_b32 s4, s56
    s_mov_b32 s5, s57
    s_mov_b32 s6, 1835008
    buffer_load_dwordx4 v[32:35], v12, s[4:7], 0 offen offset:0
    buffer_load_dwordx4 v[36:39], v12, s[4:7], 0 offen offset:896
    s_mov_b32 s33, 2097152
    buffer_load_dword v46, v11, s[8:11], s33 offen sc1
    s_mov_b32 s33, 2111488
    buffer_load_dword v46, v11, s[8:11], s33 offen sc1
    s_waitcnt vmcnt(0)
    s_mov_b32 s4, s52
    s_mov_b32 s5, s53
    s_mov_b32 s6, 1605632
    v_lshrrev_b32 v72, 2, v0
    v_and_b32 v73, 3, v0
    v_lshlrev_b32 v73, 4, v73
    s_movk_i32 s49, 896
    v_mad_u32_u24 v72, v72, s49, v73
    v_bfe_u32 v74, v0, 2, 1
    v_bfe_u32 v75, v0, 5, 1
    v_lshl_add_u32 v74, v75, 1, v74
    v_bfe_u32 v75, v0, 4, 1
    v_lshl_add_u32 v74, v75, 2, v74
    v_bfe_u32 v75, v0, 3, 1
    v_lshl_add_u32 v74, v75, 3, v74
    v_mad_u32_u24 v74, v74, s49, v73
    s_add_u32 s26, s25, 0
    s_and_b32 s38, s26, 7
    s_lshr_b32 s39, s26, 3
    s_mul_i32 s28, s39, 7
    s_add_u32 s28, s28, s22
    s_sub_u32 s29, s39, 4
    s_lshl_b32 s29, s29, 1
    s_lshr_b32 s30, s22, 1
    s_add_u32 s29, s29, s30
    s_mul_i32 s29, s29, 7
    s_and_b32 s30, s22, 1
    s_add_u32 s29, s29, s30
    s_add_u32 s29, s29, 4
    s_cmp_lt_u32 s39, 4
    s_cselect_b32 s28, s28, s29
    s_mul_i32 s29, s22, 7
    s_add_u32 s29, s29, 6
    s_cmp_ge_u32 s39, 6
    s_cselect_b32 s28, s29, s28
    s_mul_i32 s29, s38, 28
    s_add_u32 s28, s28, s29
    s_mul_i32 s28, s28, 7168
    s_mul_i32 s29, s22, 7168
    s_add_u32 s29, s29, 0
    s_mov_b32 m0, s29
    s_add_u32 s29, s29, 1024
    buffer_load_dwordx4 v1, s[4:7], s28 offen nt lds
    s_add_u32 s28, s28, 1024
    s_mov_b32 m0, s29
    s_add_u32 s29, s29, 1024
    buffer_load_dwordx4 v1, s[4:7], s28 offen nt lds
    s_add_u32 s28, s28, 1024
    s_mov_b32 m0, s29
    s_add_u32 s29, s29, 1024
    buffer_load_dwordx4 v1, s[4:7], s28 offen nt lds
    s_add_u32 s28, s28, 1024
    s_mov_b32 m0, s29
    s_add_u32 s29, s29, 1024
    buffer_load_dwordx4 v1, s[4:7], s28 offen nt lds
    s_add_u32 s28, s28, 1024
    s_mov_b32 m0, s29
    s_add_u32 s29, s29, 1024
    buffer_load_dwordx4 v1, s[4:7], s28 offen nt lds
    s_add_u32 s28, s28, 1024
    s_mov_b32 m0, s29
    s_add_u32 s29, s29, 1024
    buffer_load_dwordx4 v1, s[4:7], s28 offen nt lds
    s_add_u32 s28, s28, 1024
    s_mov_b32 m0, s29
    s_add_u32 s29, s29, 1024
    buffer_load_dwordx4 v1, s[4:7], s28 offen nt lds
    s_add_u32 s28, s28, 1024
    s_add_u32 s26, s25, 32
    s_and_b32 s50, s26, 7
    s_lshr_b32 s51, s26, 3
    s_mul_i32 s28, s51, 7
    s_add_u32 s28, s28, s22
    s_sub_u32 s29, s51, 4
    s_lshl_b32 s29, s29, 1
    s_lshr_b32 s30, s22, 1
    s_add_u32 s29, s29, s30
    s_mul_i32 s29, s29, 7
    s_and_b32 s30, s22, 1
    s_add_u32 s29, s29, s30
    s_add_u32 s29, s29, 4
    s_cmp_lt_u32 s51, 4
    s_cselect_b32 s28, s28, s29
    s_mul_i32 s29, s22, 7
    s_add_u32 s29, s29, 6
    s_cmp_ge_u32 s51, 6
    s_cselect_b32 s28, s29, s28
    s_mul_i32 s29, s50, 28
    s_add_u32 s28, s28, s29
    s_mul_i32 s28, s28, 7168
    s_mul_i32 s29, s22, 7168
    s_add_u32 s29, s29, 28672
    s_mov_b32 m0, s29
    s_add_u32 s29, s29, 1024
    buffer_load_dwordx4 v1, s[4:7], s28 offen nt lds
    s_add_u32 s28, s28, 1024
    s_mov_b32 m0, s29
    s_add_u32 s29, s29, 1024
    buffer_load_dwordx4 v1, s[4:7], s28 offen nt lds
    s_add_u32 s28, s28, 1024
    s_mov_b32 m0, s29
    s_add_u32 s29, s29, 1024
    buffer_load_dwordx4 v1, s[4:7], s28 offen nt lds
    s_add_u32 s28, s28, 1024
    s_mov_b32 m0, s29
    s_add_u32 s29, s29, 1024
    buffer_load_dwordx4 v1, s[4:7], s28 offen nt lds
    s_add_u32 s28, s28, 1024
    s_mov_b32 m0, s29
    s_add_u32 s29, s29, 1024
    buffer_load_dwordx4 v1, s[4:7], s28 offen nt lds
    s_add_u32 s28, s28, 1024
    s_mov_b32 m0, s29
    s_add_u32 s29, s29, 1024
    buffer_load_dwordx4 v1, s[4:7], s28 offen nt lds
    s_add_u32 s28, s28, 1024
    s_mov_b32 m0, s29
    s_add_u32 s29, s29, 1024
    buffer_load_dwordx4 v1, s[4:7], s28 offen nt lds
    s_add_u32 s28, s28, 1024
    s_mov_b32 s18, 2097152
    s_waitcnt vmcnt(0)
    s_waitcnt lgkmcnt(0)
    s_barrier
    s_mul_i32 s42, s43, 0x9E3779B1
    s_add_u32 s42, s42, 0x7F4A7C15
    s_and_b32 s42, s42, -16
    s_or_b32 s23, s23, s42
    v_mov_b32 v43, s23
    s_xor_b32 s35, s39, s22
    s_cmp_lt_u32 s39, 4
    s_cselect_b32 s35, s35, s39
    s_lshl_b32 s28, s38, 2
    s_add_u32 s28, s28, s22
    s_mul_i32 s28, s28, 150528
    s_add_u32 s28, s28, 7702528
    s_cmp_ge_u32 s39, 7
    s_cselect_b32 s28, 2147483648, s28
    s_mul_i32 s29, s22, 7
    s_cmp_eq_u32 s39, 6
    s_cselect_b64 vcc, -1, 0
    v_cndmask_b32 v75, v72, v74, vcc
    s_add_u32 s26, s29, 0
    s_lshr_b32 s3, s26, 1
    s_lshl_b32 s3, s3, 6
    s_and_b32 s26, s26, 1
    s_lshl_b32 s26, s26, 3
    s_add_u32 s26, s26, s3
    s_add_u32 s26, s26, 0
    v_add_u32 v73, s26, v75
    ds_read_b64_tr_b16 v[80:81], v73
    ds_read_b64_tr_b16 v[82:83], v73 offset:14336
    s_add_u32 s26, s29, 1
    s_lshr_b32 s3, s26, 1
    s_lshl_b32 s3, s3, 6
    s_and_b32 s26, s26, 1
    s_lshl_b32 s26, s26, 3
    s_add_u32 s26, s26, s3
    s_add_u32 s26, s26, 0
    v_add_u32 v73, s26, v75
    ds_read_b64_tr_b16 v[84:85], v73
    ds_read_b64_tr_b16 v[86:87], v73 offset:14336
    s_add_u32 s26, s29, 2
    s_lshr_b32 s3, s26, 1
    s_lshl_b32 s3, s3, 6
    s_and_b32 s26, s26, 1
    s_lshl_b32 s26, s26, 3
    s_add_u32 s26, s26, s3
    s_add_u32 s26, s26, 0
    v_add_u32 v73, s26, v75
    ds_read_b64_tr_b16 v[88:89], v73
    ds_read_b64_tr_b16 v[90:91], v73 offset:14336
    s_add_u32 s26, s29, 3
    s_lshr_b32 s3, s26, 1
    s_lshl_b32 s3, s3, 6
    s_and_b32 s26, s26, 1
    s_lshl_b32 s26, s26, 3
    s_add_u32 s26, s26, s3
    s_add_u32 s26, s26, 0
    v_add_u32 v73, s26, v75
    ds_read_b64_tr_b16 v[92:93], v73
    ds_read_b64_tr_b16 v[94:95], v73 offset:14336
    s_add_u32 s26, s29, 4
    s_lshr_b32 s3, s26, 1
    s_lshl_b32 s3, s3, 6
    s_and_b32 s26, s26, 1
    s_lshl_b32 s26, s26, 3
    s_add_u32 s26, s26, s3
    s_add_u32 s26, s26, 0
    v_add_u32 v73, s26, v75
    ds_read_b64_tr_b16 v[96:97], v73
    ds_read_b64_tr_b16 v[98:99], v73 offset:14336
    s_add_u32 s26, s29, 5
    s_lshr_b32 s3, s26, 1
    s_lshl_b32 s3, s3, 6
    s_and_b32 s26, s26, 1
    s_lshl_b32 s26, s26, 3
    s_add_u32 s26, s26, s3
    s_add_u32 s26, s26, 0
    v_add_u32 v73, s26, v75
    ds_read_b64_tr_b16 v[100:101], v73
    ds_read_b64_tr_b16 v[102:103], v73 offset:14336
    s_add_u32 s26, s29, 6
    s_lshr_b32 s3, s26, 1
    s_lshl_b32 s3, s3, 6
    s_and_b32 s26, s26, 1
    s_lshl_b32 s26, s26, 3
    s_add_u32 s26, s26, s3
    s_add_u32 s26, s26, 0
    v_add_u32 v73, s26, v75
    ds_read_b64_tr_b16 v[104:105], v73
    ds_read_b64_tr_b16 v[106:107], v73 offset:14336
    s_mul_i32 s26, s35, 3072
    s_add_u32 s26, s26, 4096
    s_cmp_eq_u32 s35, 0
    s_cselect_b32 s26, 0, s26
    s_add_u32 s26, s26, s28
    s_waitcnt lgkmcnt(12)
    buffer_store_dwordx4 v[80:83], v1, s[8:11], s26 offen sc1
    s_mul_i32 s26, s35, 3072
    s_add_u32 s26, s26, 5120
    s_cmp_eq_u32 s35, 0
    s_cselect_b32 s26, 1024, s26
    s_add_u32 s26, s26, s28
    s_waitcnt lgkmcnt(10)
    buffer_store_dwordx4 v[84:87], v1, s[8:11], s26 offen sc1
    s_mul_i32 s26, s35, 3072
    s_add_u32 s26, s26, 6144
    s_cmp_eq_u32 s35, 0
    s_cselect_b32 s26, 2048, s26
    s_add_u32 s26, s26, s28
    s_waitcnt lgkmcnt(8)
    buffer_store_dwordx4 v[88:91], v1, s[8:11], s26 offen sc1
    s_mul_i32 s26, s35, 2048
    s_add_u32 s26, s26, 23552
    s_cmp_eq_u32 s35, 0
    s_cselect_b32 s26, 3072, s26
    s_add_u32 s26, s26, s28
    s_waitcnt lgkmcnt(6)
    buffer_store_dwordx4 v[92:95], v1, s[8:11], s26 offen sc1
    s_mul_i32 s26, s35, 2048
    s_add_u32 s26, s26, 24576
    s_cmp_eq_u32 s35, 0
    s_cselect_b32 s26, 4096, s26
    s_add_u32 s26, s26, s28
    s_waitcnt lgkmcnt(4)
    buffer_store_dwordx4 v[96:99], v1, s[8:11], s26 offen sc1
    s_mul_i32 s26, s35, 2048
    s_add_u32 s26, s26, 35840
    s_cmp_eq_u32 s35, 0
    s_cselect_b32 s26, 5120, s26
    s_add_u32 s26, s26, s28
    s_waitcnt lgkmcnt(2)
    buffer_store_dwordx4 v[100:103], v1, s[8:11], s26 offen sc1
    s_mul_i32 s26, s35, 2048
    s_add_u32 s26, s26, 36864
    s_cmp_eq_u32 s35, 0
    s_cselect_b32 s26, 6144, s26
    s_add_u32 s26, s26, s28
    s_waitcnt lgkmcnt(0)
    buffer_store_dwordx4 v[104:107], v1, s[8:11], s26 offen sc1
    s_xor_b32 s35, s51, s22
    s_cmp_lt_u32 s51, 4
    s_cselect_b32 s35, s35, s51
    s_lshl_b32 s28, s50, 2
    s_add_u32 s28, s28, s22
    s_mul_i32 s28, s28, 150528
    s_add_u32 s28, s28, 7702528
    s_cmp_ge_u32 s51, 7
    s_cselect_b32 s28, 2147483648, s28
    s_mul_i32 s29, s22, 7
    s_cmp_eq_u32 s51, 6
    s_cselect_b64 vcc, -1, 0
    v_cndmask_b32 v75, v72, v74, vcc
    s_add_u32 s26, s29, 0
    s_lshr_b32 s3, s26, 1
    s_lshl_b32 s3, s3, 6
    s_and_b32 s26, s26, 1
    s_lshl_b32 s26, s26, 3
    s_add_u32 s26, s26, s3
    s_add_u32 s26, s26, 28672
    v_add_u32 v73, s26, v75
    ds_read_b64_tr_b16 v[108:109], v73
    ds_read_b64_tr_b16 v[110:111], v73 offset:14336
    s_add_u32 s26, s29, 1
    s_lshr_b32 s3, s26, 1
    s_lshl_b32 s3, s3, 6
    s_and_b32 s26, s26, 1
    s_lshl_b32 s26, s26, 3
    s_add_u32 s26, s26, s3
    s_add_u32 s26, s26, 28672
    v_add_u32 v73, s26, v75
    ds_read_b64_tr_b16 v[112:113], v73
    ds_read_b64_tr_b16 v[114:115], v73 offset:14336
    s_add_u32 s26, s29, 2
    s_lshr_b32 s3, s26, 1
    s_lshl_b32 s3, s3, 6
    s_and_b32 s26, s26, 1
    s_lshl_b32 s26, s26, 3
    s_add_u32 s26, s26, s3
    s_add_u32 s26, s26, 28672
    v_add_u32 v73, s26, v75
    ds_read_b64_tr_b16 v[116:117], v73
    ds_read_b64_tr_b16 v[118:119], v73 offset:14336
    s_add_u32 s26, s29, 3
    s_lshr_b32 s3, s26, 1
    s_lshl_b32 s3, s3, 6
    s_and_b32 s26, s26, 1
    s_lshl_b32 s26, s26, 3
    s_add_u32 s26, s26, s3
    s_add_u32 s26, s26, 28672
    v_add_u32 v73, s26, v75
    ds_read_b64_tr_b16 v[120:121], v73
    ds_read_b64_tr_b16 v[122:123], v73 offset:14336
    s_add_u32 s26, s29, 4
    s_lshr_b32 s3, s26, 1
    s_lshl_b32 s3, s3, 6
    s_and_b32 s26, s26, 1
    s_lshl_b32 s26, s26, 3
    s_add_u32 s26, s26, s3
    s_add_u32 s26, s26, 28672
    v_add_u32 v73, s26, v75
    ds_read_b64_tr_b16 v[124:125], v73
    ds_read_b64_tr_b16 v[126:127], v73 offset:14336
    s_add_u32 s26, s29, 5
    s_lshr_b32 s3, s26, 1
    s_lshl_b32 s3, s3, 6
    s_and_b32 s26, s26, 1
    s_lshl_b32 s26, s26, 3
    s_add_u32 s26, s26, s3
    s_add_u32 s26, s26, 28672
    v_add_u32 v73, s26, v75
    ds_read_b64_tr_b16 v[128:129], v73
    ds_read_b64_tr_b16 v[130:131], v73 offset:14336
    s_add_u32 s26, s29, 6
    s_lshr_b32 s3, s26, 1
    s_lshl_b32 s3, s3, 6
    s_and_b32 s26, s26, 1
    s_lshl_b32 s26, s26, 3
    s_add_u32 s26, s26, s3
    s_add_u32 s26, s26, 28672
    v_add_u32 v73, s26, v75
    ds_read_b64_tr_b16 v[132:133], v73
    ds_read_b64_tr_b16 v[134:135], v73 offset:14336
    s_mul_i32 s26, s35, 3072
    s_add_u32 s26, s26, 4096
    s_cmp_eq_u32 s35, 0
    s_cselect_b32 s26, 0, s26
    s_add_u32 s26, s26, s28
    s_waitcnt lgkmcnt(12)
    buffer_store_dwordx4 v[108:111], v1, s[8:11], s26 offen sc1
    s_mul_i32 s26, s35, 3072
    s_add_u32 s26, s26, 5120
    s_cmp_eq_u32 s35, 0
    s_cselect_b32 s26, 1024, s26
    s_add_u32 s26, s26, s28
    s_waitcnt lgkmcnt(10)
    buffer_store_dwordx4 v[112:115], v1, s[8:11], s26 offen sc1
    s_mul_i32 s26, s35, 3072
    s_add_u32 s26, s26, 6144
    s_cmp_eq_u32 s35, 0
    s_cselect_b32 s26, 2048, s26
    s_add_u32 s26, s26, s28
    s_waitcnt lgkmcnt(8)
    buffer_store_dwordx4 v[116:119], v1, s[8:11], s26 offen sc1
    s_mul_i32 s26, s35, 2048
    s_add_u32 s26, s26, 23552
    s_cmp_eq_u32 s35, 0
    s_cselect_b32 s26, 3072, s26
    s_add_u32 s26, s26, s28
    s_waitcnt lgkmcnt(6)
    buffer_store_dwordx4 v[120:123], v1, s[8:11], s26 offen sc1
    s_mul_i32 s26, s35, 2048
    s_add_u32 s26, s26, 24576
    s_cmp_eq_u32 s35, 0
    s_cselect_b32 s26, 4096, s26
    s_add_u32 s26, s26, s28
    s_waitcnt lgkmcnt(4)
    buffer_store_dwordx4 v[124:127], v1, s[8:11], s26 offen sc1
    s_mul_i32 s26, s35, 2048
    s_add_u32 s26, s26, 35840
    s_cmp_eq_u32 s35, 0
    s_cselect_b32 s26, 5120, s26
    s_add_u32 s26, s26, s28
    s_waitcnt lgkmcnt(2)
    buffer_store_dwordx4 v[128:131], v1, s[8:11], s26 offen sc1
    s_mul_i32 s26, s35, 2048
    s_add_u32 s26, s26, 36864
    s_cmp_eq_u32 s35, 0
    s_cselect_b32 s26, 6144, s26
    s_add_u32 s26, s26, s28
    s_waitcnt lgkmcnt(0)
    buffer_store_dwordx4 v[132:135], v1, s[8:11], s26 offen sc1
    v_mov_b32 v223, 2147483648
    s_lshl_b32 s26, s38, 14
    s_lshl_b32 s3, s39, 9
    s_add_u32 s26, s26, s3
    s_lshl_b32 s3, s22, 7
    s_add_u32 s26, s26, s3
    s_add_u32 s26, s26, 72704
    s_cmp_ge_u32 s39, 7
    s_cselect_b32 s26, 2147483648, s26
    v_writelane_b32 v223, s26, 0
    s_lshl_b32 s26, s50, 14
    s_lshl_b32 s3, s51, 9
    s_add_u32 s26, s26, s3
    s_lshl_b32 s3, s22, 7
    s_add_u32 s26, s26, s3
    s_add_u32 s26, s26, 72704
    s_cmp_ge_u32 s51, 7
    s_cselect_b32 s26, 2147483648, s26
    v_writelane_b32 v223, s26, 1
    s_waitcnt vmcnt(0)
    s_mov_b64 exec, 3
    buffer_store_dword v43, v223, s[8:11], 0 offen sc1
    s_mov_b64 exec, -1
    s_lshl_b32 s26, s21, 2
    s_add_u32 s26, s26, s22
    s_mul_i32 s26, s26, 150528
    v_add_u32 v13, s26, v1
    v_add_u32 v219, 4096, v13
    s_mov_b32 s60, 7602176
    s_mov_b32 s61, 7609344
    s_mov_b32 s62, 7616512
    s_mov_b32 s63, 7623680
    s_mov_b32 s64, 7630848
    s_mov_b32 s65, 7638016
    s_mov_b32 s66, 7645184
    s_mov_b32 s67, 7652352
    s_mov_b32 s68, 7659520
    s_mov_b32 s69, 7666688
    s_mov_b32 s70, 7673856
    s_mov_b32 s71, 7681024
    s_mov_b32 s72, 7688192
    s_mov_b32 s73, 7695360
    s_lshl_b32 s19, s21, 14
    s_add_u32 s19, s19, 65536
    v_min_u32 v212, 55, v0
    v_lshl_add_u32 v212, v212, 7, s19
    buffer_load_dword v211, v212, s[8:11], 0 offen sc1
    s_waitcnt vmcnt(0)
    v_and_b32 v211, -16, v211
    v_cmp_ne_u32 vcc, s42, v211
    s_cbranch_vccz L_waS_ok
    s_mov_b32 s34, 0
L_waS_2:
    buffer_load_dword v42, v212, s[8:11], 0 offen sc1
    s_waitcnt vmcnt(0)
    v_and_b32 v46, -16, v42
    v_cmp_ne_u32 vcc, s42, v46
    s_cbranch_vccz L_waS_2_x
    s_add_u32 s34, s34, 1
    s_cmp_lt_u32 s34, 1048576
    s_cbranch_scc1 L_waS_2
L_waS_2_x:
    s_waitcnt vmcnt(0)
L_waS_ok:
L_join:
    s_lshl_b32 s26, s22, 11
    s_add_u32 s26, s26, 155136
    v_add_u32 v49, s26, v1
    v_lshrrev_b32 v48, 2, v1
    v_and_b32 v48, 0xf0, v48
    v_and_b32 v50, 48, v1
    v_lshl_add_u32 v48, v50, 4, v48
    v_add_u32 v48, s26, v48
    ds_write_b128 v49, v[32:35] offset:0
    ds_write_b128 v49, v[36:39] offset:1024
    buffer_load_dwordx4 a[0:3], v13, s[8:11], s60 offen offset:0
    ds_read_b128 v[32:35], v48 offset:0
    ds_read_b128 v[36:39], v48 offset:1024
    s_waitcnt lgkmcnt(0)
    v_lshlrev_b32 v16, 16, v32
    v_and_b32 v17, 0xffff0000, v32
    v_lshlrev_b32 v18, 16, v33
    v_and_b32 v19, 0xffff0000, v33
    v_lshlrev_b32 v20, 16, v34
    v_and_b32 v21, 0xffff0000, v34
    v_lshlrev_b32 v22, 16, v35
    v_and_b32 v23, 0xffff0000, v35
    v_lshlrev_b32 v24, 16, v36
    v_and_b32 v25, 0xffff0000, v36
    v_lshlrev_b32 v26, 16, v37
    v_and_b32 v27, 0xffff0000, v37
    v_lshlrev_b32 v28, 16, v38
    v_and_b32 v29, 0xffff0000, v38
    v_lshlrev_b32 v30, 16, v39
    v_and_b32 v31, 0xffff0000, v39
    v_pk_add_f32 v[56:57], v[16:17], v[18:19]
    v_pk_mul_f32 v[58:59], v[16:17], v[16:17]
    v_pk_add_f32 v[56:57], v[56:57], v[20:21]
    buffer_load_dwordx4 v[160:163], v13, s[8:11], s60 offen offset:2048
    v_pk_fma_f32 v[58:59], v[18:19], v[18:19], v[58:59]
    v_pk_add_f32 v[56:57], v[56:57], v[22:23]
    v_pk_fma_f32 v[58:59], v[20:21], v[20:21], v[58:59]
    v_add_f32 v56, v56, v57
    v_pk_fma_f32 v[58:59], v[22:23], v[22:23], v[58:59]
    v_pk_add_f32 v[60:61], v[24:25], v[26:27]
    v_pk_mul_f32 v[62:63], v[24:25], v[24:25]
    v_pk_add_f32 v[60:61], v[60:61], v[28:29]
    v_pk_fma_f32 v[62:63], v[26:27], v[26:27], v[62:63]
    v_pk_add_f32 v[60:61], v[60:61], v[30:31]
    v_pk_fma_f32 v[62:63], v[28:29], v[28:29], v[62:63]
    v_add_f32 v60, v60, v61
    v_pk_fma_f32 v[62:63], v[30:31], v[30:31], v[62:63]
    v_add_f32 v58, v58, v59
    v_add_f32 v62, v62, v63
    v_permlane32_swap_b32 v56, v60
    s_nop 0
    v_permlane32_swap_b32 v58, v62
    v_add_f32 v56, v56, v60
    v_add_f32 v58, v58, v62
    s_nop 1
    v_permlane16_swap_b32 v56, v58
    v_add_f32 v56, v56, v58
    buffer_load_dwordx4 v[164:167], v13, s[8:11], s60 offen offset:3072
    s_nop 0
    v_add_f32_dpp v56, v56, v56 row_ror:4 row_mask:0xf bank_mask:0xf
    s_nop 1
    v_add_f32_dpp v56, v56, v56 row_ror:8 row_mask:0xf bank_mask:0xf
    ds_write_b32 v40, v56 offset:0
    s_waitcnt lgkmcnt(0)
    s_barrier
    ds_read_b128 v[56:59], v41 offset:0
    ds_read_b128 v[60:63], v41 offset:16
    ds_read_b128 v[64:67], v41 offset:32
    ds_read_b128 v[68:71], v41 offset:48
    s_waitcnt lgkmcnt(2)
    v_pk_add_f32 v[56:57], v[56:57], v[58:59]
    v_pk_add_f32 v[60:61], v[60:61], v[62:63]
    v_add_f32 v56, v56, v57
    v_add_f32 v60, v60, v61
    s_waitcnt lgkmcnt(0)
    v_pk_add_f32 v[64:65], v[64:65], v[66:67]
    v_pk_add_f32 v[68:69], v[68:69], v[70:71]
    v_add_f32 v64, v64, v65
    v_add_f32 v68, v68, v69
    v_mul_f32 v56, s36, v56
    v_fma_f32 v60, v60, s36, v44
    v_mul_f32 v64, s36, v64
    v_fma_f32 v68, v68, s36, v44
    buffer_load_dwordx4 v[168:171], v219, s[8:11], s60 offen offset:0
    v_fma_f32 v60, -v56, v56, v60
    v_fma_f32 v68, -v64, v64, v68
    v_max_f32 v60, v60, v44
    v_max_f32 v68, v68, v44
    v_rsq_f32 v48, v60
    v_rsq_f32 v52, v68
    v_mul_f32_e64 v50, -v56, v48
    v_mul_f32_e64 v54, -v64, v52
    v_pk_fma_f32 v[128:129], v[16:17], v[48:49], v[50:51] op_sel_hi:[1,0,0]
    v_pk_fma_f32 v[130:131], v[18:19], v[48:49], v[50:51] op_sel_hi:[1,0,0]
    v_pk_fma_f32 v[132:133], v[20:21], v[48:49], v[50:51] op_sel_hi:[1,0,0]
    v_pk_fma_f32 v[134:135], v[22:23], v[48:49], v[50:51] op_sel_hi:[1,0,0]
    v_pk_fma_f32 v[136:137], v[24:25], v[52:53], v[54:55] op_sel_hi:[1,0,0]
    v_pk_fma_f32 v[138:139], v[26:27], v[52:53], v[54:55] op_sel_hi:[1,0,0]
    v_pk_fma_f32 v[140:141], v[28:29], v[52:53], v[54:55] op_sel_hi:[1,0,0]
    v_pk_fma_f32 v[142:143], v[30:31], v[52:53], v[54:55] op_sel_hi:[1,0,0]
    s_mov_b32 s52, s54
    s_mov_b32 s53, s55
    s_mov_b32 s54, 1835008
    s_mov_b32 s55, 0x20000
    s_lshl_b32 s26, s21, 4
    buffer_load_dwordx4 v[172:175], v219, s[8:11], s60 offen offset:1024
    s_lshl_b32 s3, s22, 2
    s_add_u32 s26, s26, s3
    s_lshl_b32 s3, s20, 8
    s_add_u32 s26, s26, s3
    v_mov_b32 v14, s26
    v_lshl_add_u32 v15, v0, 2, s3
    v_lshrrev_b32 v96, 4, v0
    v_bfe_u32 v97, v0, 2, 2
    v_and_b32 v98, 3, v0
    s_lshl_b32 s26, s22, 2
    v_add_u32 v99, s26, v96
    v_cmp_gt_u32 vcc, 14, v99
    v_mov_b32 v100, 2147483648
    s_mul_i32 s33, s20, 57344
    s_lshr_b32 s26, s21, 2
    s_mul_i32 s26, s26, 28672
    s_add_u32 s26, s26, s33
    s_and_b32 s3, s21, 3
    s_lshl_b32 s3, s3, 6
    s_add_u32 s26, s26, s3
    v_lshlrev_b32 v102, 10, v99
    s_mov_b32 s56, 3932160
    buffer_load_dwordx4 v[80:83], v216, s[8:11], s56 offen offset:0 sc1
    buffer_load_dwordx4 v[84:87], v216, s[8:11], s56 offen offset:256 sc1
    buffer_load_dwordx4 v[88:91], v216, s[8:11], s56 offen offset:512 sc1
    buffer_load_dwordx4 v[92:95], v216, s[8:11], s56 offen offset:768 sc1
    buffer_load_dwordx4 v[176:179], v219, s[8:11], s60 offen offset:2048
    v_lshl_add_u32 v102, v97, 8, v102
    v_lshl_add_u32 v102, v98, 4, v102
    v_add_u32 v102, s26, v102
    v_cndmask_b32 v11, v100, v102, vcc
    v_add_u32 v45, s33, v1
    s_mul_i32 s33, s20, 458752
    s_mul_i32 s26, s21, 57344
    s_add_u32 s26, s26, s33
    v_and_b32 v102, 15, v0
    v_lshlrev_b32 v102, 4, v102
    v_lshl_add_u32 v102, v99, 9, v102
    v_add_u32 v102, s26, v102
    v_cndmask_b32 v10, v100, v102, vcc
    s_mul_i32 s3, s22, 12544
    s_add_u32 s26, s26, s3
    v_lshl_add_u32 v217, v0, 7, s26
    s_mul_i32 s3, s22, 1792
    s_add_u32 s26, s33, s3
    v_mul_u32_u24 v102, 57344, v97
    v_lshl_add_u32 v102, v96, 6, v102
    v_lshl_add_u32 v102, v98, 4, v102
    buffer_load_dwordx4 a[4:7], v13, s[8:11], s61 offen offset:0
    v_add_u32 v102, s26, v102
    s_add_u32 s3, s21, 7
    v_sub_u32 v101, s3, v97
    v_and_b32 v101, 7, v101
    s_movk_i32 s3, 7168
    v_mad_u32_u24 v9, v101, s3, v102
    v_cmp_eq_u32 vcc, 7, v101
    s_nop 1
    v_cndmask_b32 v9, v9, v100, vcc
    s_mov_b64 s[44:45], vcc
    v_xor_b32 v101, 4, v101
    v_mad_u32_u24 v218, v101, s3, v102
    v_cmp_eq_u32 vcc, 7, v101
    s_nop 1
    v_cndmask_b32 v218, v218, v100, vcc
    s_mov_b64 s[46:47], vcc
    v_mov_b32 v107, 0
    v_mov_b32 v104, 0
    v_mov_b32 v105, 0
    v_mov_b32 v106, 0
    v_add_u32 v102, 154112, v1
    ds_write_b128 v102, v[104:107]
    v_add_u32 v2, 57344, v1
    buffer_load_dwordx4 v[180:183], v13, s[8:11], s61 offen offset:2048
    s_xor_b32 s26, s22, 1
    s_lshl_b32 s26, s26, 10
    v_add_u32 v3, s26, v2
    s_xor_b32 s26, s22, 2
    s_lshl_b32 s26, s26, 10
    v_add_u32 v4, s26, v2
    s_xor_b32 s26, s22, 3
    s_lshl_b32 s26, s26, 10
    v_add_u32 v5, s26, v2
    s_lshl_b32 s26, s22, 10
    v_add_u32 v6, s26, v2
    s_lshr_b32 s26, s22, 1
    s_lshl_b32 s26, s26, 10
    s_and_b32 s3, s22, 1
    s_lshl_b32 s3, s3, 3
    s_add_u32 s26, s26, s3
    s_add_u32 s26, s26, 4096
    v_add_u32 v7, s26, v2
    s_lshl_b32 s26, s22, 2
    s_add_u32 s26, s26, 6144
    v_add_u32 v8, s26, v2
    s_mov_b32 s40, 0x3f80
    s_mov_b32 s41, 0x3f800000
    s_getpc_b64 s[4:5]
L_pc2:
    s_sub_u32 s4, s4, L_pc2-interleave_layers__ssm_conv_h3__glu_gated_bilinear__prompt_kernel
    s_subb_u32 s5, s5, 0
    s_mov_b32 s6, L_code_end-interleave_layers__ssm_conv_h3__glu_gated_bilinear__prompt_kernel
    s_lshl_b32 s50, s25, 2
    s_add_u32 s50, s50, s22
    s_lshl_b32 s50, s50, 7
    s_mul_i32 s57, s22, 14336
    s_add_u32 s57, s57, 84992
    s_add_u32 m0, s57, 0
    s_nop 0
    buffer_load_dwordx4 v13, s[8:11], s60 offen offset:1024 lds
    s_add_u32 m0, s57, 1024
    s_nop 0
    buffer_load_dwordx4 v13, s[8:11], s61 offen offset:1024 lds
    buffer_load_dwordx4 v[184:187], v13, s[8:11], s61 offen offset:3072
    buffer_load_dwordx4 v[188:191], v219, s[8:11], s61 offen offset:0
    buffer_load_dwordx4 v[192:195], v219, s[8:11], s61 offen offset:1024
    buffer_load_dwordx4 v[196:199], v219, s[8:11], s61 offen offset:2048
    s_waitcnt vmcnt(9)
    v_xor_b32 v42, s42, v81
    v_xor_b32 v46, s42, v83
    v_bitop3_b32 v42, v85, s42, v42 bitop3:0xbe
    v_bitop3_b32 v46, v87, s42, v46 bitop3:0xbe
    v_bitop3_b32 v42, v89, s42, v42 bitop3:0xbe
    v_bitop3_b32 v46, v91, s42, v46 bitop3:0xbe
    v_bitop3_b32 v42, v93, s42, v42 bitop3:0xbe
    v_bitop3_b32 v46, v95, s42, v46 bitop3:0xbe
    v_or_b32 v42, v42, v46
    v_cmp_ne_u32 vcc, 0, v42
    s_nop 0
    s_and_b64 vcc, vcc, s[16:17]
    s_cbranch_scc0 L_py_x
    s_mov_b32 s34, 0
L_py:
    s_mov_b32 s56, 3932160
    buffer_load_dwordx4 v[80:83], v216, s[8:11], s56 offen offset:0 sc1
    buffer_load_dwordx4 v[84:87], v216, s[8:11], s56 offen offset:256 sc1
    buffer_load_dwordx4 v[88:91], v216, s[8:11], s56 offen offset:512 sc1
    buffer_load_dwordx4 v[92:95], v216, s[8:11], s56 offen offset:768 sc1
    s_add_u32 s34, s34, 1
    s_cmp_gt_u32 s34, 1048576
    s_cbranch_scc1 L_py_t
    s_waitcnt vmcnt(0)
    v_xor_b32 v42, s42, v81
    v_xor_b32 v46, s42, v83
    v_bitop3_b32 v42, v85, s42, v42 bitop3:0xbe
    v_bitop3_b32 v46, v87, s42, v46 bitop3:0xbe
    v_bitop3_b32 v42, v89, s42, v42 bitop3:0xbe
    v_bitop3_b32 v46, v91, s42, v46 bitop3:0xbe
    v_bitop3_b32 v42, v93, s42, v42 bitop3:0xbe
    v_bitop3_b32 v46, v95, s42, v46 bitop3:0xbe
    v_or_b32 v42, v42, v46
    v_cmp_ne_u32 vcc, 0, v42
    s_nop 0
    s_and_b64 vcc, vcc, s[16:17]
    s_cbranch_scc1 L_py
L_py_t:
    s_waitcnt vmcnt(0)
L_py_x:
    v_lshlrev_b32 v112, 16, v80
    v_and_b32 v120, 0xffff0000, v80
    v_lshlrev_b32 v113, 16, v82
    v_and_b32 v121, 0xffff0000, v82
    v_lshlrev_b32 v114, 16, v84
    v_and_b32 v122, 0xffff0000, v84
    v_lshlrev_b32 v115, 16, v86
    v_and_b32 v123, 0xffff0000, v86
    v_lshlrev_b32 v116, 16, v88
    v_and_b32 v124, 0xffff0000, v88
    v_lshlrev_b32 v117, 16, v90
    v_and_b32 v125, 0xffff0000, v90
    v_lshlrev_b32 v118, 16, v92
    v_and_b32 v126, 0xffff0000, v92
    v_lshlrev_b32 v119, 16, v94
    v_and_b32 v127, 0xffff0000, v94
    buffer_load_dwordx4 a[8:11], v13, s[8:11], s62 offen offset:0
    s_add_u32 m0, s57, 2048
    s_nop 0
    buffer_load_dwordx4 v13, s[8:11], s62 offen offset:1024 lds
    buffer_load_dwordx4 v[200:203], v13, s[8:11], s62 offen offset:2048
    buffer_load_dwordx4 v[204:207], v13, s[8:11], s62 offen offset:3072
    buffer_load_dwordx4 v[208:211], v219, s[8:11], s62 offen offset:0
    buffer_load_dwordx4 v[212:215], v219, s[8:11], s62 offen offset:1024
    v_pk_fma_f32 v[16:17], v[128:129], v[112:113], v[16:17]
    v_pk_fma_f32 v[18:19], v[130:131], v[114:115], v[18:19]
    v_pk_fma_f32 v[20:21], v[132:133], v[116:117], v[20:21]
    v_pk_fma_f32 v[22:23], v[134:135], v[118:119], v[22:23]
    v_pk_fma_f32 v[24:25], v[136:137], v[120:121], v[24:25]
    v_pk_fma_f32 v[26:27], v[138:139], v[122:123], v[26:27]
    v_pk_fma_f32 v[28:29], v[140:141], v[124:125], v[28:29]
    v_pk_fma_f32 v[30:31], v[142:143], v[126:127], v[30:31]
    v_pk_add_f32 v[56:57], v[16:17], v[18:19]
    v_pk_mul_f32 v[58:59], v[16:17], v[16:17]
    v_pk_add_f32 v[56:57], v[56:57], v[20:21]
    v_pk_fma_f32 v[58:59], v[18:19], v[18:19], v[58:59]
    v_pk_add_f32 v[56:57], v[56:57], v[22:23]
    v_pk_fma_f32 v[58:59], v[20:21], v[20:21], v[58:59]
    v_add_f32 v56, v56, v57
    v_pk_fma_f32 v[58:59], v[22:23], v[22:23], v[58:59]
    v_pk_add_f32 v[60:61], v[24:25], v[26:27]
    v_pk_mul_f32 v[62:63], v[24:25], v[24:25]
    v_pk_add_f32 v[60:61], v[60:61], v[28:29]
    v_pk_fma_f32 v[62:63], v[26:27], v[26:27], v[62:63]
    v_pk_add_f32 v[60:61], v[60:61], v[30:31]
    v_pk_fma_f32 v[62:63], v[28:29], v[28:29], v[62:63]
    v_add_f32 v60, v60, v61
    v_pk_fma_f32 v[62:63], v[30:31], v[30:31], v[62:63]
    v_add_f32 v58, v58, v59
    v_add_f32 v62, v62, v63
    v_permlane32_swap_b32 v56, v60
    s_nop 0
    v_permlane32_swap_b32 v58, v62
    v_add_f32 v56, v56, v60
    v_add_f32 v58, v58, v62
    s_nop 1
    v_permlane16_swap_b32 v56, v58
    v_add_f32 v56, v56, v58
    s_nop 1
    v_add_f32_dpp v56, v56, v56 row_ror:4 row_mask:0xf bank_mask:0xf
    s_nop 1
    v_add_f32_dpp v56, v56, v56 row_ror:8 row_mask:0xf bank_mask:0xf
    ds_write_b32 v40, v56 offset:256
    s_waitcnt lgkmcnt(0)
    s_barrier
    ds_read_b128 v[56:59], v41 offset:256
    ds_read_b128 v[60:63], v41 offset:272
    ds_read_b128 v[64:67], v41 offset:288
    ds_read_b128 v[68:71], v41 offset:304
    s_waitcnt lgkmcnt(2)
    v_pk_add_f32 v[56:57], v[56:57], v[58:59]
    v_pk_add_f32 v[60:61], v[60:61], v[62:63]
    v_add_f32 v56, v56, v57
    v_add_f32 v60, v60, v61
    s_waitcnt lgkmcnt(0)
    v_pk_add_f32 v[64:65], v[64:65], v[66:67]
    v_pk_add_f32 v[68:69], v[68:69], v[70:71]
    v_add_f32 v64, v64, v65
    v_add_f32 v68, v68, v69
    v_mul_f32 v56, s36, v56
    v_fma_f32 v60, v60, s36, v44
    v_mul_f32 v64, s36, v64
    v_fma_f32 v68, v68, s36, v44
    v_fma_f32 v60, -v56, v56, v60
    v_fma_f32 v68, -v64, v64, v68
    v_max_f32 v60, v60, v44
    v_max_f32 v68, v68, v44
    v_rsq_f32 v48, v60
    v_rsq_f32 v52, v68
    v_mul_f32_e64 v50, -v56, v48
    v_mul_f32_e64 v54, -v64, v52
    v_pk_fma_f32 v[128:129], v[16:17], v[48:49], v[50:51] op_sel_hi:[1,0,0]
    v_pk_fma_f32 v[130:131], v[18:19], v[48:49], v[50:51] op_sel_hi:[1,0,0]
    v_pk_fma_f32 v[132:133], v[20:21], v[48:49], v[50:51] op_sel_hi:[1,0,0]
    v_pk_fma_f32 v[134:135], v[22:23], v[48:49], v[50:51] op_sel_hi:[1,0,0]
    v_pk_fma_f32 v[136:137], v[24:25], v[52:53], v[54:55] op_sel_hi:[1,0,0]
    v_pk_fma_f32 v[138:139], v[26:27], v[52:53], v[54:55] op_sel_hi:[1,0,0]
    v_pk_fma_f32 v[140:141], v[28:29], v[52:53], v[54:55] op_sel_hi:[1,0,0]
    v_pk_fma_f32 v[142:143], v[30:31], v[52:53], v[54:55] op_sel_hi:[1,0,0]
    v_cvt_pk_bf16_f32 v144, v128, v129
    v_cvt_pk_bf16_f32 v145, v130, v131
    v_cvt_pk_bf16_f32 v146, v132, v133
    v_cvt_pk_bf16_f32 v147, v134, v135
    s_add_u32 s33, s18, 0
    buffer_store_dwordx4 v[144:147], v11, s[8:11], s33 offen
    v_cvt_pk_bf16_f32 v148, v136, v137
    v_cvt_pk_bf16_f32 v149, v138, v139
    v_cvt_pk_bf16_f32 v150, v140, v141
    v_cvt_pk_bf16_f32 v151, v142, v143
    s_add_u32 s33, s18, 14336
    buffer_store_dwordx4 v[148:151], v11, s[8:11], s33 offen
    v_mov_b32 v32, v80
    v_mov_b32 v33, v82
    v_mov_b32 v34, v84
    v_mov_b32 v35, v86
    v_mov_b32 v36, v88
    v_mov_b32 v37, v90
    v_mov_b32 v38, v92
    v_mov_b32 v39, v94
    s_mov_b32 s33, 20480
    s_waitcnt vmcnt(0)
    s_mov_b64 exec, 1
    buffer_store_dword v43, v14, s[8:11], s33 offen offset:0
    s_mov_b64 exec, -1
    buffer_load_dwordx4 a[12:15], v13, s[8:11], s63 offen offset:0
    s_add_u32 m0, s57, 3072
    s_nop 0
    buffer_load_dwordx4 v13, s[8:11], s63 offen offset:1024 lds
    buffer_load_dwordx4 a[16:19], v13, s[8:11], s64 offen offset:0
    s_add_u32 m0, s57, 4096
    s_nop 0
    buffer_load_dwordx4 v13, s[8:11], s64 offen offset:1024 lds
    s_mov_b32 s34, 0
    s_mov_b32 s35, s18
    s_mov_b32 s37, 0
L_px:
    s_mov_b32 s33, 20480
    buffer_load_dword v42, v15, s[8:11], s33 offen sc1
    s_waitcnt vmcnt(0)
    v_cmp_eq_u32 vcc, s23, v42
    v_and_b32 v42, -16, v42
    v_cmp_eq_u32 s[28:29], s42, v42
    s_cmp_eq_u32 vcc_lo, -1
    s_cbranch_scc1 L_px_x
    s_add_u32 s34, s34, 1
    s_cmp_eq_u32 s34, 24
    s_cbranch_scc0 L_px_n
    s_mov_b32 s33, 14286848
    buffer_store_dwordx4 v[144:147], v11, s[8:11], s33 offen sc1
    s_mov_b32 s33, 14301184
    buffer_store_dwordx4 v[148:151], v11, s[8:11], s33 offen sc1
    s_mov_b32 s33, 20480
    s_waitcnt vmcnt(0)
    s_mov_b64 exec, 1
    buffer_store_dword v43, v14, s[8:11], s33 offen offset:128 sc1
    s_mov_b64 exec, -1
L_px_n:
    s_cmp_gt_u32 s34, 1048576
    s_cbranch_scc1 L_px_x
    s_cmp_eq_u32 s29, -1
    s_cbranch_scc0 L_px
    s_mov_b32 s35, 14286848
    s_cmp_eq_u32 vcc_hi, -1
    s_cselect_b32 s37, 0, 1
L_px_x:
    s_mul_i32 s33, s22, 14336
    s_add_u32 s34, s33, s35
    s_mov_b32 m0, s33
    s_add_u32 s33, s33, 1024
    buffer_load_dwordx4 v45, s[8:11], s34 offen sc1 lds
    s_add_u32 s34, s34, 1024
    s_mov_b32 m0, s33
    s_add_u32 s33, s33, 1024
    buffer_load_dwordx4 v45, s[8:11], s34 offen sc1 lds
    s_add_u32 s34, s34, 1024
    s_mov_b32 m0, s33
    s_add_u32 s33, s33, 1024
    buffer_load_dwordx4 v45, s[8:11], s34 offen sc1 lds
    s_add_u32 s34, s34, 1024
    s_mov_b32 m0, s33
    s_add_u32 s33, s33, 1024
    buffer_load_dwordx4 v45, s[8:11], s34 offen sc1 lds
    s_add_u32 s34, s34, 1024
    s_mov_b32 m0, s33
    s_add_u32 s33, s33, 1024
    buffer_load_dwordx4 v45, s[8:11], s34 offen sc1 lds
    s_add_u32 s34, s34, 1024
    s_mov_b32 m0, s33
    s_add_u32 s33, s33, 1024
    buffer_load_dwordx4 v45, s[8:11], s34 offen sc1 lds
    s_add_u32 s34, s34, 1024
    s_mov_b32 m0, s33
    s_add_u32 s33, s33, 1024
    buffer_load_dwordx4 v45, s[8:11], s34 offen sc1 lds
    s_add_u32 s34, s34, 1024
    s_mov_b32 m0, s33
    s_add_u32 s33, s33, 1024
    buffer_load_dwordx4 v45, s[8:11], s34 offen sc1 lds
    s_add_u32 s34, s34, 1024
    s_mov_b32 m0, s33
    s_add_u32 s33, s33, 1024
    buffer_load_dwordx4 v45, s[8:11], s34 offen sc1 lds
    s_add_u32 s34, s34, 1024
    s_mov_b32 m0, s33
    s_add_u32 s33, s33, 1024
    buffer_load_dwordx4 v45, s[8:11], s34 offen sc1 lds
    s_add_u32 s34, s34, 1024
    s_mov_b32 m0, s33
    s_add_u32 s33, s33, 1024
    buffer_load_dwordx4 v45, s[8:11], s34 offen sc1 lds
    s_add_u32 s34, s34, 1024
    s_mov_b32 m0, s33
    s_add_u32 s33, s33, 1024
    buffer_load_dwordx4 v45, s[8:11], s34 offen sc1 lds
    s_add_u32 s34, s34, 1024
    s_mov_b32 m0, s33
    s_add_u32 s33, s33, 1024
    buffer_load_dwordx4 v45, s[8:11], s34 offen sc1 lds
    s_add_u32 s34, s34, 1024
    s_mov_b32 m0, s33
    s_add_u32 s33, s33, 1024
    buffer_load_dwordx4 v45, s[8:11], s34 offen sc1 lds
    s_add_u32 s34, s34, 1024
    buffer_load_dwordx4 a[20:23], v13, s[8:11], s65 offen offset:0
    s_add_u32 m0, s57, 5120
    s_nop 0
    buffer_load_dwordx4 v13, s[8:11], s65 offen offset:1024 lds
    buffer_load_dwordx4 a[24:27], v13, s[8:11], s66 offen offset:0
    s_add_u32 m0, s57, 6144
    s_nop 0
    buffer_load_dwordx4 v13, s[8:11], s66 offen offset:1024 lds
    s_lshl_b32 s26, s20, 7
    v_subrev_u32 v14, s26, v14
    v_and_b32 v15, 31, v0
    v_lshl_add_u32 v15, v15, 2, s26
    s_add_u32 s19, s19, 7168
    v_min_u32 v216, 27, v0
    v_lshl_add_u32 v216, v216, 7, s19
    s_add_u32 s26, s57, 1024
    v_add_u32 v0, s26, v1
    s_waitcnt vmcnt(15)
    s_barrier
    s_cmp_eq_u32 s37, 0
    s_cbranch_scc0 L_global
L_g10:
    s_mov_b32 s38, 18874368
    s_mov_b32 s39, 19103744
    ds_read_b128 v[224:227], v1 offset:0
    ds_read_b128 v[228:231], v1 offset:14336
    ds_read_b128 v[232:235], v1 offset:28672
    ds_read_b128 v[236:239], v1 offset:43008
    ds_read_b128 v[220:223], v0 offset:0
    s_waitcnt lgkmcnt(4)
    v_mfma_f32_16x16x32_bf16 v[48:51], a[0:3], v[224:227], 0
    s_waitcnt lgkmcnt(3)
    v_mfma_f32_16x16x32_bf16 v[76:79], a[0:3], v[228:231], 0
    s_waitcnt lgkmcnt(2)
    v_mfma_f32_16x16x32_bf16 v[104:107], a[0:3], v[232:235], 0
    s_waitcnt lgkmcnt(1)
    v_mfma_f32_16x16x32_bf16 v[132:135], a[0:3], v[236:239], 0
    ds_read_b128 v[240:243], v1 offset:1024
    s_waitcnt lgkmcnt(1)
    v_mfma_f32_16x16x32_bf16 v[52:55], v[220:223], v[224:227], 0
    v_mfma_f32_16x16x32_bf16 v[80:83], v[220:223], v[228:231], 0
    buffer_load_dwordx4 a[28:31], v13, s[8:11], s67 offen offset:0
    v_mfma_f32_16x16x32_bf16 v[108:111], v[220:223], v[232:235], 0
    v_mfma_f32_16x16x32_bf16 v[136:139], v[220:223], v[236:239], 0
    ds_read_b128 v[244:247], v1 offset:15360
    v_mfma_f32_16x16x32_bf16 v[56:59], v[160:163], v[224:227], 0
    v_mfma_f32_16x16x32_bf16 v[84:87], v[160:163], v[228:231], 0
    ds_read_b128 v[220:223], v0 offset:1024
    v_mfma_f32_16x16x32_bf16 v[112:115], v[160:163], v[232:235], 0
    v_mfma_f32_16x16x32_bf16 v[140:143], v[160:163], v[236:239], 0
    ds_read_b128 v[248:251], v1 offset:29696
    v_mfma_f32_16x16x32_bf16 v[60:63], v[164:167], v[224:227], 0
    v_mfma_f32_16x16x32_bf16 v[88:91], v[164:167], v[228:231], 0
    buffer_load_dwordx4 v[160:163], v219, s[8:11], s62 offen offset:2048
    v_mfma_f32_16x16x32_bf16 v[116:119], v[164:167], v[232:235], 0
    v_mfma_f32_16x16x32_bf16 v[144:147], v[164:167], v[236:239], 0
    ds_read_b128 v[252:255], v1 offset:44032
    v_mfma_f32_16x16x32_bf16 v[64:67], v[168:171], v[224:227], 0
    v_mfma_f32_16x16x32_bf16 v[92:95], v[168:171], v[228:231], 0
    buffer_load_dwordx4 v[164:167], v13, s[8:11], s63 offen offset:2048
    v_mfma_f32_16x16x32_bf16 v[120:123], v[168:171], v[232:235], 0
    v_mfma_f32_16x16x32_bf16 v[148:151], v[168:171], v[236:239], 0
    s_add_u32 m0, s57, 7168
    s_nop 0
    buffer_load_dwordx4 v13, s[8:11], s67 offen offset:1024 lds
    v_mfma_f32_16x16x32_bf16 v[68:71], v[172:175], v[224:227], 0
    v_mfma_f32_16x16x32_bf16 v[96:99], v[172:175], v[228:231], 0
    buffer_load_dwordx4 v[168:171], v13, s[8:11], s63 offen offset:3072
    v_mfma_f32_16x16x32_bf16 v[124:127], v[172:175], v[232:235], 0
    v_mfma_f32_16x16x32_bf16 v[152:155], v[172:175], v[236:239], 0
    v_mfma_f32_16x16x32_bf16 v[72:75], v[176:179], v[224:227], 0
    v_mfma_f32_16x16x32_bf16 v[100:103], v[176:179], v[228:231], 0
    buffer_load_dwordx4 v[172:175], v219, s[8:11], s63 offen offset:0
    v_mfma_f32_16x16x32_bf16 v[128:131], v[176:179], v[232:235], 0
    v_mfma_f32_16x16x32_bf16 v[156:159], v[176:179], v[236:239], 0
    s_waitcnt lgkmcnt(0)
    v_mfma_f32_16x16x32_bf16 v[48:51], a[4:7], v[240:243], v[48:51]
    v_mfma_f32_16x16x32_bf16 v[76:79], a[4:7], v[244:247], v[76:79]
    buffer_load_dwordx4 v[176:179], v219, s[8:11], s63 offen offset:1024
    v_mfma_f32_16x16x32_bf16 v[104:107], a[4:7], v[248:251], v[104:107]
    v_mfma_f32_16x16x32_bf16 v[132:135], a[4:7], v[252:255], v[132:135]
    ds_read_b128 v[224:227], v1 offset:2048
    v_mfma_f32_16x16x32_bf16 v[52:55], v[220:223], v[240:243], v[52:55]
    v_mfma_f32_16x16x32_bf16 v[80:83], v[220:223], v[244:247], v[80:83]
    buffer_load_dwordx4 a[32:35], v13, s[8:11], s68 offen offset:0
    v_mfma_f32_16x16x32_bf16 v[108:111], v[220:223], v[248:251], v[108:111]
    v_mfma_f32_16x16x32_bf16 v[136:139], v[220:223], v[252:255], v[136:139]
    ds_read_b128 v[228:231], v1 offset:16384
    v_mfma_f32_16x16x32_bf16 v[56:59], v[180:183], v[240:243], v[56:59]
    v_mfma_f32_16x16x32_bf16 v[84:87], v[180:183], v[244:247], v[84:87]
    ds_read_b128 v[220:223], v0 offset:2048
    v_mfma_f32_16x16x32_bf16 v[112:115], v[180:183], v[248:251], v[112:115]
    v_mfma_f32_16x16x32_bf16 v[140:143], v[180:183], v[252:255], v[140:143]
    ds_read_b128 v[232:235], v1 offset:30720
    v_mfma_f32_16x16x32_bf16 v[60:63], v[184:187], v[240:243], v[60:63]
    v_mfma_f32_16x16x32_bf16 v[88:91], v[184:187], v[244:247], v[88:91]
    buffer_load_dwordx4 v[180:183], v219, s[8:11], s63 offen offset:2048
    v_mfma_f32_16x16x32_bf16 v[116:119], v[184:187], v[248:251], v[116:119]
    v_mfma_f32_16x16x32_bf16 v[144:147], v[184:187], v[252:255], v[144:147]
    ds_read_b128 v[236:239], v1 offset:45056
    v_mfma_f32_16x16x32_bf16 v[64:67], v[188:191], v[240:243], v[64:67]
    v_mfma_f32_16x16x32_bf16 v[92:95], v[188:191], v[244:247], v[92:95]
    buffer_load_dwordx4 v[184:187], v13, s[8:11], s64 offen offset:2048
    v_mfma_f32_16x16x32_bf16 v[120:123], v[188:191], v[248:251], v[120:123]
    v_mfma_f32_16x16x32_bf16 v[148:151], v[188:191], v[252:255], v[148:151]
    s_add_u32 m0, s57, 8192
    s_nop 0
    buffer_load_dwordx4 v13, s[8:11], s68 offen offset:1024 lds
    v_mfma_f32_16x16x32_bf16 v[68:71], v[192:195], v[240:243], v[68:71]
    v_mfma_f32_16x16x32_bf16 v[96:99], v[192:195], v[244:247], v[96:99]
    buffer_load_dwordx4 v[188:191], v13, s[8:11], s64 offen offset:3072
    v_mfma_f32_16x16x32_bf16 v[124:127], v[192:195], v[248:251], v[124:127]
    v_mfma_f32_16x16x32_bf16 v[152:155], v[192:195], v[252:255], v[152:155]
    v_mfma_f32_16x16x32_bf16 v[72:75], v[196:199], v[240:243], v[72:75]
    v_mfma_f32_16x16x32_bf16 v[100:103], v[196:199], v[244:247], v[100:103]
    buffer_load_dwordx4 v[192:195], v219, s[8:11], s64 offen offset:0
    v_mfma_f32_16x16x32_bf16 v[128:131], v[196:199], v[248:251], v[128:131]
    v_mfma_f32_16x16x32_bf16 v[156:159], v[196:199], v[252:255], v[156:159]
    s_waitcnt lgkmcnt(0)
    v_mfma_f32_16x16x32_bf16 v[48:51], a[8:11], v[224:227], v[48:51]
    v_mfma_f32_16x16x32_bf16 v[76:79], a[8:11], v[228:231], v[76:79]
    buffer_load_dwordx4 v[196:199], v219, s[8:11], s64 offen offset:1024
    v_mfma_f32_16x16x32_bf16 v[104:107], a[8:11], v[232:235], v[104:107]
    s_waitcnt vmcnt(18)
    s_barrier
    v_mfma_f32_16x16x32_bf16 v[132:135], a[8:11], v[236:239], v[132:135]
    ds_read_b128 v[240:243], v1 offset:3072
    v_mfma_f32_16x16x32_bf16 v[52:55], v[220:223], v[224:227], v[52:55]
    v_mfma_f32_16x16x32_bf16 v[80:83], v[220:223], v[228:231], v[80:83]
    buffer_load_dwordx4 a[36:39], v13, s[8:11], s69 offen offset:0
    v_mfma_f32_16x16x32_bf16 v[108:111], v[220:223], v[232:235], v[108:111]
    v_mfma_f32_16x16x32_bf16 v[136:139], v[220:223], v[236:239], v[136:139]
    ds_read_b128 v[244:247], v1 offset:17408
    v_mfma_f32_16x16x32_bf16 v[56:59], v[200:203], v[224:227], v[56:59]
    v_mfma_f32_16x16x32_bf16 v[84:87], v[200:203], v[228:231], v[84:87]
    ds_read_b128 v[220:223], v0 offset:3072
    v_mfma_f32_16x16x32_bf16 v[112:115], v[200:203], v[232:235], v[112:115]
    v_mfma_f32_16x16x32_bf16 v[140:143], v[200:203], v[236:239], v[140:143]
    ds_read_b128 v[248:251], v1 offset:31744
    v_mfma_f32_16x16x32_bf16 v[60:63], v[204:207], v[224:227], v[60:63]
    v_mfma_f32_16x16x32_bf16 v[88:91], v[204:207], v[228:231], v[88:91]
    buffer_load_dwordx4 v[200:203], v219, s[8:11], s64 offen offset:2048
    v_mfma_f32_16x16x32_bf16 v[116:119], v[204:207], v[232:235], v[116:119]
    v_mfma_f32_16x16x32_bf16 v[144:147], v[204:207], v[236:239], v[144:147]
    ds_read_b128 v[252:255], v1 offset:46080
    v_mfma_f32_16x16x32_bf16 v[64:67], v[208:211], v[224:227], v[64:67]
    v_mfma_f32_16x16x32_bf16 v[92:95], v[208:211], v[228:231], v[92:95]
    buffer_load_dwordx4 v[204:207], v13, s[8:11], s65 offen offset:2048
    v_mfma_f32_16x16x32_bf16 v[120:123], v[208:211], v[232:235], v[120:123]
    v_mfma_f32_16x16x32_bf16 v[148:151], v[208:211], v[236:239], v[148:151]
    s_add_u32 m0, s57, 9216
    s_nop 0
    buffer_load_dwordx4 v13, s[8:11], s69 offen offset:1024 lds
    v_mfma_f32_16x16x32_bf16 v[68:71], v[212:215], v[224:227], v[68:71]
    v_mfma_f32_16x16x32_bf16 v[96:99], v[212:215], v[228:231], v[96:99]
    buffer_load_dwordx4 v[208:211], v13, s[8:11], s65 offen offset:3072
    v_mfma_f32_16x16x32_bf16 v[124:127], v[212:215], v[232:235], v[124:127]
    v_mfma_f32_16x16x32_bf16 v[152:155], v[212:215], v[236:239], v[152:155]
    s_waitcnt vmcnt(17)
    v_mfma_f32_16x16x32_bf16 v[72:75], v[160:163], v[224:227], v[72:75]
    v_mfma_f32_16x16x32_bf16 v[100:103], v[160:163], v[228:231], v[100:103]
    buffer_load_dwordx4 v[212:215], v219, s[8:11], s65 offen offset:0
    v_mfma_f32_16x16x32_bf16 v[128:131], v[160:163], v[232:235], v[128:131]
    v_mfma_f32_16x16x32_bf16 v[156:159], v[160:163], v[236:239], v[156:159]
    s_waitcnt lgkmcnt(0)
    v_mfma_f32_16x16x32_bf16 v[48:51], a[12:15], v[240:243], v[48:51]
    v_mfma_f32_16x16x32_bf16 v[76:79], a[12:15], v[244:247], v[76:79]
    buffer_load_dwordx4 v[160:163], v219, s[8:11], s65 offen offset:1024
    v_mfma_f32_16x16x32_bf16 v[104:107], a[12:15], v[248:251], v[104:107]
    v_mfma_f32_16x16x32_bf16 v[132:135], a[12:15], v[252:255], v[132:135]
    ds_read_b128 v[224:227], v1 offset:4096
    v_mfma_f32_16x16x32_bf16 v[52:55], v[220:223], v[240:243], v[52:55]
    v_mfma_f32_16x16x32_bf16 v[80:83], v[220:223], v[244:247], v[80:83]
    buffer_load_dwordx4 a[40:43], v13, s[8:11], s70 offen offset:0
    v_mfma_f32_16x16x32_bf16 v[108:111], v[220:223], v[248:251], v[108:111]
    v_mfma_f32_16x16x32_bf16 v[136:139], v[220:223], v[252:255], v[136:139]
    ds_read_b128 v[228:231], v1 offset:18432
    s_waitcnt vmcnt(17)
    v_mfma_f32_16x16x32_bf16 v[56:59], v[164:167], v[240:243], v[56:59]
    v_mfma_f32_16x16x32_bf16 v[84:87], v[164:167], v[244:247], v[84:87]
    ds_read_b128 v[220:223], v0 offset:4096
    v_mfma_f32_16x16x32_bf16 v[112:115], v[164:167], v[248:251], v[112:115]
    v_mfma_f32_16x16x32_bf16 v[140:143], v[164:167], v[252:255], v[140:143]
    ds_read_b128 v[232:235], v1 offset:32768
    v_mfma_f32_16x16x32_bf16 v[60:63], v[168:171], v[240:243], v[60:63]
    v_mfma_f32_16x16x32_bf16 v[88:91], v[168:171], v[244:247], v[88:91]
    buffer_load_dwordx4 v[164:167], v219, s[8:11], s65 offen offset:2048
    v_mfma_f32_16x16x32_bf16 v[116:119], v[168:171], v[248:251], v[116:119]
    buffer_load_dword v47, v216, s[8:11], 0 offen sc1
    v_mfma_f32_16x16x32_bf16 v[144:147], v[168:171], v[252:255], v[144:147]
    ds_read_b128 v[236:239], v1 offset:47104
    s_waitcnt vmcnt(17)
    v_mfma_f32_16x16x32_bf16 v[64:67], v[172:175], v[240:243], v[64:67]
    v_mfma_f32_16x16x32_bf16 v[92:95], v[172:175], v[244:247], v[92:95]
    buffer_load_dwordx4 v[168:171], v13, s[8:11], s66 offen offset:2048
    v_mfma_f32_16x16x32_bf16 v[120:123], v[172:175], v[248:251], v[120:123]
    v_mfma_f32_16x16x32_bf16 v[148:151], v[172:175], v[252:255], v[148:151]
    s_add_u32 m0, s57, 10240
    s_nop 0
    buffer_load_dwordx4 v13, s[8:11], s70 offen offset:1024 lds
    v_mfma_f32_16x16x32_bf16 v[68:71], v[176:179], v[240:243], v[68:71]
    v_mfma_f32_16x16x32_bf16 v[96:99], v[176:179], v[244:247], v[96:99]
    buffer_load_dwordx4 v[172:175], v13, s[8:11], s66 offen offset:3072
    v_mfma_f32_16x16x32_bf16 v[124:127], v[176:179], v[248:251], v[124:127]
    v_mfma_f32_16x16x32_bf16 v[152:155], v[176:179], v[252:255], v[152:155]
    s_waitcnt vmcnt(18)
    v_mfma_f32_16x16x32_bf16 v[72:75], v[180:183], v[240:243], v[72:75]
    v_mfma_f32_16x16x32_bf16 v[100:103], v[180:183], v[244:247], v[100:103]
    buffer_load_dwordx4 v[176:179], v219, s[8:11], s66 offen offset:0
    v_mfma_f32_16x16x32_bf16 v[128:131], v[180:183], v[248:251], v[128:131]
    v_mfma_f32_16x16x32_bf16 v[156:159], v[180:183], v[252:255], v[156:159]
    s_waitcnt lgkmcnt(0)
    v_mfma_f32_16x16x32_bf16 v[48:51], a[16:19], v[224:227], v[48:51]
    v_mfma_f32_16x16x32_bf16 v[76:79], a[16:19], v[228:231], v[76:79]
    buffer_load_dwordx4 v[180:183], v219, s[8:11], s66 offen offset:1024
    v_mfma_f32_16x16x32_bf16 v[104:107], a[16:19], v[232:235], v[104:107]
    v_mfma_f32_16x16x32_bf16 v[132:135], a[16:19], v[236:239], v[132:135]
    ds_read_b128 v[240:243], v1 offset:5120
    v_mfma_f32_16x16x32_bf16 v[52:55], v[220:223], v[224:227], v[52:55]
    v_mfma_f32_16x16x32_bf16 v[80:83], v[220:223], v[228:231], v[80:83]
    buffer_load_dwordx4 a[44:47], v13, s[8:11], s71 offen offset:0
    v_mfma_f32_16x16x32_bf16 v[108:111], v[220:223], v[232:235], v[108:111]
    v_mfma_f32_16x16x32_bf16 v[136:139], v[220:223], v[236:239], v[136:139]
    ds_read_b128 v[244:247], v1 offset:19456
    s_waitcnt vmcnt(18)
    v_mfma_f32_16x16x32_bf16 v[56:59], v[184:187], v[224:227], v[56:59]
    v_mfma_f32_16x16x32_bf16 v[84:87], v[184:187], v[228:231], v[84:87]
    ds_read_b128 v[220:223], v0 offset:5120
    v_mfma_f32_16x16x32_bf16 v[112:115], v[184:187], v[232:235], v[112:115]
    v_mfma_f32_16x16x32_bf16 v[140:143], v[184:187], v[236:239], v[140:143]
    ds_read_b128 v[248:251], v1 offset:33792
    v_mfma_f32_16x16x32_bf16 v[60:63], v[188:191], v[224:227], v[60:63]
    v_mfma_f32_16x16x32_bf16 v[88:91], v[188:191], v[228:231], v[88:91]
    buffer_load_dwordx4 v[184:187], v219, s[8:11], s66 offen offset:2048
    v_mfma_f32_16x16x32_bf16 v[116:119], v[188:191], v[232:235], v[116:119]
    v_mfma_f32_16x16x32_bf16 v[144:147], v[188:191], v[236:239], v[144:147]
    ds_read_b128 v[252:255], v1 offset:48128
    s_waitcnt vmcnt(17)
    v_mfma_f32_16x16x32_bf16 v[64:67], v[192:195], v[224:227], v[64:67]
    v_mfma_f32_16x16x32_bf16 v[92:95], v[192:195], v[228:231], v[92:95]
    buffer_load_dwordx4 v[188:191], v13, s[8:11], s67 offen offset:2048
    v_mfma_f32_16x16x32_bf16 v[120:123], v[192:195], v[232:235], v[120:123]
    v_mfma_f32_16x16x32_bf16 v[148:151], v[192:195], v[236:239], v[148:151]
    s_add_u32 m0, s57, 11264
    s_nop 0
    buffer_load_dwordx4 v13, s[8:11], s71 offen offset:1024 lds
    v_mfma_f32_16x16x32_bf16 v[68:71], v[196:199], v[224:227], v[68:71]
    v_mfma_f32_16x16x32_bf16 v[96:99], v[196:199], v[228:231], v[96:99]
    buffer_load_dwordx4 v[192:195], v13, s[8:11], s67 offen offset:3072
    v_mfma_f32_16x16x32_bf16 v[124:127], v[196:199], v[232:235], v[124:127]
    v_mfma_f32_16x16x32_bf16 v[152:155], v[196:199], v[236:239], v[152:155]
    s_waitcnt vmcnt(18)
    v_mfma_f32_16x16x32_bf16 v[72:75], v[200:203], v[224:227], v[72:75]
    v_mfma_f32_16x16x32_bf16 v[100:103], v[200:203], v[228:231], v[100:103]
    buffer_load_dwordx4 v[196:199], v219, s[8:11], s67 offen offset:0
    v_mfma_f32_16x16x32_bf16 v[128:131], v[200:203], v[232:235], v[128:131]
    v_mfma_f32_16x16x32_bf16 v[156:159], v[200:203], v[236:239], v[156:159]
    s_waitcnt lgkmcnt(0)
    v_mfma_f32_16x16x32_bf16 v[48:51], a[20:23], v[240:243], v[48:51]
    v_mfma_f32_16x16x32_bf16 v[76:79], a[20:23], v[244:247], v[76:79]
    buffer_load_dwordx4 v[200:203], v219, s[8:11], s67 offen offset:1024
    v_mfma_f32_16x16x32_bf16 v[104:107], a[20:23], v[248:251], v[104:107]
    v_mfma_f32_16x16x32_bf16 v[132:135], a[20:23], v[252:255], v[132:135]
    ds_read_b128 v[224:227], v1 offset:6144
    v_mfma_f32_16x16x32_bf16 v[52:55], v[220:223], v[240:243], v[52:55]
    v_mfma_f32_16x16x32_bf16 v[80:83], v[220:223], v[244:247], v[80:83]
    buffer_load_dwordx4 a[48:51], v13, s[8:11], s72 offen offset:0
    v_mfma_f32_16x16x32_bf16 v[108:111], v[220:223], v[248:251], v[108:111]
    v_mfma_f32_16x16x32_bf16 v[136:139], v[220:223], v[252:255], v[136:139]
    ds_read_b128 v[228:231], v1 offset:20480
    s_waitcnt vmcnt(18)
    v_mfma_f32_16x16x32_bf16 v[56:59], v[204:207], v[240:243], v[56:59]
    v_mfma_f32_16x16x32_bf16 v[84:87], v[204:207], v[244:247], v[84:87]
    ds_read_b128 v[220:223], v0 offset:6144
    v_mfma_f32_16x16x32_bf16 v[112:115], v[204:207], v[248:251], v[112:115]
    v_mfma_f32_16x16x32_bf16 v[140:143], v[204:207], v[252:255], v[140:143]
    ds_read_b128 v[232:235], v1 offset:34816
    v_mfma_f32_16x16x32_bf16 v[60:63], v[208:211], v[240:243], v[60:63]
    v_mfma_f32_16x16x32_bf16 v[88:91], v[208:211], v[244:247], v[88:91]
    buffer_load_dwordx4 v[204:207], v219, s[8:11], s67 offen offset:2048
    v_mfma_f32_16x16x32_bf16 v[116:119], v[208:211], v[248:251], v[116:119]
    v_mfma_f32_16x16x32_bf16 v[144:147], v[208:211], v[252:255], v[144:147]
    ds_read_b128 v[236:239], v1 offset:49152
    s_waitcnt vmcnt(17)
    v_mfma_f32_16x16x32_bf16 v[64:67], v[212:215], v[240:243], v[64:67]
    v_mfma_f32_16x16x32_bf16 v[92:95], v[212:215], v[244:247], v[92:95]
    buffer_load_dwordx4 v[208:211], v13, s[8:11], s68 offen offset:2048
    v_mfma_f32_16x16x32_bf16 v[120:123], v[212:215], v[248:251], v[120:123]
    v_mfma_f32_16x16x32_bf16 v[148:151], v[212:215], v[252:255], v[148:151]
    s_add_u32 m0, s57, 12288
    s_nop 0
    buffer_load_dwordx4 v13, s[8:11], s72 offen offset:1024 lds
    v_mfma_f32_16x16x32_bf16 v[68:71], v[160:163], v[240:243], v[68:71]
    v_mfma_f32_16x16x32_bf16 v[96:99], v[160:163], v[244:247], v[96:99]
    buffer_load_dwordx4 v[212:215], v13, s[8:11], s68 offen offset:3072
    v_mfma_f32_16x16x32_bf16 v[124:127], v[160:163], v[248:251], v[124:127]
    v_mfma_f32_16x16x32_bf16 v[152:155], v[160:163], v[252:255], v[152:155]
    s_waitcnt vmcnt(18)
    v_mfma_f32_16x16x32_bf16 v[72:75], v[164:167], v[240:243], v[72:75]
    v_mfma_f32_16x16x32_bf16 v[100:103], v[164:167], v[244:247], v[100:103]
    buffer_load_dwordx4 v[160:163], v219, s[8:11], s68 offen offset:0
    v_mfma_f32_16x16x32_bf16 v[128:131], v[164:167], v[248:251], v[128:131]
    v_mfma_f32_16x16x32_bf16 v[156:159], v[164:167], v[252:255], v[156:159]
    s_waitcnt lgkmcnt(0)
    v_mfma_f32_16x16x32_bf16 v[48:51], a[24:27], v[224:227], v[48:51]
    v_mfma_f32_16x16x32_bf16 v[76:79], a[24:27], v[228:231], v[76:79]
    buffer_load_dwordx4 v[164:167], v219, s[8:11], s68 offen offset:1024
    v_mfma_f32_16x16x32_bf16 v[104:107], a[24:27], v[232:235], v[104:107]
    v_mfma_f32_16x16x32_bf16 v[132:135], a[24:27], v[236:239], v[132:135]
    ds_read_b128 v[240:243], v1 offset:7168
    v_mfma_f32_16x16x32_bf16 v[52:55], v[220:223], v[224:227], v[52:55]
    v_mfma_f32_16x16x32_bf16 v[80:83], v[220:223], v[228:231], v[80:83]
    buffer_load_dwordx4 a[52:55], v13, s[8:11], s73 offen offset:0
    v_mfma_f32_16x16x32_bf16 v[108:111], v[220:223], v[232:235], v[108:111]
    v_mfma_f32_16x16x32_bf16 v[136:139], v[220:223], v[236:239], v[136:139]
    ds_read_b128 v[244:247], v1 offset:21504
    s_waitcnt vmcnt(17)
    v_mfma_f32_16x16x32_bf16 v[56:59], v[168:171], v[224:227], v[56:59]
    v_mfma_f32_16x16x32_bf16 v[84:87], v[168:171], v[228:231], v[84:87]
    ds_read_b128 v[220:223], v0 offset:7168
    v_mfma_f32_16x16x32_bf16 v[112:115], v[168:171], v[232:235], v[112:115]
    v_mfma_f32_16x16x32_bf16 v[140:143], v[168:171], v[236:239], v[140:143]
    ds_read_b128 v[248:251], v1 offset:35840
    v_mfma_f32_16x16x32_bf16 v[60:63], v[172:175], v[224:227], v[60:63]
    v_mfma_f32_16x16x32_bf16 v[88:91], v[172:175], v[228:231], v[88:91]
    buffer_load_dwordx4 v[168:171], v219, s[8:11], s68 offen offset:2048
    v_mfma_f32_16x16x32_bf16 v[116:119], v[172:175], v[232:235], v[116:119]
    v_and_b32 v47, -16, v47
    v_cmp_ne_u32 vcc, s42, v47
    s_cbranch_vccz L_wcL_ok
    s_mov_b32 s34, 0
L_wcL_3:
    buffer_load_dword v42, v216, s[8:11], 0 offen sc1
    s_waitcnt vmcnt(0)
    v_and_b32 v46, -16, v42
    v_cmp_ne_u32 vcc, s42, v46
    s_cbranch_vccz L_wcL_3_x
    s_add_u32 s34, s34, 1
    s_cmp_lt_u32 s34, 1048576
    s_cbranch_scc1 L_wcL_3
L_wcL_3_x:
    s_waitcnt vmcnt(0)
L_wcL_ok:
    v_mfma_f32_16x16x32_bf16 v[144:147], v[172:175], v[236:239], v[144:147]
    ds_read_b128 v[252:255], v1 offset:50176
    s_waitcnt vmcnt(16)
    v_mfma_f32_16x16x32_bf16 v[64:67], v[176:179], v[224:227], v[64:67]
    v_mfma_f32_16x16x32_bf16 v[92:95], v[176:179], v[228:231], v[92:95]
    buffer_load_dwordx4 v[172:175], v13, s[8:11], s69 offen offset:2048
    v_mfma_f32_16x16x32_bf16 v[120:123], v[176:179], v[232:235], v[120:123]
    v_mfma_f32_16x16x32_bf16 v[148:151], v[176:179], v[236:239], v[148:151]
    s_add_u32 m0, s57, 13312
    s_nop 0
    buffer_load_dwordx4 v13, s[8:11], s73 offen offset:1024 lds
    v_mfma_f32_16x16x32_bf16 v[68:71], v[180:183], v[224:227], v[68:71]
    v_mfma_f32_16x16x32_bf16 v[96:99], v[180:183], v[228:231], v[96:99]
    buffer_load_dwordx4 v[176:179], v13, s[8:11], s69 offen offset:3072
    v_mfma_f32_16x16x32_bf16 v[124:127], v[180:183], v[232:235], v[124:127]
    v_mfma_f32_16x16x32_bf16 v[152:155], v[180:183], v[236:239], v[152:155]
    s_waitcnt vmcnt(17)
    v_mfma_f32_16x16x32_bf16 v[72:75], v[184:187], v[224:227], v[72:75]
    v_mfma_f32_16x16x32_bf16 v[100:103], v[184:187], v[228:231], v[100:103]
    buffer_load_dwordx4 v[180:183], v219, s[8:11], s69 offen offset:0
    v_mfma_f32_16x16x32_bf16 v[128:131], v[184:187], v[232:235], v[128:131]
    v_mfma_f32_16x16x32_bf16 v[156:159], v[184:187], v[236:239], v[156:159]
    s_waitcnt lgkmcnt(0)
    v_mfma_f32_16x16x32_bf16 v[48:51], a[28:31], v[240:243], v[48:51]
    v_mfma_f32_16x16x32_bf16 v[76:79], a[28:31], v[244:247], v[76:79]
    buffer_load_dwordx4 v[184:187], v219, s[8:11], s69 offen offset:1024
    v_mfma_f32_16x16x32_bf16 v[104:107], a[28:31], v[248:251], v[104:107]
    v_mfma_f32_16x16x32_bf16 v[132:135], a[28:31], v[252:255], v[132:135]
    ds_read_b128 v[224:227], v1 offset:8192
    v_mfma_f32_16x16x32_bf16 v[52:55], v[220:223], v[240:243], v[52:55]
    v_mfma_f32_16x16x32_bf16 v[80:83], v[220:223], v[244:247], v[80:83]
    s_mov_b32 s31, 7700480
    buffer_load_dwordx4 a[56:59], v13, s[8:11], s31 offen offset:2048
    v_mfma_f32_16x16x32_bf16 v[108:111], v[220:223], v[248:251], v[108:111]
    v_mfma_f32_16x16x32_bf16 v[136:139], v[220:223], v[252:255], v[136:139]
    ds_read_b128 v[228:231], v1 offset:22528
    s_waitcnt vmcnt(17)
    v_mfma_f32_16x16x32_bf16 v[56:59], v[188:191], v[240:243], v[56:59]
    v_mfma_f32_16x16x32_bf16 v[84:87], v[188:191], v[244:247], v[84:87]
    ds_read_b128 v[220:223], v0 offset:8192
    v_mfma_f32_16x16x32_bf16 v[112:115], v[188:191], v[248:251], v[112:115]
    v_mfma_f32_16x16x32_bf16 v[140:143], v[188:191], v[252:255], v[140:143]
    ds_read_b128 v[232:235], v1 offset:36864
    v_mfma_f32_16x16x32_bf16 v[60:63], v[192:195], v[240:243], v[60:63]
    v_mfma_f32_16x16x32_bf16 v[88:91], v[192:195], v[244:247], v[88:91]
    buffer_load_dwordx4 v[188:191], v219, s[8:11], s69 offen offset:2048
    v_mfma_f32_16x16x32_bf16 v[116:119], v[192:195], v[248:251], v[116:119]
    v_mfma_f32_16x16x32_bf16 v[144:147], v[192:195], v[252:255], v[144:147]
    ds_read_b128 v[236:239], v1 offset:51200
    s_waitcnt vmcnt(16)
    v_mfma_f32_16x16x32_bf16 v[64:67], v[196:199], v[240:243], v[64:67]
    v_mfma_f32_16x16x32_bf16 v[92:95], v[196:199], v[244:247], v[92:95]
    buffer_load_dwordx4 v[192:195], v13, s[8:11], s70 offen offset:2048
    v_mfma_f32_16x16x32_bf16 v[120:123], v[196:199], v[248:251], v[120:123]
    v_mfma_f32_16x16x32_bf16 v[148:151], v[196:199], v[252:255], v[148:151]
    buffer_load_dwordx4 a[60:63], v13, s[8:11], s31 offen offset:3072
    v_mfma_f32_16x16x32_bf16 v[68:71], v[200:203], v[240:243], v[68:71]
    v_mfma_f32_16x16x32_bf16 v[96:99], v[200:203], v[244:247], v[96:99]
    buffer_load_dwordx4 v[196:199], v13, s[8:11], s70 offen offset:3072
    v_mfma_f32_16x16x32_bf16 v[124:127], v[200:203], v[248:251], v[124:127]
    v_mfma_f32_16x16x32_bf16 v[152:155], v[200:203], v[252:255], v[152:155]
    s_waitcnt vmcnt(17)
    v_mfma_f32_16x16x32_bf16 v[72:75], v[204:207], v[240:243], v[72:75]
    v_mfma_f32_16x16x32_bf16 v[100:103], v[204:207], v[244:247], v[100:103]
    buffer_load_dwordx4 v[200:203], v219, s[8:11], s70 offen offset:0
    v_mfma_f32_16x16x32_bf16 v[128:131], v[204:207], v[248:251], v[128:131]
    v_mfma_f32_16x16x32_bf16 v[156:159], v[204:207], v[252:255], v[156:159]
    s_waitcnt lgkmcnt(0)
    v_mfma_f32_16x16x32_bf16 v[48:51], a[32:35], v[224:227], v[48:51]
    v_mfma_f32_16x16x32_bf16 v[76:79], a[32:35], v[228:231], v[76:79]
    buffer_load_dwordx4 v[204:207], v219, s[8:11], s70 offen offset:1024
    v_mfma_f32_16x16x32_bf16 v[104:107], a[32:35], v[232:235], v[104:107]
    v_mfma_f32_16x16x32_bf16 v[132:135], a[32:35], v[236:239], v[132:135]
    ds_read_b128 v[240:243], v1 offset:9216
    v_mfma_f32_16x16x32_bf16 v[52:55], v[220:223], v[224:227], v[52:55]
    v_mfma_f32_16x16x32_bf16 v[80:83], v[220:223], v[228:231], v[80:83]
    s_mov_b32 s31, 7704576
    buffer_load_dwordx4 a[64:67], v13, s[8:11], s31 offen offset:0
    v_mfma_f32_16x16x32_bf16 v[108:111], v[220:223], v[232:235], v[108:111]
    v_mfma_f32_16x16x32_bf16 v[136:139], v[220:223], v[236:239], v[136:139]
    ds_read_b128 v[244:247], v1 offset:23552
    s_waitcnt vmcnt(17)
    v_mfma_f32_16x16x32_bf16 v[56:59], v[208:211], v[224:227], v[56:59]
    v_mfma_f32_16x16x32_bf16 v[84:87], v[208:211], v[228:231], v[84:87]
    ds_read_b128 v[220:223], v0 offset:9216
    v_mfma_f32_16x16x32_bf16 v[112:115], v[208:211], v[232:235], v[112:115]
    v_mfma_f32_16x16x32_bf16 v[140:143], v[208:211], v[236:239], v[140:143]
    ds_read_b128 v[248:251], v1 offset:37888
    v_mfma_f32_16x16x32_bf16 v[60:63], v[212:215], v[224:227], v[60:63]
    v_mfma_f32_16x16x32_bf16 v[88:91], v[212:215], v[228:231], v[88:91]
    buffer_load_dwordx4 v[208:211], v219, s[8:11], s70 offen offset:2048
    v_mfma_f32_16x16x32_bf16 v[116:119], v[212:215], v[232:235], v[116:119]
    v_mfma_f32_16x16x32_bf16 v[144:147], v[212:215], v[236:239], v[144:147]
    ds_read_b128 v[252:255], v1 offset:52224
    s_waitcnt vmcnt(16)
    v_mfma_f32_16x16x32_bf16 v[64:67], v[160:163], v[224:227], v[64:67]
    v_mfma_f32_16x16x32_bf16 v[92:95], v[160:163], v[228:231], v[92:95]
    buffer_load_dwordx4 v[212:215], v13, s[8:11], s71 offen offset:2048
    v_mfma_f32_16x16x32_bf16 v[120:123], v[160:163], v[232:235], v[120:123]
    v_mfma_f32_16x16x32_bf16 v[148:151], v[160:163], v[236:239], v[148:151]
    buffer_load_dwordx4 a[68:71], v13, s[8:11], s31 offen offset:1024
    v_mfma_f32_16x16x32_bf16 v[68:71], v[164:167], v[224:227], v[68:71]
    v_mfma_f32_16x16x32_bf16 v[96:99], v[164:167], v[228:231], v[96:99]
    buffer_load_dwordx4 v[160:163], v13, s[8:11], s71 offen offset:3072
    v_mfma_f32_16x16x32_bf16 v[124:127], v[164:167], v[232:235], v[124:127]
    v_mfma_f32_16x16x32_bf16 v[152:155], v[164:167], v[236:239], v[152:155]
    s_waitcnt vmcnt(17)
    v_mfma_f32_16x16x32_bf16 v[72:75], v[168:171], v[224:227], v[72:75]
    v_mfma_f32_16x16x32_bf16 v[100:103], v[168:171], v[228:231], v[100:103]
    buffer_load_dwordx4 v[164:167], v219, s[8:11], s71 offen offset:0
    v_mfma_f32_16x16x32_bf16 v[128:131], v[168:171], v[232:235], v[128:131]
    v_mfma_f32_16x16x32_bf16 v[156:159], v[168:171], v[236:239], v[156:159]
    s_waitcnt lgkmcnt(0)
    v_mfma_f32_16x16x32_bf16 v[48:51], a[36:39], v[240:243], v[48:51]
    v_mfma_f32_16x16x32_bf16 v[76:79], a[36:39], v[244:247], v[76:79]
    buffer_load_dwordx4 v[168:171], v219, s[8:11], s71 offen offset:1024
    v_mfma_f32_16x16x32_bf16 v[104:107], a[36:39], v[248:251], v[104:107]
    s_add_u32 s51, s50, L_ab0-interleave_layers__ssm_conv_h3__glu_gated_bilinear__prompt_kernel
    buffer_load_dword v46, off, s[4:7], s51
    v_mfma_f32_16x16x32_bf16 v[132:135], a[36:39], v[252:255], v[132:135]
    ds_read_b128 v[224:227], v1 offset:10240
    v_mfma_f32_16x16x32_bf16 v[52:55], v[220:223], v[240:243], v[52:55]
    v_mfma_f32_16x16x32_bf16 v[80:83], v[220:223], v[244:247], v[80:83]
    buffer_load_dwordx4 a[72:75], v13, s[8:11], s31 offen offset:2048
    v_mfma_f32_16x16x32_bf16 v[108:111], v[220:223], v[248:251], v[108:111]
    v_mfma_f32_16x16x32_bf16 v[136:139], v[220:223], v[252:255], v[136:139]
    ds_read_b128 v[228:231], v1 offset:24576
    s_waitcnt vmcnt(18)
    v_mfma_f32_16x16x32_bf16 v[56:59], v[172:175], v[240:243], v[56:59]
    v_mfma_f32_16x16x32_bf16 v[84:87], v[172:175], v[244:247], v[84:87]
    ds_read_b128 v[220:223], v0 offset:10240
    v_mfma_f32_16x16x32_bf16 v[112:115], v[172:175], v[248:251], v[112:115]
    v_mfma_f32_16x16x32_bf16 v[140:143], v[172:175], v[252:255], v[140:143]
    ds_read_b128 v[232:235], v1 offset:38912
    v_mfma_f32_16x16x32_bf16 v[60:63], v[176:179], v[240:243], v[60:63]
    v_mfma_f32_16x16x32_bf16 v[88:91], v[176:179], v[244:247], v[88:91]
    buffer_load_dwordx4 v[172:175], v219, s[8:11], s71 offen offset:2048
    v_mfma_f32_16x16x32_bf16 v[116:119], v[176:179], v[248:251], v[116:119]
    v_mfma_f32_16x16x32_bf16 v[144:147], v[176:179], v[252:255], v[144:147]
    ds_read_b128 v[236:239], v1 offset:53248
    s_waitcnt vmcnt(17)
    v_mfma_f32_16x16x32_bf16 v[64:67], v[180:183], v[240:243], v[64:67]
    v_mfma_f32_16x16x32_bf16 v[92:95], v[180:183], v[244:247], v[92:95]
    buffer_load_dwordx4 v[176:179], v13, s[8:11], s72 offen offset:2048
    v_mfma_f32_16x16x32_bf16 v[120:123], v[180:183], v[248:251], v[120:123]
    v_mfma_f32_16x16x32_bf16 v[148:151], v[180:183], v[252:255], v[148:151]
    buffer_load_dwordx4 a[76:79], v13, s[8:11], s31 offen offset:3072
    v_mfma_f32_16x16x32_bf16 v[68:71], v[184:187], v[240:243], v[68:71]
    v_mfma_f32_16x16x32_bf16 v[96:99], v[184:187], v[244:247], v[96:99]
    buffer_load_dwordx4 v[180:183], v13, s[8:11], s72 offen offset:3072
    v_mfma_f32_16x16x32_bf16 v[124:127], v[184:187], v[248:251], v[124:127]
    v_mfma_f32_16x16x32_bf16 v[152:155], v[184:187], v[252:255], v[152:155]
    s_mov_b32 s31, 7708672
    buffer_load_dwordx4 a[80:83], v13, s[8:11], s31 offen offset:0
    s_waitcnt vmcnt(19)
    v_mfma_f32_16x16x32_bf16 v[72:75], v[188:191], v[240:243], v[72:75]
    v_mfma_f32_16x16x32_bf16 v[100:103], v[188:191], v[244:247], v[100:103]
    buffer_load_dwordx4 v[184:187], v219, s[8:11], s72 offen offset:0
    v_mfma_f32_16x16x32_bf16 v[128:131], v[188:191], v[248:251], v[128:131]
    v_mfma_f32_16x16x32_bf16 v[156:159], v[188:191], v[252:255], v[156:159]
    s_waitcnt lgkmcnt(0)
    v_mfma_f32_16x16x32_bf16 v[48:51], a[40:43], v[224:227], v[48:51]
    v_mfma_f32_16x16x32_bf16 v[76:79], a[40:43], v[228:231], v[76:79]
    buffer_load_dwordx4 v[188:191], v219, s[8:11], s72 offen offset:1024
    v_mfma_f32_16x16x32_bf16 v[104:107], a[40:43], v[232:235], v[104:107]
    v_mfma_f32_16x16x32_bf16 v[132:135], a[40:43], v[236:239], v[132:135]
    ds_read_b128 v[240:243], v1 offset:11264
    v_mfma_f32_16x16x32_bf16 v[52:55], v[220:223], v[224:227], v[52:55]
    v_mfma_f32_16x16x32_bf16 v[80:83], v[220:223], v[228:231], v[80:83]
    buffer_load_dwordx4 a[84:87], v13, s[8:11], s31 offen offset:1024
    v_mfma_f32_16x16x32_bf16 v[108:111], v[220:223], v[232:235], v[108:111]
    v_mfma_f32_16x16x32_bf16 v[136:139], v[220:223], v[236:239], v[136:139]
    ds_read_b128 v[244:247], v1 offset:25600
    s_waitcnt vmcnt(19)
    v_mfma_f32_16x16x32_bf16 v[56:59], v[192:195], v[224:227], v[56:59]
    v_mfma_f32_16x16x32_bf16 v[84:87], v[192:195], v[228:231], v[84:87]
    ds_read_b128 v[220:223], v0 offset:11264
    v_mfma_f32_16x16x32_bf16 v[112:115], v[192:195], v[232:235], v[112:115]
    v_mfma_f32_16x16x32_bf16 v[140:143], v[192:195], v[236:239], v[140:143]
    ds_read_b128 v[248:251], v1 offset:39936
    v_mfma_f32_16x16x32_bf16 v[60:63], v[196:199], v[224:227], v[60:63]
    v_mfma_f32_16x16x32_bf16 v[88:91], v[196:199], v[228:231], v[88:91]
    buffer_load_dwordx4 v[192:195], v219, s[8:11], s72 offen offset:2048
    v_mfma_f32_16x16x32_bf16 v[116:119], v[196:199], v[232:235], v[116:119]
    v_mfma_f32_16x16x32_bf16 v[144:147], v[196:199], v[236:239], v[144:147]
    ds_read_b128 v[252:255], v1 offset:54272
    s_waitcnt vmcnt(18)
    v_mfma_f32_16x16x32_bf16 v[64:67], v[200:203], v[224:227], v[64:67]
    v_mfma_f32_16x16x32_bf16 v[92:95], v[200:203], v[228:231], v[92:95]
    buffer_load_dwordx4 v[196:199], v13, s[8:11], s73 offen offset:2048
    v_mfma_f32_16x16x32_bf16 v[120:123], v[200:203], v[232:235], v[120:123]
    v_mfma_f32_16x16x32_bf16 v[148:151], v[200:203], v[236:239], v[148:151]
    buffer_load_dwordx4 a[88:91], v13, s[8:11], s31 offen offset:2048
    v_mfma_f32_16x16x32_bf16 v[68:71], v[204:207], v[224:227], v[68:71]
    v_mfma_f32_16x16x32_bf16 v[96:99], v[204:207], v[228:231], v[96:99]
    buffer_load_dwordx4 v[200:203], v13, s[8:11], s73 offen offset:3072
    v_mfma_f32_16x16x32_bf16 v[124:127], v[204:207], v[232:235], v[124:127]
    v_mfma_f32_16x16x32_bf16 v[152:155], v[204:207], v[236:239], v[152:155]
    buffer_load_dwordx4 a[92:95], v13, s[8:11], s31 offen offset:3072
    s_waitcnt vmcnt(20)
    v_mfma_f32_16x16x32_bf16 v[72:75], v[208:211], v[224:227], v[72:75]
    v_mfma_f32_16x16x32_bf16 v[100:103], v[208:211], v[228:231], v[100:103]
    buffer_load_dwordx4 v[204:207], v219, s[8:11], s73 offen offset:0
    v_mfma_f32_16x16x32_bf16 v[128:131], v[208:211], v[232:235], v[128:131]
    v_mfma_f32_16x16x32_bf16 v[156:159], v[208:211], v[236:239], v[156:159]
    s_waitcnt lgkmcnt(0)
    v_mfma_f32_16x16x32_bf16 v[48:51], a[44:47], v[240:243], v[48:51]
    v_mfma_f32_16x16x32_bf16 v[76:79], a[44:47], v[244:247], v[76:79]
    buffer_load_dwordx4 v[208:211], v219, s[8:11], s73 offen offset:1024
    v_mfma_f32_16x16x32_bf16 v[104:107], a[44:47], v[248:251], v[104:107]
    v_mfma_f32_16x16x32_bf16 v[132:135], a[44:47], v[252:255], v[132:135]
    ds_read_b128 v[224:227], v1 offset:12288
    v_mfma_f32_16x16x32_bf16 v[52:55], v[220:223], v[240:243], v[52:55]
    v_mfma_f32_16x16x32_bf16 v[80:83], v[220:223], v[244:247], v[80:83]
    s_mov_b32 s31, 7712768
    buffer_load_dwordx4 a[96:99], v13, s[8:11], s31 offen offset:0
    v_mfma_f32_16x16x32_bf16 v[108:111], v[220:223], v[248:251], v[108:111]
    v_mfma_f32_16x16x32_bf16 v[136:139], v[220:223], v[252:255], v[136:139]
    ds_read_b128 v[228:231], v1 offset:26624
    s_waitcnt vmcnt(20)
    v_mfma_f32_16x16x32_bf16 v[56:59], v[212:215], v[240:243], v[56:59]
    v_mfma_f32_16x16x32_bf16 v[84:87], v[212:215], v[244:247], v[84:87]
    ds_read_b128 v[220:223], v0 offset:12288
    v_mfma_f32_16x16x32_bf16 v[112:115], v[212:215], v[248:251], v[112:115]
    v_mfma_f32_16x16x32_bf16 v[140:143], v[212:215], v[252:255], v[140:143]
    ds_read_b128 v[232:235], v1 offset:40960
    v_mfma_f32_16x16x32_bf16 v[60:63], v[160:163], v[240:243], v[60:63]
    v_mfma_f32_16x16x32_bf16 v[88:91], v[160:163], v[244:247], v[88:91]
    buffer_load_dwordx4 v[212:215], v219, s[8:11], s73 offen offset:2048
    v_mfma_f32_16x16x32_bf16 v[116:119], v[160:163], v[248:251], v[116:119]
    v_mfma_f32_16x16x32_bf16 v[144:147], v[160:163], v[252:255], v[144:147]
    ds_read_b128 v[236:239], v1 offset:55296
    s_waitcnt vmcnt(19)
    v_mfma_f32_16x16x32_bf16 v[64:67], v[164:167], v[240:243], v[64:67]
    v_mfma_f32_16x16x32_bf16 v[92:95], v[164:167], v[244:247], v[92:95]
    v_mfma_f32_16x16x32_bf16 v[120:123], v[164:167], v[248:251], v[120:123]
    v_mfma_f32_16x16x32_bf16 v[148:151], v[164:167], v[252:255], v[148:151]
    buffer_load_dwordx4 a[100:103], v13, s[8:11], s31 offen offset:1024
    v_mfma_f32_16x16x32_bf16 v[68:71], v[168:171], v[240:243], v[68:71]
    v_mfma_f32_16x16x32_bf16 v[96:99], v[168:171], v[244:247], v[96:99]
    v_mfma_f32_16x16x32_bf16 v[124:127], v[168:171], v[248:251], v[124:127]
    v_mfma_f32_16x16x32_bf16 v[152:155], v[168:171], v[252:255], v[152:155]
    buffer_load_dwordx4 a[104:107], v13, s[8:11], s31 offen offset:2048
    s_waitcnt vmcnt(18)
    v_mfma_f32_16x16x32_bf16 v[72:75], v[172:175], v[240:243], v[72:75]
    v_mfma_f32_16x16x32_bf16 v[100:103], v[172:175], v[244:247], v[100:103]
    v_mfma_f32_16x16x32_bf16 v[128:131], v[172:175], v[248:251], v[128:131]
    v_mfma_f32_16x16x32_bf16 v[156:159], v[172:175], v[252:255], v[156:159]
    s_waitcnt lgkmcnt(0)
    v_mfma_f32_16x16x32_bf16 v[48:51], a[48:51], v[224:227], v[48:51]
    v_mfma_f32_16x16x32_bf16 v[76:79], a[48:51], v[228:231], v[76:79]
    v_mfma_f32_16x16x32_bf16 v[104:107], a[48:51], v[232:235], v[104:107]
    v_mfma_f32_16x16x32_bf16 v[132:135], a[48:51], v[236:239], v[132:135]
    ds_read_b128 v[240:243], v1 offset:13312
    v_mfma_f32_16x16x32_bf16 v[52:55], v[220:223], v[224:227], v[52:55]
    v_mfma_f32_16x16x32_bf16 v[80:83], v[220:223], v[228:231], v[80:83]
    buffer_load_dwordx4 a[108:111], v13, s[8:11], s31 offen offset:3072
    v_mfma_f32_16x16x32_bf16 v[108:111], v[220:223], v[232:235], v[108:111]
    v_mfma_f32_16x16x32_bf16 v[136:139], v[220:223], v[236:239], v[136:139]
    ds_read_b128 v[244:247], v1 offset:27648
    s_waitcnt vmcnt(16)
    v_mfma_f32_16x16x32_bf16 v[56:59], v[176:179], v[224:227], v[56:59]
    v_mfma_f32_16x16x32_bf16 v[84:87], v[176:179], v[228:231], v[84:87]
    ds_read_b128 v[220:223], v0 offset:13312
    v_mfma_f32_16x16x32_bf16 v[112:115], v[176:179], v[232:235], v[112:115]
    v_mfma_f32_16x16x32_bf16 v[140:143], v[176:179], v[236:239], v[140:143]
    ds_read_b128 v[248:251], v1 offset:41984
    v_mfma_f32_16x16x32_bf16 v[60:63], v[180:183], v[224:227], v[60:63]
    v_mfma_f32_16x16x32_bf16 v[88:91], v[180:183], v[228:231], v[88:91]
    v_mfma_f32_16x16x32_bf16 v[116:119], v[180:183], v[232:235], v[116:119]
    v_mfma_f32_16x16x32_bf16 v[144:147], v[180:183], v[236:239], v[144:147]
    ds_read_b128 v[252:255], v1 offset:56320
    s_waitcnt vmcnt(13)
    v_mfma_f32_16x16x32_bf16 v[64:67], v[184:187], v[224:227], v[64:67]
    v_mfma_f32_16x16x32_bf16 v[92:95], v[184:187], v[228:231], v[92:95]
    v_mfma_f32_16x16x32_bf16 v[120:123], v[184:187], v[232:235], v[120:123]
    v_mfma_f32_16x16x32_bf16 v[148:151], v[184:187], v[236:239], v[148:151]
    s_mov_b32 s31, 7716864
    buffer_load_dwordx4 a[112:115], v13, s[8:11], s31 offen offset:0
    v_mfma_f32_16x16x32_bf16 v[68:71], v[188:191], v[224:227], v[68:71]
    v_mfma_f32_16x16x32_bf16 v[96:99], v[188:191], v[228:231], v[96:99]
    v_mfma_f32_16x16x32_bf16 v[124:127], v[188:191], v[232:235], v[124:127]
    v_mfma_f32_16x16x32_bf16 v[152:155], v[188:191], v[236:239], v[152:155]
    buffer_load_dwordx4 a[116:119], v13, s[8:11], s31 offen offset:1024
    s_waitcnt vmcnt(13)
    v_mfma_f32_16x16x32_bf16 v[72:75], v[192:195], v[224:227], v[72:75]
    v_mfma_f32_16x16x32_bf16 v[100:103], v[192:195], v[228:231], v[100:103]
    v_mfma_f32_16x16x32_bf16 v[128:131], v[192:195], v[232:235], v[128:131]
    v_mfma_f32_16x16x32_bf16 v[156:159], v[192:195], v[236:239], v[156:159]
L_ab0:
    s_waitcnt lgkmcnt(4)
    v_mfma_f32_16x16x32_bf16 v[48:51], a[52:55], v[240:243], v[48:51]
    s_waitcnt lgkmcnt(2)
    v_mfma_f32_16x16x32_bf16 v[52:55], v[220:223], v[240:243], v[52:55]
    s_waitcnt vmcnt(12)
    v_mfma_f32_16x16x32_bf16 v[56:59], v[196:199], v[240:243], v[56:59]
    buffer_load_dwordx4 a[120:123], v13, s[8:11], s31 offen offset:2048
    s_waitcnt vmcnt(11)
    v_mfma_f32_16x16x32_bf16 v[60:63], v[200:203], v[240:243], v[60:63]
    s_waitcnt vmcnt(9)
    v_mfma_f32_16x16x32_bf16 v[64:67], v[204:207], v[240:243], v[64:67]
    s_waitcnt vmcnt(8)
    v_mfma_f32_16x16x32_bf16 v[68:71], v[208:211], v[240:243], v[68:71]
    buffer_load_dwordx4 a[124:127], v13, s[8:11], s31 offen offset:3072
    s_waitcnt vmcnt(7)
    v_mfma_f32_16x16x32_bf16 v[72:75], v[212:215], v[240:243], v[72:75]
    v_mfma_f32_16x16x32_bf16 v[76:79], a[52:55], v[244:247], v[76:79]
    v_mfma_f32_16x16x32_bf16 v[80:83], v[220:223], v[244:247], v[80:83]
    v_mul_f32 v48, v48, v52
    v_mul_f32 v49, v49, v53
    v_mfma_f32_16x16x32_bf16 v[84:87], v[196:199], v[244:247], v[84:87]
    s_mov_b32 s31, 7720960
    buffer_load_dwordx4 a[128:131], v13, s[8:11], s31 offen offset:0
    v_mul_f32 v50, v50, v54
    v_mul_f32 v51, v51, v55
    v_cvt_pk_bf16_f32 v240, v48, v49
    v_mfma_f32_16x16x32_bf16 v[88:91], v[200:203], v[244:247], v[88:91]
    v_cvt_pk_bf16_f32 v241, v50, v51
    v_mul_f32 v56, v56, v60
    v_mul_f32 v57, v57, v61
    v_mfma_f32_16x16x32_bf16 v[92:95], v[204:207], v[244:247], v[92:95]
    v_mul_f32 v58, v58, v62
    v_mul_f32 v59, v59, v63
    v_mfma_f32_16x16x32_bf16 v[96:99], v[208:211], v[244:247], v[96:99]
    buffer_load_dwordx4 a[132:135], v13, s[8:11], s31 offen offset:1024
    v_cvt_pk_bf16_f32 v242, v56, v57
    v_cvt_pk_bf16_f32 v243, v58, v59
    ds_write_b128 v6, v[240:243] offset:0
    v_mfma_f32_16x16x32_bf16 v[100:103], v[212:215], v[244:247], v[100:103]
    v_mul_f32 v64, v64, v68
    v_mul_f32 v65, v65, v69
    v_mul_f32 v66, v66, v70
    s_waitcnt lgkmcnt(2)
    v_mfma_f32_16x16x32_bf16 v[104:107], a[52:55], v[248:251], v[104:107]
    v_mul_f32 v67, v67, v71
    v_cvt_pk_bf16_f32 v64, v64, v65
    v_mfma_f32_16x16x32_bf16 v[108:111], v[220:223], v[248:251], v[108:111]
    v_cvt_pk_bf16_f32 v65, v66, v67
    v_permlane32_swap_b32 v72, v74
    v_permlane32_swap_b32 v73, v75
    v_mfma_f32_16x16x32_bf16 v[112:115], v[196:199], v[248:251], v[112:115]
    buffer_load_dwordx4 a[136:139], v13, s[8:11], s31 offen offset:2048
    v_mul_f32 v72, v72, v74
    v_mul_f32 v73, v73, v75
    v_cvt_pk_bf16_f32 v66, v72, v73
    v_mfma_f32_16x16x32_bf16 v[116:119], v[200:203], v[248:251], v[116:119]
    ds_write_b64 v7, v[64:65] offset:0
    ds_write_b32 v8, v66 offset:0
    v_mul_f32 v76, v76, v80
    v_mfma_f32_16x16x32_bf16 v[120:123], v[204:207], v[248:251], v[120:123]
    v_mul_f32 v77, v77, v81
    v_mul_f32 v78, v78, v82
    v_mfma_f32_16x16x32_bf16 v[124:127], v[208:211], v[248:251], v[124:127]
    buffer_load_dwordx4 a[140:143], v13, s[8:11], s31 offen offset:3072
    v_mul_f32 v79, v79, v83
    v_cvt_pk_bf16_f32 v244, v76, v77
    v_cvt_pk_bf16_f32 v245, v78, v79
    v_mfma_f32_16x16x32_bf16 v[128:131], v[212:215], v[248:251], v[128:131]
    v_mul_f32 v84, v84, v88
    v_mul_f32 v85, v85, v89
    v_mul_f32 v86, v86, v90
    s_waitcnt lgkmcnt(3)
    v_mfma_f32_16x16x32_bf16 v[132:135], a[52:55], v[252:255], v[132:135]
    v_mul_f32 v87, v87, v91
    v_cvt_pk_bf16_f32 v246, v84, v85
    v_mfma_f32_16x16x32_bf16 v[136:139], v[220:223], v[252:255], v[136:139]
    v_cvt_pk_bf16_f32 v247, v86, v87
    ds_write_b128 v6, v[244:247] offset:7168
    v_mul_f32 v92, v92, v96
    v_mfma_f32_16x16x32_bf16 v[140:143], v[196:199], v[252:255], v[140:143]
    s_mov_b32 s31, 7725056
    buffer_load_dwordx4 a[144:147], v13, s[8:11], s31 offen offset:0
    v_mul_f32 v93, v93, v97
    v_mul_f32 v94, v94, v98
    v_mul_f32 v95, v95, v99
    v_mfma_f32_16x16x32_bf16 v[144:147], v[200:203], v[252:255], v[144:147]
    v_cvt_pk_bf16_f32 v92, v92, v93
    v_cvt_pk_bf16_f32 v93, v94, v95
    v_mfma_f32_16x16x32_bf16 v[148:151], v[204:207], v[252:255], v[148:151]
    v_permlane32_swap_b32 v100, v102
    v_permlane32_swap_b32 v101, v103
    v_mul_f32 v100, v100, v102
    v_mfma_f32_16x16x32_bf16 v[152:155], v[208:211], v[252:255], v[152:155]
    buffer_load_dwordx4 a[148:151], v13, s[8:11], s31 offen offset:1024
    v_mul_f32 v101, v101, v103
    v_cvt_pk_bf16_f32 v94, v100, v101
    ds_write_b64 v7, v[92:93] offset:7168
    v_mfma_f32_16x16x32_bf16 v[156:159], v[212:215], v[252:255], v[156:159]
    ds_write_b32 v8, v94 offset:7168
    v_mul_f32 v104, v104, v108
    v_mul_f32 v105, v105, v109
    v_mfma_f32_16x16x32_bf16 v[48:51], a[56:59], v[240:243], 0
    v_mul_f32 v106, v106, v110
    v_mul_f32 v107, v107, v111
    v_mfma_f32_16x16x32_bf16 v[52:55], a[60:63], v[240:243], 0
    v_cvt_pk_bf16_f32 v248, v104, v105
    v_cvt_pk_bf16_f32 v249, v106, v107
    v_mul_f32 v112, v112, v116
    v_mfma_f32_16x16x32_bf16 v[56:59], a[64:67], v[240:243], 0
    buffer_load_dwordx4 a[152:155], v13, s[8:11], s31 offen offset:2048
    v_mul_f32 v113, v113, v117
    v_mul_f32 v114, v114, v118
    v_mul_f32 v115, v115, v119
    v_mfma_f32_16x16x32_bf16 v[60:63], a[68:71], v[240:243], 0
    v_cvt_pk_bf16_f32 v250, v112, v113
    v_cvt_pk_bf16_f32 v251, v114, v115
    v_mfma_f32_16x16x32_bf16 v[64:67], a[72:75], v[240:243], 0
    ds_write_b128 v6, v[248:251] offset:14336
    v_mul_f32 v120, v120, v124
    v_mul_f32 v121, v121, v125
    v_mfma_f32_16x16x32_bf16 v[68:71], a[76:79], v[240:243], 0
    buffer_load_dwordx4 a[156:159], v13, s[8:11], s31 offen offset:3072
    v_mul_f32 v122, v122, v126
    v_mul_f32 v123, v123, v127
    v_cvt_pk_bf16_f32 v120, v120, v121
    v_mfma_f32_16x16x32_bf16 v[72:75], a[80:83], v[240:243], 0
    v_cvt_pk_bf16_f32 v121, v122, v123
    v_permlane32_swap_b32 v128, v130
    v_mfma_f32_16x16x32_bf16 v[76:79], a[56:59], v[244:247], 0
    v_permlane32_swap_b32 v129, v131
    v_mul_f32 v128, v128, v130
    v_mul_f32 v129, v129, v131
    v_mfma_f32_16x16x32_bf16 v[80:83], a[60:63], v[244:247], 0
    v_cvt_pk_bf16_f32 v122, v128, v129
    ds_write_b64 v7, v[120:121] offset:14336
    ds_write_b32 v8, v122 offset:14336
    v_mfma_f32_16x16x32_bf16 v[84:87], a[64:67], v[244:247], 0
    s_mov_b32 s31, 7729152
    buffer_load_dwordx4 a[160:163], v13, s[8:11], s31 offen offset:0
    v_mul_f32 v132, v132, v136
    v_mul_f32 v133, v133, v137
    v_mul_f32 v134, v134, v138
    v_mfma_f32_16x16x32_bf16 v[88:91], a[68:71], v[244:247], 0
    v_mul_f32 v135, v135, v139
    v_cvt_pk_bf16_f32 v252, v132, v133
    v_mfma_f32_16x16x32_bf16 v[92:95], a[72:75], v[244:247], 0
    v_cvt_pk_bf16_f32 v253, v134, v135
    v_mul_f32 v140, v140, v144
    v_mul_f32 v141, v141, v145
    v_mfma_f32_16x16x32_bf16 v[96:99], a[76:79], v[244:247], 0
    buffer_load_dwordx4 a[164:167], v13, s[8:11], s31 offen offset:1024
    v_mul_f32 v142, v142, v146
    v_mul_f32 v143, v143, v147
    v_cvt_pk_bf16_f32 v254, v140, v141
    v_mfma_f32_16x16x32_bf16 v[100:103], a[80:83], v[244:247], 0
    v_cvt_pk_bf16_f32 v255, v142, v143
    ds_write_b128 v6, v[252:255] offset:21504
    v_mfma_f32_16x16x32_bf16 v[104:107], a[56:59], v[248:251], 0
    v_mul_f32 v148, v148, v152
    v_mul_f32 v149, v149, v153
    v_mul_f32 v150, v150, v154
    v_mfma_f32_16x16x32_bf16 v[108:111], a[60:63], v[248:251], 0
    v_mul_f32 v151, v151, v155
    v_cvt_pk_bf16_f32 v148, v148, v149
    v_cvt_pk_bf16_f32 v149, v150, v151
    v_mfma_f32_16x16x32_bf16 v[112:115], a[64:67], v[248:251], 0
    buffer_load_dwordx4 a[168:171], v13, s[8:11], s31 offen offset:2048
    v_permlane32_swap_b32 v156, v158
    v_permlane32_swap_b32 v157, v159
    v_mfma_f32_16x16x32_bf16 v[116:119], a[68:71], v[248:251], 0
    v_mul_f32 v156, v156, v158
    v_mul_f32 v157, v157, v159
    v_cvt_pk_bf16_f32 v150, v156, v157
    v_mfma_f32_16x16x32_bf16 v[120:123], a[72:75], v[248:251], 0
    ds_write_b64 v7, v[148:149] offset:21504
    ds_write_b32 v8, v150 offset:21504
    v_mfma_f32_16x16x32_bf16 v[124:127], a[76:79], v[248:251], 0
    buffer_load_dwordx4 a[172:175], v13, s[8:11], s31 offen offset:3072
    v_mfma_f32_16x16x32_bf16 v[128:131], a[80:83], v[248:251], 0
    s_waitcnt lgkmcnt(0)
    s_barrier
    v_mfma_f32_16x16x32_bf16 v[132:135], a[56:59], v[252:255], 0
    ds_read_b128 v[224:227], v3 offset:0
    v_mfma_f32_16x16x32_bf16 v[136:139], a[60:63], v[252:255], 0
    ds_read_b128 v[228:231], v3 offset:7168
    v_mfma_f32_16x16x32_bf16 v[140:143], a[64:67], v[252:255], 0
    ds_read_b128 v[232:235], v3 offset:14336
    s_mov_b32 s31, 7733248
    buffer_load_dwordx4 a[176:179], v13, s[8:11], s31 offen offset:0
    v_mfma_f32_16x16x32_bf16 v[144:147], a[68:71], v[252:255], 0
    ds_read_b128 v[236:239], v3 offset:21504
    v_mfma_f32_16x16x32_bf16 v[148:151], a[72:75], v[252:255], 0
    v_mfma_f32_16x16x32_bf16 v[152:155], a[76:79], v[252:255], 0
    buffer_load_dwordx4 a[180:183], v13, s[8:11], s31 offen offset:1024
    v_mfma_f32_16x16x32_bf16 v[156:159], a[80:83], v[252:255], 0
    s_waitcnt lgkmcnt(3)
    v_mfma_f32_16x16x32_bf16 v[48:51], a[84:87], v[224:227], v[48:51]
    ds_read_b128 v[240:243], v4 offset:0
    s_waitcnt lgkmcnt(3)
    v_mfma_f32_16x16x32_bf16 v[76:79], a[84:87], v[228:231], v[76:79]
    ds_read_b128 v[244:247], v4 offset:7168
    buffer_load_dwordx4 a[184:187], v13, s[8:11], s31 offen offset:2048
    s_waitcnt lgkmcnt(3)
    v_mfma_f32_16x16x32_bf16 v[104:107], a[84:87], v[232:235], v[104:107]
    ds_read_b128 v[248:251], v4 offset:14336
    s_waitcnt lgkmcnt(3)
    v_mfma_f32_16x16x32_bf16 v[132:135], a[84:87], v[236:239], v[132:135]
    ds_read_b128 v[252:255], v4 offset:21504
    v_mfma_f32_16x16x32_bf16 v[52:55], a[88:91], v[224:227], v[52:55]
    s_mul_i32 s26, s22, 1792
    s_add_u32 s26, s26, 146944
    v_mfma_f32_16x16x32_bf16 v[80:83], a[88:91], v[228:231], v[80:83]
    buffer_load_dwordx4 a[188:191], v13, s[8:11], s31 offen offset:3072
    v_and_b32 v220, 48, v1
    v_mfma_f32_16x16x32_bf16 v[108:111], a[88:91], v[232:235], v[108:111]
    v_lshrrev_b32 v221, 8, v1
    v_mfma_f32_16x16x32_bf16 v[136:139], a[88:91], v[236:239], v[136:139]
    v_lshl_add_u32 v220, v221, 6, v220
    v_mfma_f32_16x16x32_bf16 v[56:59], a[92:95], v[224:227], v[56:59]
    v_add_u32 v220, s26, v220
    v_mfma_f32_16x16x32_bf16 v[84:87], a[92:95], v[228:231], v[84:87]
    s_mov_b32 s31, 7737344
    buffer_load_dwordx4 a[192:195], v13, s[8:11], s31 offen offset:0
    v_mfma_f32_16x16x32_bf16 v[112:115], a[92:95], v[232:235], v[112:115]
    v_mfma_f32_16x16x32_bf16 v[140:143], a[92:95], v[236:239], v[140:143]
    s_waitcnt lgkmcnt(0)
    v_mfma_f32_16x16x32_bf16 v[48:51], a[96:99], v[240:243], v[48:51]
    ds_read_b128 v[224:227], v5 offset:0
    v_mfma_f32_16x16x32_bf16 v[76:79], a[96:99], v[244:247], v[76:79]
    ds_read_b128 v[228:231], v5 offset:7168
    buffer_load_dwordx4 a[196:199], v13, s[8:11], s31 offen offset:1024
    v_mfma_f32_16x16x32_bf16 v[104:107], a[96:99], v[248:251], v[104:107]
    ds_read_b128 v[232:235], v5 offset:14336
    v_mfma_f32_16x16x32_bf16 v[132:135], a[96:99], v[252:255], v[132:135]
    ds_read_b128 v[236:239], v5 offset:21504
    s_waitcnt vmcnt(24)
    v_mfma_f32_16x16x32_bf16 v[52:55], a[100:103], v[240:243], v[52:55]
    v_mfma_f32_16x16x32_bf16 v[80:83], a[100:103], v[244:247], v[80:83]
    buffer_load_dwordx4 a[200:203], v13, s[8:11], s31 offen offset:2048
    v_mfma_f32_16x16x32_bf16 v[108:111], a[100:103], v[248:251], v[108:111]
    v_mfma_f32_16x16x32_bf16 v[136:139], a[100:103], v[252:255], v[136:139]
    s_waitcnt vmcnt(24)
    v_mfma_f32_16x16x32_bf16 v[56:59], a[104:107], v[240:243], v[56:59]
    v_mfma_f32_16x16x32_bf16 v[84:87], a[104:107], v[244:247], v[84:87]
    buffer_load_dwordx4 a[204:207], v13, s[8:11], s31 offen offset:3072
    v_mfma_f32_16x16x32_bf16 v[112:115], a[104:107], v[248:251], v[112:115]
    v_mfma_f32_16x16x32_bf16 v[140:143], a[104:107], v[252:255], v[140:143]
    s_waitcnt vmcnt(24)
    s_waitcnt lgkmcnt(0)
    v_mfma_f32_16x16x32_bf16 v[48:51], a[108:111], v[224:227], v[48:51]
    ds_read_b128 v[240:243], v2 offset:4096
    v_mfma_f32_16x16x32_bf16 v[76:79], a[108:111], v[228:231], v[76:79]
    ds_read_b128 v[244:247], v2 offset:11264
    s_mov_b32 s31, 7741440
    buffer_load_dwordx4 a[208:211], v13, s[8:11], s31 offen offset:0
    v_mfma_f32_16x16x32_bf16 v[104:107], a[108:111], v[232:235], v[104:107]
    ds_read_b128 v[248:251], v2 offset:18432
    v_mfma_f32_16x16x32_bf16 v[132:135], a[108:111], v[236:239], v[132:135]
    ds_read_b128 v[252:255], v2 offset:25600
    s_waitcnt vmcnt(24)
    v_mfma_f32_16x16x32_bf16 v[52:55], a[112:115], v[224:227], v[52:55]
    v_mfma_f32_16x16x32_bf16 v[80:83], a[112:115], v[228:231], v[80:83]
    buffer_load_dwordx4 a[212:215], v13, s[8:11], s31 offen offset:1024
    v_mfma_f32_16x16x32_bf16 v[108:111], a[112:115], v[232:235], v[108:111]
    v_mfma_f32_16x16x32_bf16 v[136:139], a[112:115], v[236:239], v[136:139]
    s_waitcnt vmcnt(24)
    v_mfma_f32_16x16x32_bf16 v[56:59], a[116:119], v[224:227], v[56:59]
    v_mfma_f32_16x16x32_bf16 v[84:87], a[116:119], v[228:231], v[84:87]
    buffer_load_dwordx4 a[216:219], v13, s[8:11], s31 offen offset:2048
    v_mfma_f32_16x16x32_bf16 v[112:115], a[116:119], v[232:235], v[112:115]
    v_mfma_f32_16x16x32_bf16 v[140:143], a[116:119], v[236:239], v[140:143]
    s_waitcnt vmcnt(24)
    s_waitcnt lgkmcnt(0)
    v_mfma_f32_16x16x32_bf16 v[48:51], a[120:123], v[240:243], v[48:51]
    ds_read_b128 v[224:227], v2 offset:5120
    v_mfma_f32_16x16x32_bf16 v[76:79], a[120:123], v[244:247], v[76:79]
    ds_read_b128 v[228:231], v2 offset:12288
    buffer_load_dwordx4 a[220:223], v13, s[8:11], s31 offen offset:3072
    v_mfma_f32_16x16x32_bf16 v[104:107], a[120:123], v[248:251], v[104:107]
    ds_read_b128 v[232:235], v2 offset:19456
    v_mfma_f32_16x16x32_bf16 v[132:135], a[120:123], v[252:255], v[132:135]
    ds_read_b128 v[236:239], v2 offset:26624
    s_waitcnt vmcnt(24)
    v_mfma_f32_16x16x32_bf16 v[52:55], a[124:127], v[240:243], v[52:55]
    v_mfma_f32_16x16x32_bf16 v[80:83], a[124:127], v[244:247], v[80:83]
    s_mov_b32 s31, 7745536
    buffer_load_dwordx4 a[224:227], v13, s[8:11], s31 offen offset:0
    v_mfma_f32_16x16x32_bf16 v[108:111], a[124:127], v[248:251], v[108:111]
    v_mfma_f32_16x16x32_bf16 v[136:139], a[124:127], v[252:255], v[136:139]
    s_waitcnt vmcnt(24)
    v_mfma_f32_16x16x32_bf16 v[56:59], a[128:131], v[240:243], v[56:59]
    v_mfma_f32_16x16x32_bf16 v[84:87], a[128:131], v[244:247], v[84:87]
    buffer_load_dwordx4 a[228:231], v13, s[8:11], s31 offen offset:1024
    v_mfma_f32_16x16x32_bf16 v[112:115], a[128:131], v[248:251], v[112:115]
    v_mfma_f32_16x16x32_bf16 v[140:143], a[128:131], v[252:255], v[140:143]
    s_waitcnt vmcnt(24)
    s_waitcnt lgkmcnt(0)
    v_mfma_f32_16x16x32_bf16 v[48:51], a[132:135], v[224:227], v[48:51]
    ds_read_b128 v[240:243], v2 offset:6144
    v_mfma_f32_16x16x32_bf16 v[76:79], a[132:135], v[228:231], v[76:79]
    ds_read_b128 v[244:247], v2 offset:13312
    buffer_load_dwordx4 a[232:235], v13, s[8:11], s31 offen offset:2048
    v_mfma_f32_16x16x32_bf16 v[104:107], a[132:135], v[232:235], v[104:107]
    ds_read_b128 v[248:251], v2 offset:20480
    v_mfma_f32_16x16x32_bf16 v[132:135], a[132:135], v[236:239], v[132:135]
    ds_read_b128 v[252:255], v2 offset:27648
    s_waitcnt vmcnt(24)
    v_mfma_f32_16x16x32_bf16 v[52:55], a[136:139], v[224:227], v[52:55]
    v_mfma_f32_16x16x32_bf16 v[80:83], a[136:139], v[228:231], v[80:83]
    buffer_load_dwordx4 a[236:239], v13, s[8:11], s31 offen offset:3072
    v_mfma_f32_16x16x32_bf16 v[108:111], a[136:139], v[232:235], v[108:111]
    v_mfma_f32_16x16x32_bf16 v[136:139], a[136:139], v[236:239], v[136:139]
    s_waitcnt vmcnt(24)
    v_mfma_f32_16x16x32_bf16 v[56:59], a[140:143], v[224:227], v[56:59]
    v_mfma_f32_16x16x32_bf16 v[84:87], a[140:143], v[228:231], v[84:87]
    s_mov_b32 s31, 7749632
    buffer_load_dwordx4 a[240:243], v13, s[8:11], s31 offen offset:0
    v_mfma_f32_16x16x32_bf16 v[112:115], a[140:143], v[232:235], v[112:115]
    v_mfma_f32_16x16x32_bf16 v[140:143], a[140:143], v[236:239], v[140:143]
    s_waitcnt vmcnt(24)
    s_waitcnt lgkmcnt(0)
    v_mfma_f32_16x16x32_bf16 v[48:51], a[144:147], v[240:243], v[48:51]
    ds_read_b128 v[224:227], v3 offset:0
    v_mfma_f32_16x16x32_bf16 v[76:79], a[144:147], v[244:247], v[76:79]
    ds_read_b128 v[228:231], v3 offset:7168
    buffer_load_dwordx4 a[244:247], v13, s[8:11], s31 offen offset:1024
    v_mfma_f32_16x16x32_bf16 v[104:107], a[144:147], v[248:251], v[104:107]
    ds_read_b128 v[232:235], v3 offset:14336
    v_mfma_f32_16x16x32_bf16 v[132:135], a[144:147], v[252:255], v[132:135]
    ds_read_b128 v[236:239], v3 offset:21504
    s_waitcnt vmcnt(24)
    v_mfma_f32_16x16x32_bf16 v[52:55], a[148:151], v[240:243], v[52:55]
    v_mfma_f32_16x16x32_bf16 v[80:83], a[148:151], v[244:247], v[80:83]
    buffer_load_dwordx4 a[248:251], v13, s[8:11], s31 offen offset:2048
    v_mfma_f32_16x16x32_bf16 v[108:111], a[148:151], v[248:251], v[108:111]
    v_mfma_f32_16x16x32_bf16 v[136:139], a[148:151], v[252:255], v[136:139]
    s_waitcnt vmcnt(24)
    v_mfma_f32_16x16x32_bf16 v[56:59], a[152:155], v[240:243], v[56:59]
    v_mfma_f32_16x16x32_bf16 v[84:87], a[152:155], v[244:247], v[84:87]
    v_mfma_f32_16x16x32_bf16 v[112:115], a[152:155], v[248:251], v[112:115]
    v_mfma_f32_16x16x32_bf16 v[140:143], a[152:155], v[252:255], v[140:143]
    s_waitcnt vmcnt(23)
    s_waitcnt lgkmcnt(0)
    v_mfma_f32_16x16x32_bf16 v[60:63], a[156:159], v[224:227], v[60:63]
    ds_read_b128 v[240:243], v4 offset:0
    v_mfma_f32_16x16x32_bf16 v[88:91], a[156:159], v[228:231], v[88:91]
    ds_read_b128 v[244:247], v4 offset:7168
    v_mfma_f32_16x16x32_bf16 v[116:119], a[156:159], v[232:235], v[116:119]
    ds_read_b128 v[248:251], v4 offset:14336
    v_mfma_f32_16x16x32_bf16 v[144:147], a[156:159], v[236:239], v[144:147]
    ds_read_b128 v[252:255], v4 offset:21504
    s_waitcnt vmcnt(22)
    v_mfma_f32_16x16x32_bf16 v[64:67], a[160:163], v[224:227], v[64:67]
    v_cvt_pk_bf16_f32 v48, v48, v49
    v_mfma_f32_16x16x32_bf16 v[92:95], a[160:163], v[228:231], v[92:95]
    v_cvt_pk_bf16_f32 v49, v50, v51
    v_mfma_f32_16x16x32_bf16 v[120:123], a[160:163], v[232:235], v[120:123]
    v_cvt_pk_bf16_f32 v50, v76, v77
    v_mfma_f32_16x16x32_bf16 v[148:151], a[160:163], v[236:239], v[148:151]
    v_cvt_pk_bf16_f32 v51, v78, v79
    s_waitcnt vmcnt(21)
    s_waitcnt lgkmcnt(0)
    v_mfma_f32_16x16x32_bf16 v[60:63], a[164:167], v[240:243], v[60:63]
    ds_read_b128 v[224:227], v5 offset:0
    buffer_store_dwordx4 v[48:51], v9, s[8:11], s38 offen offset:0 sc1
    v_mfma_f32_16x16x32_bf16 v[88:91], a[164:167], v[244:247], v[88:91]
    ds_read_b128 v[228:231], v5 offset:7168
    s_mov_b64 exec, s[44:45]
    ds_write_b128 v220, v[48:51] offset:0
    s_mov_b64 exec, -1
    v_mfma_f32_16x16x32_bf16 v[116:119], a[164:167], v[248:251], v[116:119]
    ds_read_b128 v[232:235], v5 offset:14336
    v_cvt_pk_bf16_f32 v104, v104, v105
    v_mfma_f32_16x16x32_bf16 v[144:147], a[164:167], v[252:255], v[144:147]
    ds_read_b128 v[236:239], v5 offset:21504
    v_cvt_pk_bf16_f32 v105, v106, v107
    s_waitcnt vmcnt(21)
    v_mfma_f32_16x16x32_bf16 v[64:67], a[168:171], v[240:243], v[64:67]
    v_cvt_pk_bf16_f32 v106, v132, v133
    v_mfma_f32_16x16x32_bf16 v[92:95], a[168:171], v[244:247], v[92:95]
    v_cvt_pk_bf16_f32 v107, v134, v135
    v_mfma_f32_16x16x32_bf16 v[120:123], a[168:171], v[248:251], v[120:123]
    buffer_store_dwordx4 v[104:107], v218, s[8:11], s39 offen offset:0 sc1
    v_mfma_f32_16x16x32_bf16 v[148:151], a[168:171], v[252:255], v[148:151]
    s_mov_b64 exec, s[46:47]
    ds_write_b128 v220, v[104:107] offset:0
    s_mov_b64 exec, -1
    s_waitcnt vmcnt(21)
    s_waitcnt lgkmcnt(1)
    v_mfma_f32_16x16x32_bf16 v[60:63], a[172:175], v[224:227], v[60:63]
    ds_read_b128 v[240:243], v2 offset:4096
    v_cvt_pk_bf16_f32 v52, v52, v53
    v_mfma_f32_16x16x32_bf16 v[88:91], a[172:175], v[228:231], v[88:91]
    ds_read_b128 v[244:247], v2 offset:11264
    v_cvt_pk_bf16_f32 v53, v54, v55
    v_mfma_f32_16x16x32_bf16 v[116:119], a[172:175], v[232:235], v[116:119]
    ds_read_b128 v[248:251], v2 offset:18432
    v_cvt_pk_bf16_f32 v54, v80, v81
    v_mfma_f32_16x16x32_bf16 v[144:147], a[172:175], v[236:239], v[144:147]
    ds_read_b128 v[252:255], v2 offset:25600
    v_cvt_pk_bf16_f32 v55, v82, v83
    s_waitcnt vmcnt(20)
    v_mfma_f32_16x16x32_bf16 v[64:67], a[176:179], v[224:227], v[64:67]
    buffer_store_dwordx4 v[52:55], v9, s[8:11], s38 offen offset:256 sc1
    v_mfma_f32_16x16x32_bf16 v[92:95], a[176:179], v[228:231], v[92:95]
    s_mov_b64 exec, s[44:45]
    ds_write_b128 v220, v[52:55] offset:256
    s_mov_b64 exec, -1
    v_mfma_f32_16x16x32_bf16 v[120:123], a[176:179], v[232:235], v[120:123]
    v_cvt_pk_bf16_f32 v108, v108, v109
    v_mfma_f32_16x16x32_bf16 v[148:151], a[176:179], v[236:239], v[148:151]
    v_cvt_pk_bf16_f32 v109, v110, v111
    s_waitcnt vmcnt(20)
    s_waitcnt lgkmcnt(1)
    v_mfma_f32_16x16x32_bf16 v[60:63], a[180:183], v[240:243], v[60:63]
    ds_read_b128 v[224:227], v2 offset:5120
    v_cvt_pk_bf16_f32 v110, v136, v137
    v_mfma_f32_16x16x32_bf16 v[88:91], a[180:183], v[244:247], v[88:91]
    ds_read_b128 v[228:231], v2 offset:12288
    v_cvt_pk_bf16_f32 v111, v138, v139
    v_mfma_f32_16x16x32_bf16 v[116:119], a[180:183], v[248:251], v[116:119]
    ds_read_b128 v[232:235], v2 offset:19456
    buffer_store_dwordx4 v[108:111], v218, s[8:11], s39 offen offset:256 sc1
    v_mfma_f32_16x16x32_bf16 v[144:147], a[180:183], v[252:255], v[144:147]
    ds_read_b128 v[236:239], v2 offset:26624
    s_mov_b64 exec, s[46:47]
    ds_write_b128 v220, v[108:111] offset:256
    s_mov_b64 exec, -1
    s_waitcnt vmcnt(20)
    v_mfma_f32_16x16x32_bf16 v[64:67], a[184:187], v[240:243], v[64:67]
    v_cvt_pk_bf16_f32 v56, v56, v57
    v_mfma_f32_16x16x32_bf16 v[92:95], a[184:187], v[244:247], v[92:95]
    v_cvt_pk_bf16_f32 v57, v58, v59
    v_mfma_f32_16x16x32_bf16 v[120:123], a[184:187], v[248:251], v[120:123]
    v_cvt_pk_bf16_f32 v58, v84, v85
    v_mfma_f32_16x16x32_bf16 v[148:151], a[184:187], v[252:255], v[148:151]
    v_cvt_pk_bf16_f32 v59, v86, v87
    s_waitcnt vmcnt(19)
    s_waitcnt lgkmcnt(1)
    v_mfma_f32_16x16x32_bf16 v[60:63], a[188:191], v[224:227], v[60:63]
    ds_read_b128 v[240:243], v2 offset:6144
    buffer_store_dwordx4 v[56:59], v9, s[8:11], s38 offen offset:512 sc1
    v_mfma_f32_16x16x32_bf16 v[88:91], a[188:191], v[228:231], v[88:91]
    ds_read_b128 v[244:247], v2 offset:13312
    s_mov_b64 exec, s[44:45]
    ds_write_b128 v220, v[56:59] offset:512
    s_mov_b64 exec, -1
    v_mfma_f32_16x16x32_bf16 v[116:119], a[188:191], v[232:235], v[116:119]
    ds_read_b128 v[248:251], v2 offset:20480
    v_cvt_pk_bf16_f32 v112, v112, v113
    v_mfma_f32_16x16x32_bf16 v[144:147], a[188:191], v[236:239], v[144:147]
    ds_read_b128 v[252:255], v2 offset:27648
    v_cvt_pk_bf16_f32 v113, v114, v115
    s_waitcnt vmcnt(19)
    v_mfma_f32_16x16x32_bf16 v[64:67], a[192:195], v[224:227], v[64:67]
    v_cvt_pk_bf16_f32 v114, v140, v141
    v_mfma_f32_16x16x32_bf16 v[92:95], a[192:195], v[228:231], v[92:95]
    v_cvt_pk_bf16_f32 v115, v142, v143
    v_mfma_f32_16x16x32_bf16 v[120:123], a[192:195], v[232:235], v[120:123]
    buffer_store_dwordx4 v[112:115], v218, s[8:11], s39 offen offset:512 sc1
    v_mfma_f32_16x16x32_bf16 v[148:151], a[192:195], v[236:239], v[148:151]
    s_mov_b64 exec, s[46:47]
    ds_write_b128 v220, v[112:115] offset:512
    s_mov_b64 exec, -1
    s_waitcnt vmcnt(19)
    s_waitcnt lgkmcnt(1)
    v_mfma_f32_16x16x32_bf16 v[60:63], a[196:199], v[240:243], v[60:63]
    ds_read_b128 v[224:227], v3 offset:0
    v_mfma_f32_16x16x32_bf16 v[88:91], a[196:199], v[244:247], v[88:91]
    ds_read_b128 v[228:231], v3 offset:7168
    v_mfma_f32_16x16x32_bf16 v[116:119], a[196:199], v[248:251], v[116:119]
    ds_read_b128 v[232:235], v3 offset:14336
    v_mfma_f32_16x16x32_bf16 v[144:147], a[196:199], v[252:255], v[144:147]
    ds_read_b128 v[236:239], v3 offset:21504
    s_waitcnt vmcnt(18)
    v_mfma_f32_16x16x32_bf16 v[64:67], a[200:203], v[240:243], v[64:67]
    v_mfma_f32_16x16x32_bf16 v[92:95], a[200:203], v[244:247], v[92:95]
    v_mfma_f32_16x16x32_bf16 v[120:123], a[200:203], v[248:251], v[120:123]
    v_mfma_f32_16x16x32_bf16 v[148:151], a[200:203], v[252:255], v[148:151]
    s_waitcnt vmcnt(17)
    s_waitcnt lgkmcnt(0)
    v_mfma_f32_16x16x32_bf16 v[68:71], a[204:207], v[224:227], v[68:71]
    ds_read_b128 v[240:243], v4 offset:0
    v_mfma_f32_16x16x32_bf16 v[96:99], a[204:207], v[228:231], v[96:99]
    ds_read_b128 v[244:247], v4 offset:7168
    v_mfma_f32_16x16x32_bf16 v[124:127], a[204:207], v[232:235], v[124:127]
    ds_read_b128 v[248:251], v4 offset:14336
    v_mfma_f32_16x16x32_bf16 v[152:155], a[204:207], v[236:239], v[152:155]
    ds_read_b128 v[252:255], v4 offset:21504
    s_waitcnt vmcnt(16)
    v_mfma_f32_16x16x32_bf16 v[72:75], a[208:211], v[224:227], v[72:75]
    v_cvt_pk_bf16_f32 v60, v60, v61
    v_mfma_f32_16x16x32_bf16 v[100:103], a[208:211], v[228:231], v[100:103]
    v_cvt_pk_bf16_f32 v61, v62, v63
    v_mfma_f32_16x16x32_bf16 v[128:131], a[208:211], v[232:235], v[128:131]
    v_cvt_pk_bf16_f32 v62, v88, v89
    v_mfma_f32_16x16x32_bf16 v[156:159], a[208:211], v[236:239], v[156:159]
    v_cvt_pk_bf16_f32 v63, v90, v91
    s_waitcnt vmcnt(15)
    s_waitcnt lgkmcnt(0)
    v_mfma_f32_16x16x32_bf16 v[68:71], a[212:215], v[240:243], v[68:71]
    ds_read_b128 v[224:227], v5 offset:0
    buffer_store_dwordx4 v[60:63], v9, s[8:11], s38 offen offset:768 sc1
    v_mfma_f32_16x16x32_bf16 v[96:99], a[212:215], v[244:247], v[96:99]
    ds_read_b128 v[228:231], v5 offset:7168
    s_mov_b64 exec, s[44:45]
    ds_write_b128 v220, v[60:63] offset:768
    s_mov_b64 exec, -1
    v_mfma_f32_16x16x32_bf16 v[124:127], a[212:215], v[248:251], v[124:127]
    ds_read_b128 v[232:235], v5 offset:14336
    v_cvt_pk_bf16_f32 v116, v116, v117
    v_mfma_f32_16x16x32_bf16 v[152:155], a[212:215], v[252:255], v[152:155]
    ds_read_b128 v[236:239], v5 offset:21504
    v_cvt_pk_bf16_f32 v117, v118, v119
    s_waitcnt vmcnt(15)
    v_mfma_f32_16x16x32_bf16 v[72:75], a[216:219], v[240:243], v[72:75]
    v_cvt_pk_bf16_f32 v118, v144, v145
    v_mfma_f32_16x16x32_bf16 v[100:103], a[216:219], v[244:247], v[100:103]
    v_cvt_pk_bf16_f32 v119, v146, v147
    v_mfma_f32_16x16x32_bf16 v[128:131], a[216:219], v[248:251], v[128:131]
    buffer_store_dwordx4 v[116:119], v218, s[8:11], s39 offen offset:768 sc1
    v_mfma_f32_16x16x32_bf16 v[156:159], a[216:219], v[252:255], v[156:159]
    s_mov_b64 exec, s[46:47]
    ds_write_b128 v220, v[116:119] offset:768
    s_mov_b64 exec, -1
    s_waitcnt vmcnt(15)
    s_waitcnt lgkmcnt(1)
    v_mfma_f32_16x16x32_bf16 v[68:71], a[220:223], v[224:227], v[68:71]
    ds_read_b128 v[240:243], v2 offset:4096
    v_cvt_pk_bf16_f32 v64, v64, v65
    v_mfma_f32_16x16x32_bf16 v[96:99], a[220:223], v[228:231], v[96:99]
    ds_read_b128 v[244:247], v2 offset:11264
    v_cvt_pk_bf16_f32 v65, v66, v67
    v_mfma_f32_16x16x32_bf16 v[124:127], a[220:223], v[232:235], v[124:127]
    ds_read_b128 v[248:251], v2 offset:18432
    v_cvt_pk_bf16_f32 v66, v92, v93
    v_mfma_f32_16x16x32_bf16 v[152:155], a[220:223], v[236:239], v[152:155]
    ds_read_b128 v[252:255], v2 offset:25600
    v_cvt_pk_bf16_f32 v67, v94, v95
    s_waitcnt vmcnt(14)
    v_mfma_f32_16x16x32_bf16 v[72:75], a[224:227], v[224:227], v[72:75]
    buffer_store_dwordx4 v[64:67], v9, s[8:11], s38 offen offset:1024 sc1
    v_mfma_f32_16x16x32_bf16 v[100:103], a[224:227], v[228:231], v[100:103]
    s_mov_b64 exec, s[44:45]
    ds_write_b128 v220, v[64:67] offset:1024
    s_mov_b64 exec, -1
    v_mfma_f32_16x16x32_bf16 v[128:131], a[224:227], v[232:235], v[128:131]
    v_cvt_pk_bf16_f32 v120, v120, v121
    v_mfma_f32_16x16x32_bf16 v[156:159], a[224:227], v[236:239], v[156:159]
    v_cvt_pk_bf16_f32 v121, v122, v123
    s_waitcnt vmcnt(14)
    s_waitcnt lgkmcnt(1)
    v_mfma_f32_16x16x32_bf16 v[68:71], a[228:231], v[240:243], v[68:71]
    ds_read_b128 v[224:227], v2 offset:5120
    v_cvt_pk_bf16_f32 v122, v148, v149
    v_mfma_f32_16x16x32_bf16 v[96:99], a[228:231], v[244:247], v[96:99]
    ds_read_b128 v[228:231], v2 offset:12288
    v_cvt_pk_bf16_f32 v123, v150, v151
    v_mfma_f32_16x16x32_bf16 v[124:127], a[228:231], v[248:251], v[124:127]
    ds_read_b128 v[232:235], v2 offset:19456
    buffer_store_dwordx4 v[120:123], v218, s[8:11], s39 offen offset:1024 sc1
    v_mfma_f32_16x16x32_bf16 v[152:155], a[228:231], v[252:255], v[152:155]
    ds_read_b128 v[236:239], v2 offset:26624
    s_mov_b64 exec, s[46:47]
    ds_write_b128 v220, v[120:123] offset:1024
    s_mov_b64 exec, -1
    s_waitcnt vmcnt(14)
    v_mfma_f32_16x16x32_bf16 v[72:75], a[232:235], v[240:243], v[72:75]
    v_mfma_f32_16x16x32_bf16 v[100:103], a[232:235], v[244:247], v[100:103]
    v_mfma_f32_16x16x32_bf16 v[128:131], a[232:235], v[248:251], v[128:131]
    v_mfma_f32_16x16x32_bf16 v[156:159], a[232:235], v[252:255], v[156:159]
    s_waitcnt vmcnt(13)
    s_waitcnt lgkmcnt(1)
    v_mfma_f32_16x16x32_bf16 v[68:71], a[236:239], v[224:227], v[68:71]
    ds_read_b128 v[240:243], v2 offset:6144
    v_mfma_f32_16x16x32_bf16 v[96:99], a[236:239], v[228:231], v[96:99]
    ds_read_b128 v[244:247], v2 offset:13312
    v_mfma_f32_16x16x32_bf16 v[124:127], a[236:239], v[232:235], v[124:127]
    ds_read_b128 v[248:251], v2 offset:20480
    v_mfma_f32_16x16x32_bf16 v[152:155], a[236:239], v[236:239], v[152:155]
    ds_read_b128 v[252:255], v2 offset:27648
    s_waitcnt vmcnt(12)
    v_mfma_f32_16x16x32_bf16 v[72:75], a[240:243], v[224:227], v[72:75]
    v_mfma_f32_16x16x32_bf16 v[100:103], a[240:243], v[228:231], v[100:103]
    v_mfma_f32_16x16x32_bf16 v[128:131], a[240:243], v[232:235], v[128:131]
    v_mfma_f32_16x16x32_bf16 v[156:159], a[240:243], v[236:239], v[156:159]
    s_waitcnt vmcnt(11)
    s_waitcnt lgkmcnt(0)
    v_mfma_f32_16x16x32_bf16 v[68:71], a[244:247], v[240:243], v[68:71]
    v_mfma_f32_16x16x32_bf16 v[96:99], a[244:247], v[244:247], v[96:99]
    v_mfma_f32_16x16x32_bf16 v[124:127], a[244:247], v[248:251], v[124:127]
    v_mfma_f32_16x16x32_bf16 v[152:155], a[244:247], v[252:255], v[152:155]
    s_waitcnt vmcnt(10)
    v_mfma_f32_16x16x32_bf16 v[72:75], a[248:251], v[240:243], v[72:75]
    s_nop 2
    v_cvt_pk_bf16_f32 v68, v68, v69
    v_cvt_pk_bf16_f32 v69, v70, v71
    v_mfma_f32_16x16x32_bf16 v[100:103], a[248:251], v[244:247], v[100:103]
    v_cvt_pk_bf16_f32 v70, v96, v97
    v_cvt_pk_bf16_f32 v71, v98, v99
    v_mfma_f32_16x16x32_bf16 v[128:131], a[248:251], v[248:251], v[128:131]
    buffer_store_dwordx4 v[68:71], v9, s[8:11], s38 offen offset:1280 sc1
    s_mov_b64 exec, s[44:45]
    ds_write_b128 v220, v[68:71] offset:1280
    s_mov_b64 exec, -1
    v_mfma_f32_16x16x32_bf16 v[156:159], a[248:251], v[252:255], v[156:159]
    v_cvt_pk_bf16_f32 v124, v124, v125
    v_cvt_pk_bf16_f32 v125, v126, v127
L_x0:
    v_cvt_pk_bf16_f32 v126, v152, v153
    v_cvt_pk_bf16_f32 v127, v154, v155
    buffer_store_dwordx4 v[124:127], v218, s[8:11], s39 offen offset:1280 sc1
    s_mov_b64 exec, s[46:47]
    ds_write_b128 v220, v[124:127] offset:1280
    s_mov_b64 exec, -1
    v_cvt_pk_bf16_f32 v72, v72, v73
    v_cvt_pk_bf16_f32 v73, v74, v75
    v_cvt_pk_bf16_f32 v74, v100, v101
    v_cvt_pk_bf16_f32 v75, v102, v103
    buffer_store_dwordx4 v[72:75], v9, s[8:11], s38 offen offset:1536 sc1
    s_mov_b64 exec, s[44:45]
    ds_write_b128 v220, v[72:75] offset:1536
    s_mov_b64 exec, -1
    v_cvt_pk_bf16_f32 v128, v128, v129
    v_cvt_pk_bf16_f32 v129, v130, v131
    v_cvt_pk_bf16_f32 v130, v156, v157
    v_cvt_pk_bf16_f32 v131, v158, v159
    buffer_store_dwordx4 v[128:131], v218, s[8:11], s39 offen offset:1536 sc1
    s_mov_b64 exec, s[46:47]
    ds_write_b128 v220, v[128:131] offset:1536
    s_mov_b64 exec, -1
    s_mov_b32 s33, 28672
    s_lshl_b32 s26, s22, 11
    s_add_u32 s26, s26, 146944
    v_lshrrev_b32 v220, 8, v1
    v_lshl_add_u32 v220, v220, 8, v1
    v_add_u32 v220, s26, v220
    s_waitcnt lgkmcnt(0)
    s_barrier
    ds_read_b128 v[104:107], v220 offset:0
    ds_read_b128 v[108:111], v220 offset:256
    s_waitcnt vmcnt(0)
    s_mov_b64 exec, 1
    buffer_store_dword v43, v14, s[8:11], s33 offen offset:0
    s_mov_b64 exec, -1
    s_waitcnt lgkmcnt(1)
    v_dot2_f32_bf16 v16, v104, s40, v16
    v_dot2_f32_bf16 v17, v104, s41, v17
    v_dot2_f32_bf16 v18, v105, s40, v18
    v_dot2_f32_bf16 v19, v105, s41, v19
    v_dot2_f32_bf16 v24, v106, s40, v24
    v_dot2_f32_bf16 v25, v106, s41, v25
    v_dot2_f32_bf16 v26, v107, s40, v26
    v_dot2_f32_bf16 v27, v107, s41, v27
    s_waitcnt lgkmcnt(0)
    v_dot2_f32_bf16 v20, v108, s40, v20
    v_dot2_f32_bf16 v21, v108, s41, v21
    v_dot2_f32_bf16 v22, v109, s40, v22
    v_dot2_f32_bf16 v23, v109, s41, v23
    v_dot2_f32_bf16 v28, v110, s40, v28
    v_dot2_f32_bf16 v29, v110, s41, v29
    v_dot2_f32_bf16 v30, v111, s40, v30
    v_dot2_f32_bf16 v31, v111, s41, v31
    v_lshlrev_b32 v112, 16, v32
    v_and_b32 v120, 0xffff0000, v32
    v_lshlrev_b32 v113, 16, v33
    v_and_b32 v121, 0xffff0000, v33
    v_lshlrev_b32 v114, 16, v34
    v_and_b32 v122, 0xffff0000, v34
    v_lshlrev_b32 v115, 16, v35
    v_and_b32 v123, 0xffff0000, v35
    v_lshlrev_b32 v116, 16, v36
    v_and_b32 v124, 0xffff0000, v36
    v_lshlrev_b32 v117, 16, v37
    v_and_b32 v125, 0xffff0000, v37
    v_lshlrev_b32 v118, 16, v38
    v_and_b32 v126, 0xffff0000, v38
    v_lshlrev_b32 v119, 16, v39
    v_and_b32 v127, 0xffff0000, v39
    s_mov_b32 s34, 0
    buffer_load_dword v42, v15, s[8:11], s33 offen sc1
L_pp_4:
    buffer_load_dword v47, v15, s[8:11], s33 offen sc1
    s_waitcnt vmcnt(1)
    v_and_b32 v46, -16, v42
    v_cmp_ne_u32 vcc, s42, v46
    s_cbranch_vccz L_pp_4_x
    buffer_load_dword v42, v15, s[8:11], s33 offen sc1
    s_waitcnt vmcnt(1)
    v_and_b32 v46, -16, v47
    v_cmp_ne_u32 vcc, s42, v46
    s_cbranch_vccz L_pp_4_x
    s_add_u32 s34, s34, 1
    s_cmp_lt_u32 s34, 1048576
    s_cbranch_scc1 L_pp_4
L_pp_4_x:
    s_mov_b32 s33, 18874368
    buffer_load_dwordx4 v[48:51], v10, s[8:11], s33 offen offset:0 sc1
    buffer_load_dwordx4 v[52:55], v10, s[8:11], s33 offen offset:256 sc1
    s_mov_b32 s33, 18881536
    buffer_load_dwordx4 v[56:59], v10, s[8:11], s33 offen offset:0 sc1
    buffer_load_dwordx4 v[60:63], v10, s[8:11], s33 offen offset:256 sc1
    s_mov_b32 s33, 18888704
    buffer_load_dwordx4 v[64:67], v10, s[8:11], s33 offen offset:0 sc1
    buffer_load_dwordx4 v[68:71], v10, s[8:11], s33 offen offset:256 sc1
    s_mov_b32 s33, 18895872
    buffer_load_dwordx4 v[72:75], v10, s[8:11], s33 offen offset:0 sc1
    buffer_load_dwordx4 v[76:79], v10, s[8:11], s33 offen offset:256 sc1
    s_mov_b32 s33, 18903040
    buffer_load_dwordx4 v[80:83], v10, s[8:11], s33 offen offset:0 sc1
    buffer_load_dwordx4 v[84:87], v10, s[8:11], s33 offen offset:256 sc1
    s_mov_b32 s33, 18910208
    buffer_load_dwordx4 v[88:91], v10, s[8:11], s33 offen offset:0 sc1
    buffer_load_dwordx4 v[92:95], v10, s[8:11], s33 offen offset:256 sc1
    s_mov_b32 s33, 18917376
    buffer_load_dwordx4 v[96:99], v10, s[8:11], s33 offen offset:0 sc1
    buffer_load_dwordx4 v[100:103], v10, s[8:11], s33 offen offset:256 sc1
    s_waitcnt vmcnt(13)
    v_dot2_f32_bf16 v16, v48, s40, v16
    v_dot2_f32_bf16 v17, v48, s41, v17
    v_dot2_f32_bf16 v18, v49, s40, v18
    v_dot2_f32_bf16 v19, v49, s41, v19
    v_dot2_f32_bf16 v24, v50, s40, v24
    v_dot2_f32_bf16 v25, v50, s41, v25
    v_dot2_f32_bf16 v26, v51, s40, v26
    v_dot2_f32_bf16 v27, v51, s41, v27
    s_waitcnt vmcnt(12)
    v_dot2_f32_bf16 v20, v52, s40, v20
    v_dot2_f32_bf16 v21, v52, s41, v21
    v_dot2_f32_bf16 v22, v53, s40, v22
    v_dot2_f32_bf16 v23, v53, s41, v23
    v_dot2_f32_bf16 v28, v54, s40, v28
    v_dot2_f32_bf16 v29, v54, s41, v29
    v_dot2_f32_bf16 v30, v55, s40, v30
    v_dot2_f32_bf16 v31, v55, s41, v31
    s_waitcnt vmcnt(11)
    v_dot2_f32_bf16 v16, v56, s40, v16
    v_dot2_f32_bf16 v17, v56, s41, v17
    v_dot2_f32_bf16 v18, v57, s40, v18
    v_dot2_f32_bf16 v19, v57, s41, v19
    v_dot2_f32_bf16 v24, v58, s40, v24
    v_dot2_f32_bf16 v25, v58, s41, v25
    v_dot2_f32_bf16 v26, v59, s40, v26
    v_dot2_f32_bf16 v27, v59, s41, v27
    s_waitcnt vmcnt(10)
    v_dot2_f32_bf16 v20, v60, s40, v20
    v_dot2_f32_bf16 v21, v60, s41, v21
    v_dot2_f32_bf16 v22, v61, s40, v22
    v_dot2_f32_bf16 v23, v61, s41, v23
    v_dot2_f32_bf16 v28, v62, s40, v28
    v_dot2_f32_bf16 v29, v62, s41, v29
    v_dot2_f32_bf16 v30, v63, s40, v30
    v_dot2_f32_bf16 v31, v63, s41, v31
    s_waitcnt vmcnt(9)
    v_dot2_f32_bf16 v16, v64, s40, v16
    v_dot2_f32_bf16 v17, v64, s41, v17
    v_dot2_f32_bf16 v18, v65, s40, v18
    v_dot2_f32_bf16 v19, v65, s41, v19
    v_dot2_f32_bf16 v24, v66, s40, v24
    v_dot2_f32_bf16 v25, v66, s41, v25
    v_dot2_f32_bf16 v26, v67, s40, v26
    v_dot2_f32_bf16 v27, v67, s41, v27
    s_waitcnt vmcnt(8)
    v_dot2_f32_bf16 v20, v68, s40, v20
    v_dot2_f32_bf16 v21, v68, s41, v21
    v_dot2_f32_bf16 v22, v69, s40, v22
    v_dot2_f32_bf16 v23, v69, s41, v23
    v_dot2_f32_bf16 v28, v70, s40, v28
    v_dot2_f32_bf16 v29, v70, s41, v29
    v_dot2_f32_bf16 v30, v71, s40, v30
    v_dot2_f32_bf16 v31, v71, s41, v31
    s_waitcnt vmcnt(7)
    v_dot2_f32_bf16 v16, v72, s40, v16
    v_dot2_f32_bf16 v17, v72, s41, v17
    v_dot2_f32_bf16 v18, v73, s40, v18
    v_dot2_f32_bf16 v19, v73, s41, v19
    v_dot2_f32_bf16 v24, v74, s40, v24
    v_dot2_f32_bf16 v25, v74, s41, v25
    v_dot2_f32_bf16 v26, v75, s40, v26
    v_dot2_f32_bf16 v27, v75, s41, v27
    s_waitcnt vmcnt(6)
    v_dot2_f32_bf16 v20, v76, s40, v20
    v_dot2_f32_bf16 v21, v76, s41, v21
    v_dot2_f32_bf16 v22, v77, s40, v22
    v_dot2_f32_bf16 v23, v77, s41, v23
    v_dot2_f32_bf16 v28, v78, s40, v28
    v_dot2_f32_bf16 v29, v78, s41, v29
    v_dot2_f32_bf16 v30, v79, s40, v30
    v_dot2_f32_bf16 v31, v79, s41, v31
    s_waitcnt vmcnt(5)
    v_dot2_f32_bf16 v16, v80, s40, v16
    v_dot2_f32_bf16 v17, v80, s41, v17
    v_dot2_f32_bf16 v18, v81, s40, v18
    v_dot2_f32_bf16 v19, v81, s41, v19
    v_dot2_f32_bf16 v24, v82, s40, v24
    v_dot2_f32_bf16 v25, v82, s41, v25
    v_dot2_f32_bf16 v26, v83, s40, v26
    v_dot2_f32_bf16 v27, v83, s41, v27
    s_waitcnt vmcnt(4)
    v_dot2_f32_bf16 v20, v84, s40, v20
    v_dot2_f32_bf16 v21, v84, s41, v21
    v_dot2_f32_bf16 v22, v85, s40, v22
    v_dot2_f32_bf16 v23, v85, s41, v23
    v_dot2_f32_bf16 v28, v86, s40, v28
    v_dot2_f32_bf16 v29, v86, s41, v29
    v_dot2_f32_bf16 v30, v87, s40, v30
    v_dot2_f32_bf16 v31, v87, s41, v31
    s_waitcnt vmcnt(3)
    v_dot2_f32_bf16 v16, v88, s40, v16
    v_dot2_f32_bf16 v17, v88, s41, v17
    v_dot2_f32_bf16 v18, v89, s40, v18
    v_dot2_f32_bf16 v19, v89, s41, v19
    v_dot2_f32_bf16 v24, v90, s40, v24
    v_dot2_f32_bf16 v25, v90, s41, v25
    v_dot2_f32_bf16 v26, v91, s40, v26
    v_dot2_f32_bf16 v27, v91, s41, v27
    s_waitcnt vmcnt(2)
    v_dot2_f32_bf16 v20, v92, s40, v20
    v_dot2_f32_bf16 v21, v92, s41, v21
    v_dot2_f32_bf16 v22, v93, s40, v22
    v_dot2_f32_bf16 v23, v93, s41, v23
    v_dot2_f32_bf16 v28, v94, s40, v28
    v_dot2_f32_bf16 v29, v94, s41, v29
    v_dot2_f32_bf16 v30, v95, s40, v30
    v_dot2_f32_bf16 v31, v95, s41, v31
    s_waitcnt vmcnt(1)
    v_dot2_f32_bf16 v16, v96, s40, v16
    v_dot2_f32_bf16 v17, v96, s41, v17
    v_dot2_f32_bf16 v18, v97, s40, v18
    v_dot2_f32_bf16 v19, v97, s41, v19
    v_dot2_f32_bf16 v24, v98, s40, v24
    v_dot2_f32_bf16 v25, v98, s41, v25
    v_dot2_f32_bf16 v26, v99, s40, v26
    v_dot2_f32_bf16 v27, v99, s41, v27
    s_waitcnt vmcnt(0)
    v_dot2_f32_bf16 v20, v100, s40, v20
    v_dot2_f32_bf16 v21, v100, s41, v21
    v_dot2_f32_bf16 v22, v101, s40, v22
    v_dot2_f32_bf16 v23, v101, s41, v23
    v_dot2_f32_bf16 v28, v102, s40, v28
    v_dot2_f32_bf16 v29, v102, s41, v29
    v_dot2_f32_bf16 v30, v103, s40, v30
    v_dot2_f32_bf16 v31, v103, s41, v31
    s_add_u32 s51, s50, L_g11-interleave_layers__ssm_conv_h3__glu_gated_bilinear__prompt_kernel
    buffer_load_dword v46, off, s[4:7], s51
    v_pk_add_f32 v[56:57], v[16:17], v[18:19]
    v_pk_mul_f32 v[58:59], v[16:17], v[16:17]
    v_pk_add_f32 v[56:57], v[56:57], v[20:21]
    v_pk_fma_f32 v[58:59], v[18:19], v[18:19], v[58:59]
    v_pk_add_f32 v[56:57], v[56:57], v[22:23]
    v_pk_fma_f32 v[58:59], v[20:21], v[20:21], v[58:59]
    v_add_f32 v56, v56, v57
    v_pk_fma_f32 v[58:59], v[22:23], v[22:23], v[58:59]
    v_pk_add_f32 v[60:61], v[24:25], v[26:27]
    v_pk_mul_f32 v[62:63], v[24:25], v[24:25]
    v_pk_add_f32 v[60:61], v[60:61], v[28:29]
    v_pk_fma_f32 v[62:63], v[26:27], v[26:27], v[62:63]
    v_pk_add_f32 v[60:61], v[60:61], v[30:31]
    v_pk_fma_f32 v[62:63], v[28:29], v[28:29], v[62:63]
    v_add_f32 v60, v60, v61
    v_pk_fma_f32 v[62:63], v[30:31], v[30:31], v[62:63]
    v_add_f32 v58, v58, v59
    v_add_f32 v62, v62, v63
    v_permlane32_swap_b32 v56, v60
    s_nop 0
    v_permlane32_swap_b32 v58, v62
    v_add_f32 v56, v56, v60
    v_add_f32 v58, v58, v62
    s_nop 1
    v_permlane16_swap_b32 v56, v58
    v_add_f32 v56, v56, v58
    s_nop 1
    v_add_f32_dpp v56, v56, v56 row_ror:4 row_mask:0xf bank_mask:0xf
    s_nop 1
    v_add_f32_dpp v56, v56, v56 row_ror:8 row_mask:0xf bank_mask:0xf
    ds_write_b32 v40, v56 offset:512
    s_waitcnt lgkmcnt(0)
    s_barrier
    ds_read_b128 v[56:59], v41 offset:512
    ds_read_b128 v[60:63], v41 offset:528
    ds_read_b128 v[64:67], v41 offset:544
    ds_read_b128 v[68:71], v41 offset:560
    s_waitcnt lgkmcnt(2)
    v_pk_add_f32 v[56:57], v[56:57], v[58:59]
    v_pk_add_f32 v[60:61], v[60:61], v[62:63]
    v_add_f32 v56, v56, v57
    v_add_f32 v60, v60, v61
    s_waitcnt lgkmcnt(0)
    v_pk_add_f32 v[64:65], v[64:65], v[66:67]
    v_pk_add_f32 v[68:69], v[68:69], v[70:71]
    v_add_f32 v64, v64, v65
    v_add_f32 v68, v68, v69
    v_mul_f32 v56, s36, v56
    v_fma_f32 v60, v60, s36, v44
    v_mul_f32 v64, s36, v64
    v_fma_f32 v68, v68, s36, v44
    v_fma_f32 v60, -v56, v56, v60
    v_fma_f32 v68, -v64, v64, v68
    v_max_f32 v60, v60, v44
    v_max_f32 v68, v68, v44
    v_rsq_f32 v48, v60
    v_rsq_f32 v52, v68
    v_mul_f32_e64 v50, -v56, v48
    v_mul_f32_e64 v54, -v64, v52
    v_pk_fma_f32 v[128:129], v[16:17], v[48:49], v[50:51] op_sel_hi:[1,0,0]
    v_pk_fma_f32 v[130:131], v[18:19], v[48:49], v[50:51] op_sel_hi:[1,0,0]
    v_pk_fma_f32 v[132:133], v[20:21], v[48:49], v[50:51] op_sel_hi:[1,0,0]
    v_pk_fma_f32 v[134:135], v[22:23], v[48:49], v[50:51] op_sel_hi:[1,0,0]
    v_pk_fma_f32 v[136:137], v[24:25], v[52:53], v[54:55] op_sel_hi:[1,0,0]
    v_pk_fma_f32 v[138:139], v[26:27], v[52:53], v[54:55] op_sel_hi:[1,0,0]
    v_pk_fma_f32 v[140:141], v[28:29], v[52:53], v[54:55] op_sel_hi:[1,0,0]
    v_pk_fma_f32 v[142:143], v[30:31], v[52:53], v[54:55] op_sel_hi:[1,0,0]
    s_mov_b32 s35, s18
    v_pk_fma_f32 v[16:17], v[128:129], v[112:113], v[16:17]
    v_pk_fma_f32 v[18:19], v[130:131], v[114:115], v[18:19]
    v_pk_fma_f32 v[20:21], v[132:133], v[116:117], v[20:21]
    v_pk_fma_f32 v[22:23], v[134:135], v[118:119], v[22:23]
    v_pk_fma_f32 v[24:25], v[136:137], v[120:121], v[24:25]
    v_pk_fma_f32 v[26:27], v[138:139], v[122:123], v[26:27]
    v_pk_fma_f32 v[28:29], v[140:141], v[124:125], v[28:29]
    v_pk_fma_f32 v[30:31], v[142:143], v[126:127], v[30:31]
    v_pk_add_f32 v[56:57], v[16:17], v[18:19]
    v_pk_mul_f32 v[58:59], v[16:17], v[16:17]
    v_pk_add_f32 v[56:57], v[56:57], v[20:21]
    v_pk_fma_f32 v[58:59], v[18:19], v[18:19], v[58:59]
    v_pk_add_f32 v[56:57], v[56:57], v[22:23]
    v_pk_fma_f32 v[58:59], v[20:21], v[20:21], v[58:59]
    v_add_f32 v56, v56, v57
    v_pk_fma_f32 v[58:59], v[22:23], v[22:23], v[58:59]
    v_pk_add_f32 v[60:61], v[24:25], v[26:27]
    v_pk_mul_f32 v[62:63], v[24:25], v[24:25]
    v_pk_add_f32 v[60:61], v[60:61], v[28:29]
    v_pk_fma_f32 v[62:63], v[26:27], v[26:27], v[62:63]
    v_pk_add_f32 v[60:61], v[60:61], v[30:31]
    v_pk_fma_f32 v[62:63], v[28:29], v[28:29], v[62:63]
    v_add_f32 v60, v60, v61
    v_pk_fma_f32 v[62:63], v[30:31], v[30:31], v[62:63]
    v_add_f32 v58, v58, v59
    v_add_f32 v62, v62, v63
    v_permlane32_swap_b32 v56, v60
    s_nop 0
    v_permlane32_swap_b32 v58, v62
    v_add_f32 v56, v56, v60
    v_add_f32 v58, v58, v62
    s_nop 1
    v_permlane16_swap_b32 v56, v58
    v_add_f32 v56, v56, v58
    s_nop 1
    v_add_f32_dpp v56, v56, v56 row_ror:4 row_mask:0xf bank_mask:0xf
    s_nop 1
    v_add_f32_dpp v56, v56, v56 row_ror:8 row_mask:0xf bank_mask:0xf
    ds_write_b32 v40, v56 offset:768
    s_waitcnt lgkmcnt(0)
    s_barrier
    ds_read_b128 v[56:59], v41 offset:768
    ds_read_b128 v[60:63], v41 offset:784
    ds_read_b128 v[64:67], v41 offset:800
    ds_read_b128 v[68:71], v41 offset:816
    s_waitcnt lgkmcnt(2)
    v_pk_add_f32 v[56:57], v[56:57], v[58:59]
    v_pk_add_f32 v[60:61], v[60:61], v[62:63]
    v_add_f32 v56, v56, v57
    v_add_f32 v60, v60, v61
    s_waitcnt lgkmcnt(0)
    v_pk_add_f32 v[64:65], v[64:65], v[66:67]
    v_pk_add_f32 v[68:69], v[68:69], v[70:71]
    v_add_f32 v64, v64, v65
    v_add_f32 v68, v68, v69
    v_mul_f32 v56, s36, v56
    v_fma_f32 v60, v60, s36, v44
    v_mul_f32 v64, s36, v64
    v_fma_f32 v68, v68, s36, v44
    v_fma_f32 v60, -v56, v56, v60
    v_fma_f32 v68, -v64, v64, v68
    v_max_f32 v60, v60, v44
    v_max_f32 v68, v68, v44
    v_rsq_f32 v48, v60
    v_rsq_f32 v52, v68
    v_mul_f32_e64 v50, -v56, v48
    v_mul_f32_e64 v54, -v64, v52
    v_pk_fma_f32 v[128:129], v[16:17], v[48:49], v[50:51] op_sel_hi:[1,0,0]
    v_pk_fma_f32 v[130:131], v[18:19], v[48:49], v[50:51] op_sel_hi:[1,0,0]
    v_pk_fma_f32 v[132:133], v[20:21], v[48:49], v[50:51] op_sel_hi:[1,0,0]
    v_pk_fma_f32 v[134:135], v[22:23], v[48:49], v[50:51] op_sel_hi:[1,0,0]
    v_pk_fma_f32 v[136:137], v[24:25], v[52:53], v[54:55] op_sel_hi:[1,0,0]
    v_pk_fma_f32 v[138:139], v[26:27], v[52:53], v[54:55] op_sel_hi:[1,0,0]
    v_pk_fma_f32 v[140:141], v[28:29], v[52:53], v[54:55] op_sel_hi:[1,0,0]
    v_pk_fma_f32 v[142:143], v[30:31], v[52:53], v[54:55] op_sel_hi:[1,0,0]
    v_cvt_pk_bf16_f32 v144, v128, v129
    v_cvt_pk_bf16_f32 v145, v130, v131
    v_cvt_pk_bf16_f32 v146, v132, v133
    v_cvt_pk_bf16_f32 v147, v134, v135
    s_add_u32 s33, s35, 0
    buffer_store_dwordx4 v[144:147], v11, s[8:11], s33 offen
    v_cvt_pk_bf16_f32 v148, v136, v137
    v_cvt_pk_bf16_f32 v149, v138, v139
    v_cvt_pk_bf16_f32 v150, v140, v141
    v_cvt_pk_bf16_f32 v151, v142, v143
    s_add_u32 s33, s35, 14336
    buffer_store_dwordx4 v[148:151], v11, s[8:11], s33 offen
    s_mov_b32 s33, 36864
    s_waitcnt vmcnt(0)
    s_mov_b64 exec, 1
    buffer_store_dword v43, v14, s[8:11], s33 offen offset:0
    s_mov_b64 exec, -1
    s_mov_b32 s34, 0
    buffer_load_dword v42, v15, s[8:11], s33 offen sc1
L_px_5:
    buffer_load_dword v47, v15, s[8:11], s33 offen sc1
    s_waitcnt vmcnt(1)
    v_and_b32 v46, -16, v42
    v_cmp_ne_u32 vcc, s42, v46
    s_cbranch_vccz L_px_5_x
    buffer_load_dword v42, v15, s[8:11], s33 offen sc1
    s_waitcnt vmcnt(1)
    v_and_b32 v46, -16, v47
    v_cmp_ne_u32 vcc, s42, v46
    s_cbranch_vccz L_px_5_x
    s_add_u32 s34, s34, 1
    s_cmp_lt_u32 s34, 1048576
    s_cbranch_scc1 L_px_5
L_px_5_x:
    s_mul_i32 s33, s22, 14336
    s_add_u32 s33, s33, 13312
    s_add_u32 s34, s33, s35
    s_mov_b32 m0, s33
    s_sub_u32 s33, s33, 1024
    buffer_load_dwordx4 v45, s[8:11], s34 offen sc1 lds
    s_sub_u32 s34, s34, 1024
    s_mov_b32 m0, s33
    s_sub_u32 s33, s33, 1024
    buffer_load_dwordx4 v45, s[8:11], s34 offen sc1 lds
    s_sub_u32 s34, s34, 1024
    s_mov_b32 m0, s33
    s_sub_u32 s33, s33, 1024
    buffer_load_dwordx4 v45, s[8:11], s34 offen sc1 lds
    s_sub_u32 s34, s34, 1024
    s_mov_b32 m0, s33
    s_sub_u32 s33, s33, 1024
    buffer_load_dwordx4 v45, s[8:11], s34 offen sc1 lds
    s_sub_u32 s34, s34, 1024
    s_mov_b32 m0, s33
    s_sub_u32 s33, s33, 1024
    buffer_load_dwordx4 v45, s[8:11], s34 offen sc1 lds
    s_sub_u32 s34, s34, 1024
    s_mov_b32 m0, s33
    s_sub_u32 s33, s33, 1024
    buffer_load_dwordx4 v45, s[8:11], s34 offen sc1 lds
    s_sub_u32 s34, s34, 1024
    s_mov_b32 m0, s33
    s_sub_u32 s33, s33, 1024
    buffer_load_dwordx4 v45, s[8:11], s34 offen sc1 lds
    s_sub_u32 s34, s34, 1024
    s_mov_b32 m0, s33
    s_sub_u32 s33, s33, 1024
    buffer_load_dwordx4 v45, s[8:11], s34 offen sc1 lds
    s_sub_u32 s34, s34, 1024
    s_mov_b32 m0, s33
    s_sub_u32 s33, s33, 1024
    buffer_load_dwordx4 v45, s[8:11], s34 offen sc1 lds
    s_sub_u32 s34, s34, 1024
    s_mov_b32 m0, s33
    s_sub_u32 s33, s33, 1024
    buffer_load_dwordx4 v45, s[8:11], s34 offen sc1 lds
    s_sub_u32 s34, s34, 1024
    s_mov_b32 m0, s33
    s_sub_u32 s33, s33, 1024
    buffer_load_dwordx4 v45, s[8:11], s34 offen sc1 lds
    s_sub_u32 s34, s34, 1024
    s_mov_b32 m0, s33
    s_sub_u32 s33, s33, 1024
    buffer_load_dwordx4 v45, s[8:11], s34 offen sc1 lds
    s_sub_u32 s34, s34, 1024
    s_mov_b32 m0, s33
    s_sub_u32 s33, s33, 1024
    buffer_load_dwordx4 v45, s[8:11], s34 offen sc1 lds
    s_sub_u32 s34, s34, 1024
    s_mov_b32 m0, s33
    s_sub_u32 s33, s33, 1024
    buffer_load_dwordx4 v45, s[8:11], s34 offen sc1 lds
    s_sub_u32 s34, s34, 1024
    s_waitcnt vmcnt(11)
    s_barrier
L_g11:
    s_mov_b32 s38, 18874368
    s_mov_b32 s39, 19103744
    ds_read_b128 v[224:227], v1 offset:13312
    ds_read_b128 v[228:231], v1 offset:27648
    ds_read_b128 v[232:235], v1 offset:41984
    ds_read_b128 v[236:239], v1 offset:56320
    ds_read_b128 v[220:223], v0 offset:13312
    s_waitcnt lgkmcnt(4)
    v_mfma_f32_16x16x32_bf16 v[48:51], a[52:55], v[224:227], 0
    s_waitcnt lgkmcnt(3)
    v_mfma_f32_16x16x32_bf16 v[76:79], a[52:55], v[228:231], 0
    s_waitcnt lgkmcnt(2)
    v_mfma_f32_16x16x32_bf16 v[104:107], a[52:55], v[232:235], 0
    s_waitcnt lgkmcnt(1)
    v_mfma_f32_16x16x32_bf16 v[132:135], a[52:55], v[236:239], 0
    ds_read_b128 v[240:243], v1 offset:12288
    s_waitcnt lgkmcnt(1)
    v_mfma_f32_16x16x32_bf16 v[52:55], v[220:223], v[224:227], 0
    v_mfma_f32_16x16x32_bf16 v[80:83], v[220:223], v[228:231], 0
    v_mfma_f32_16x16x32_bf16 v[108:111], v[220:223], v[232:235], 0
    v_mfma_f32_16x16x32_bf16 v[136:139], v[220:223], v[236:239], 0
    ds_read_b128 v[244:247], v1 offset:26624
    v_mfma_f32_16x16x32_bf16 v[56:59], v[196:199], v[224:227], 0
    v_mfma_f32_16x16x32_bf16 v[84:87], v[196:199], v[228:231], 0
    ds_read_b128 v[220:223], v0 offset:12288
    v_mfma_f32_16x16x32_bf16 v[112:115], v[196:199], v[232:235], 0
    v_mfma_f32_16x16x32_bf16 v[140:143], v[196:199], v[236:239], 0
    ds_read_b128 v[248:251], v1 offset:40960
    v_mfma_f32_16x16x32_bf16 v[60:63], v[200:203], v[224:227], 0
    v_mfma_f32_16x16x32_bf16 v[88:91], v[200:203], v[228:231], 0
    buffer_load_dwordx4 v[196:199], v13, s[8:11], s71 offen offset:2048
    v_mfma_f32_16x16x32_bf16 v[116:119], v[200:203], v[232:235], 0
    v_mfma_f32_16x16x32_bf16 v[144:147], v[200:203], v[236:239], 0
    ds_read_b128 v[252:255], v1 offset:55296
    v_mfma_f32_16x16x32_bf16 v[64:67], v[204:207], v[224:227], 0
    v_mfma_f32_16x16x32_bf16 v[92:95], v[204:207], v[228:231], 0
    buffer_load_dwordx4 v[200:203], v13, s[8:11], s70 offen offset:2048
    v_mfma_f32_16x16x32_bf16 v[120:123], v[204:207], v[232:235], 0
    v_mfma_f32_16x16x32_bf16 v[148:151], v[204:207], v[236:239], 0
    v_mfma_f32_16x16x32_bf16 v[68:71], v[208:211], v[224:227], 0
    v_mfma_f32_16x16x32_bf16 v[96:99], v[208:211], v[228:231], 0
    buffer_load_dwordx4 v[204:207], v13, s[8:11], s70 offen offset:3072
    v_mfma_f32_16x16x32_bf16 v[124:127], v[208:211], v[232:235], 0
    v_mfma_f32_16x16x32_bf16 v[152:155], v[208:211], v[236:239], 0
    v_mfma_f32_16x16x32_bf16 v[72:75], v[212:215], v[224:227], 0
    v_mfma_f32_16x16x32_bf16 v[100:103], v[212:215], v[228:231], 0
    buffer_load_dwordx4 v[208:211], v219, s[8:11], s70 offen offset:0
    v_mfma_f32_16x16x32_bf16 v[128:131], v[212:215], v[232:235], 0
    v_mfma_f32_16x16x32_bf16 v[156:159], v[212:215], v[236:239], 0
    s_waitcnt lgkmcnt(0)
    v_mfma_f32_16x16x32_bf16 v[48:51], a[48:51], v[240:243], v[48:51]
    v_mfma_f32_16x16x32_bf16 v[76:79], a[48:51], v[244:247], v[76:79]
    buffer_load_dwordx4 v[212:215], v219, s[8:11], s70 offen offset:1024
    v_mfma_f32_16x16x32_bf16 v[104:107], a[48:51], v[248:251], v[104:107]
    v_mfma_f32_16x16x32_bf16 v[132:135], a[48:51], v[252:255], v[132:135]
    ds_read_b128 v[224:227], v1 offset:11264
    v_mfma_f32_16x16x32_bf16 v[52:55], v[220:223], v[240:243], v[52:55]
    v_mfma_f32_16x16x32_bf16 v[80:83], v[220:223], v[244:247], v[80:83]
    v_mfma_f32_16x16x32_bf16 v[108:111], v[220:223], v[248:251], v[108:111]
    v_mfma_f32_16x16x32_bf16 v[136:139], v[220:223], v[252:255], v[136:139]
    ds_read_b128 v[228:231], v1 offset:25600
    v_mfma_f32_16x16x32_bf16 v[56:59], v[176:179], v[240:243], v[56:59]
    v_mfma_f32_16x16x32_bf16 v[84:87], v[176:179], v[244:247], v[84:87]
    ds_read_b128 v[220:223], v0 offset:11264
    v_mfma_f32_16x16x32_bf16 v[112:115], v[176:179], v[248:251], v[112:115]
    v_mfma_f32_16x16x32_bf16 v[140:143], v[176:179], v[252:255], v[140:143]
    ds_read_b128 v[232:235], v1 offset:39936
    v_mfma_f32_16x16x32_bf16 v[60:63], v[180:183], v[240:243], v[60:63]
    v_mfma_f32_16x16x32_bf16 v[88:91], v[180:183], v[244:247], v[88:91]
    buffer_load_dwordx4 v[176:179], v219, s[8:11], s70 offen offset:2048
    v_mfma_f32_16x16x32_bf16 v[116:119], v[180:183], v[248:251], v[116:119]
    v_mfma_f32_16x16x32_bf16 v[144:147], v[180:183], v[252:255], v[144:147]
    ds_read_b128 v[236:239], v1 offset:54272
    v_mfma_f32_16x16x32_bf16 v[64:67], v[184:187], v[240:243], v[64:67]
    v_mfma_f32_16x16x32_bf16 v[92:95], v[184:187], v[244:247], v[92:95]
    buffer_load_dwordx4 v[180:183], v13, s[8:11], s69 offen offset:2048
    v_mfma_f32_16x16x32_bf16 v[120:123], v[184:187], v[248:251], v[120:123]
    v_mfma_f32_16x16x32_bf16 v[148:151], v[184:187], v[252:255], v[148:151]
    v_mfma_f32_16x16x32_bf16 v[68:71], v[188:191], v[240:243], v[68:71]
    v_mfma_f32_16x16x32_bf16 v[96:99], v[188:191], v[244:247], v[96:99]
    buffer_load_dwordx4 v[184:187], v13, s[8:11], s69 offen offset:3072
    v_mfma_f32_16x16x32_bf16 v[124:127], v[188:191], v[248:251], v[124:127]
    v_mfma_f32_16x16x32_bf16 v[152:155], v[188:191], v[252:255], v[152:155]
    v_mfma_f32_16x16x32_bf16 v[72:75], v[192:195], v[240:243], v[72:75]
    v_mfma_f32_16x16x32_bf16 v[100:103], v[192:195], v[244:247], v[100:103]
    buffer_load_dwordx4 v[188:191], v219, s[8:11], s69 offen offset:0
    v_mfma_f32_16x16x32_bf16 v[128:131], v[192:195], v[248:251], v[128:131]
    v_mfma_f32_16x16x32_bf16 v[156:159], v[192:195], v[252:255], v[156:159]
    s_waitcnt lgkmcnt(0)
    v_mfma_f32_16x16x32_bf16 v[48:51], a[44:47], v[224:227], v[48:51]
    v_mfma_f32_16x16x32_bf16 v[76:79], a[44:47], v[228:231], v[76:79]
    buffer_load_dwordx4 v[192:195], v219, s[8:11], s69 offen offset:1024
    v_mfma_f32_16x16x32_bf16 v[104:107], a[44:47], v[232:235], v[104:107]
    s_waitcnt vmcnt(10)
    s_barrier
    v_mfma_f32_16x16x32_bf16 v[132:135], a[44:47], v[236:239], v[132:135]
    ds_read_b128 v[240:243], v1 offset:10240
    v_mfma_f32_16x16x32_bf16 v[52:55], v[220:223], v[224:227], v[52:55]
    v_mfma_f32_16x16x32_bf16 v[80:83], v[220:223], v[228:231], v[80:83]
    v_mfma_f32_16x16x32_bf16 v[108:111], v[220:223], v[232:235], v[108:111]
    v_mfma_f32_16x16x32_bf16 v[136:139], v[220:223], v[236:239], v[136:139]
    ds_read_b128 v[244:247], v1 offset:24576
    v_mfma_f32_16x16x32_bf16 v[60:63], v[160:163], v[224:227], v[60:63]
    v_mfma_f32_16x16x32_bf16 v[88:91], v[160:163], v[228:231], v[88:91]
    ds_read_b128 v[220:223], v0 offset:10240
    v_mfma_f32_16x16x32_bf16 v[116:119], v[160:163], v[232:235], v[116:119]
    v_mfma_f32_16x16x32_bf16 v[144:147], v[160:163], v[236:239], v[144:147]
    ds_read_b128 v[248:251], v1 offset:38912
    v_mfma_f32_16x16x32_bf16 v[64:67], v[164:167], v[224:227], v[64:67]
    v_mfma_f32_16x16x32_bf16 v[92:95], v[164:167], v[228:231], v[92:95]
    buffer_load_dwordx4 v[160:163], v219, s[8:11], s69 offen offset:2048
    v_mfma_f32_16x16x32_bf16 v[120:123], v[164:167], v[232:235], v[120:123]
    v_mfma_f32_16x16x32_bf16 v[148:151], v[164:167], v[236:239], v[148:151]
    ds_read_b128 v[252:255], v1 offset:53248
    v_mfma_f32_16x16x32_bf16 v[68:71], v[168:171], v[224:227], v[68:71]
    v_mfma_f32_16x16x32_bf16 v[96:99], v[168:171], v[228:231], v[96:99]
    buffer_load_dwordx4 v[164:167], v13, s[8:11], s68 offen offset:2048
    v_mfma_f32_16x16x32_bf16 v[124:127], v[168:171], v[232:235], v[124:127]
    v_mfma_f32_16x16x32_bf16 v[152:155], v[168:171], v[236:239], v[152:155]
    v_mfma_f32_16x16x32_bf16 v[72:75], v[172:175], v[224:227], v[72:75]
    v_mfma_f32_16x16x32_bf16 v[100:103], v[172:175], v[228:231], v[100:103]
    buffer_load_dwordx4 v[168:171], v13, s[8:11], s68 offen offset:3072
    v_mfma_f32_16x16x32_bf16 v[128:131], v[172:175], v[232:235], v[128:131]
    v_mfma_f32_16x16x32_bf16 v[156:159], v[172:175], v[236:239], v[156:159]
    s_waitcnt vmcnt(12)
    v_mfma_f32_16x16x32_bf16 v[56:59], v[196:199], v[224:227], v[56:59]
    v_mfma_f32_16x16x32_bf16 v[84:87], v[196:199], v[228:231], v[84:87]
    buffer_load_dwordx4 v[172:175], v219, s[8:11], s68 offen offset:0
    v_mfma_f32_16x16x32_bf16 v[112:115], v[196:199], v[232:235], v[112:115]
    v_mfma_f32_16x16x32_bf16 v[140:143], v[196:199], v[236:239], v[140:143]
    s_waitcnt lgkmcnt(0)
    v_mfma_f32_16x16x32_bf16 v[48:51], a[40:43], v[240:243], v[48:51]
    v_mfma_f32_16x16x32_bf16 v[76:79], a[40:43], v[244:247], v[76:79]
    buffer_load_dwordx4 v[196:199], v219, s[8:11], s68 offen offset:1024
    v_mfma_f32_16x16x32_bf16 v[104:107], a[40:43], v[248:251], v[104:107]
    v_mfma_f32_16x16x32_bf16 v[132:135], a[40:43], v[252:255], v[132:135]
    ds_read_b128 v[224:227], v1 offset:9216
    v_mfma_f32_16x16x32_bf16 v[52:55], v[220:223], v[240:243], v[52:55]
    v_mfma_f32_16x16x32_bf16 v[80:83], v[220:223], v[244:247], v[80:83]
    v_mfma_f32_16x16x32_bf16 v[108:111], v[220:223], v[248:251], v[108:111]
    v_mfma_f32_16x16x32_bf16 v[136:139], v[220:223], v[252:255], v[136:139]
    ds_read_b128 v[228:231], v1 offset:23552
    s_waitcnt vmcnt(12)
    v_mfma_f32_16x16x32_bf16 v[56:59], v[200:203], v[240:243], v[56:59]
    v_mfma_f32_16x16x32_bf16 v[84:87], v[200:203], v[244:247], v[84:87]
    ds_read_b128 v[220:223], v0 offset:9216
    v_mfma_f32_16x16x32_bf16 v[112:115], v[200:203], v[248:251], v[112:115]
    v_mfma_f32_16x16x32_bf16 v[140:143], v[200:203], v[252:255], v[140:143]
    ds_read_b128 v[232:235], v1 offset:37888
    v_mfma_f32_16x16x32_bf16 v[60:63], v[204:207], v[240:243], v[60:63]
    v_mfma_f32_16x16x32_bf16 v[88:91], v[204:207], v[244:247], v[88:91]
    buffer_load_dwordx4 v[200:203], v219, s[8:11], s68 offen offset:2048
    v_mfma_f32_16x16x32_bf16 v[116:119], v[204:207], v[248:251], v[116:119]
    v_mfma_f32_16x16x32_bf16 v[144:147], v[204:207], v[252:255], v[144:147]
    ds_read_b128 v[236:239], v1 offset:52224
    s_waitcnt vmcnt(11)
    v_mfma_f32_16x16x32_bf16 v[64:67], v[208:211], v[240:243], v[64:67]
    v_mfma_f32_16x16x32_bf16 v[92:95], v[208:211], v[244:247], v[92:95]
    buffer_load_dwordx4 v[204:207], v13, s[8:11], s67 offen offset:2048
    v_mfma_f32_16x16x32_bf16 v[120:123], v[208:211], v[248:251], v[120:123]
    v_mfma_f32_16x16x32_bf16 v[148:151], v[208:211], v[252:255], v[148:151]
    v_mfma_f32_16x16x32_bf16 v[68:71], v[212:215], v[240:243], v[68:71]
    v_mfma_f32_16x16x32_bf16 v[96:99], v[212:215], v[244:247], v[96:99]
    buffer_load_dwordx4 v[208:211], v13, s[8:11], s67 offen offset:3072
    v_mfma_f32_16x16x32_bf16 v[124:127], v[212:215], v[248:251], v[124:127]
    v_mfma_f32_16x16x32_bf16 v[152:155], v[212:215], v[252:255], v[152:155]
    s_waitcnt vmcnt(12)
    v_mfma_f32_16x16x32_bf16 v[72:75], v[176:179], v[240:243], v[72:75]
    v_mfma_f32_16x16x32_bf16 v[100:103], v[176:179], v[244:247], v[100:103]
    buffer_load_dwordx4 v[212:215], v219, s[8:11], s67 offen offset:0
    v_mfma_f32_16x16x32_bf16 v[128:131], v[176:179], v[248:251], v[128:131]
    v_mfma_f32_16x16x32_bf16 v[156:159], v[176:179], v[252:255], v[156:159]
    s_waitcnt lgkmcnt(0)
    v_mfma_f32_16x16x32_bf16 v[48:51], a[36:39], v[224:227], v[48:51]
    v_mfma_f32_16x16x32_bf16 v[76:79], a[36:39], v[228:231], v[76:79]
    buffer_load_dwordx4 v[176:179], v219, s[8:11], s67 offen offset:1024
    v_mfma_f32_16x16x32_bf16 v[104:107], a[36:39], v[232:235], v[104:107]
    v_mfma_f32_16x16x32_bf16 v[132:135], a[36:39], v[236:239], v[132:135]
    ds_read_b128 v[240:243], v1 offset:8192
    v_mfma_f32_16x16x32_bf16 v[52:55], v[220:223], v[224:227], v[52:55]
    v_mfma_f32_16x16x32_bf16 v[80:83], v[220:223], v[228:231], v[80:83]
    v_mfma_f32_16x16x32_bf16 v[108:111], v[220:223], v[232:235], v[108:111]
    v_mfma_f32_16x16x32_bf16 v[136:139], v[220:223], v[236:239], v[136:139]
    ds_read_b128 v[244:247], v1 offset:22528
    s_waitcnt vmcnt(12)
    v_mfma_f32_16x16x32_bf16 v[56:59], v[180:183], v[224:227], v[56:59]
    v_mfma_f32_16x16x32_bf16 v[84:87], v[180:183], v[228:231], v[84:87]
    ds_read_b128 v[220:223], v0 offset:8192
    v_mfma_f32_16x16x32_bf16 v[112:115], v[180:183], v[232:235], v[112:115]
    v_mfma_f32_16x16x32_bf16 v[140:143], v[180:183], v[236:239], v[140:143]
    ds_read_b128 v[248:251], v1 offset:36864
    v_mfma_f32_16x16x32_bf16 v[60:63], v[184:187], v[224:227], v[60:63]
    v_mfma_f32_16x16x32_bf16 v[88:91], v[184:187], v[228:231], v[88:91]
    buffer_load_dwordx4 v[180:183], v219, s[8:11], s67 offen offset:2048
    v_mfma_f32_16x16x32_bf16 v[116:119], v[184:187], v[232:235], v[116:119]
    v_mfma_f32_16x16x32_bf16 v[144:147], v[184:187], v[236:239], v[144:147]
    ds_read_b128 v[252:255], v1 offset:51200
    s_waitcnt vmcnt(11)
    v_mfma_f32_16x16x32_bf16 v[64:67], v[188:191], v[224:227], v[64:67]
    v_mfma_f32_16x16x32_bf16 v[92:95], v[188:191], v[228:231], v[92:95]
    buffer_load_dwordx4 v[184:187], v13, s[8:11], s66 offen offset:2048
    v_mfma_f32_16x16x32_bf16 v[120:123], v[188:191], v[232:235], v[120:123]
    v_mfma_f32_16x16x32_bf16 v[148:151], v[188:191], v[236:239], v[148:151]
    v_mfma_f32_16x16x32_bf16 v[68:71], v[192:195], v[224:227], v[68:71]
    v_mfma_f32_16x16x32_bf16 v[96:99], v[192:195], v[228:231], v[96:99]
    buffer_load_dwordx4 v[188:191], v13, s[8:11], s66 offen offset:3072
    v_mfma_f32_16x16x32_bf16 v[124:127], v[192:195], v[232:235], v[124:127]
    v_mfma_f32_16x16x32_bf16 v[152:155], v[192:195], v[236:239], v[152:155]
    s_waitcnt vmcnt(12)
    v_mfma_f32_16x16x32_bf16 v[72:75], v[160:163], v[224:227], v[72:75]
    v_mfma_f32_16x16x32_bf16 v[100:103], v[160:163], v[228:231], v[100:103]
    buffer_load_dwordx4 v[192:195], v219, s[8:11], s66 offen offset:0
    v_mfma_f32_16x16x32_bf16 v[128:131], v[160:163], v[232:235], v[128:131]
    v_mfma_f32_16x16x32_bf16 v[156:159], v[160:163], v[236:239], v[156:159]
    s_waitcnt lgkmcnt(0)
    v_mfma_f32_16x16x32_bf16 v[48:51], a[32:35], v[240:243], v[48:51]
    v_mfma_f32_16x16x32_bf16 v[76:79], a[32:35], v[244:247], v[76:79]
    buffer_load_dwordx4 v[160:163], v219, s[8:11], s66 offen offset:1024
    v_mfma_f32_16x16x32_bf16 v[104:107], a[32:35], v[248:251], v[104:107]
    v_mfma_f32_16x16x32_bf16 v[132:135], a[32:35], v[252:255], v[132:135]
    ds_read_b128 v[224:227], v1 offset:7168
    v_mfma_f32_16x16x32_bf16 v[52:55], v[220:223], v[240:243], v[52:55]
    v_mfma_f32_16x16x32_bf16 v[80:83], v[220:223], v[244:247], v[80:83]
    v_mfma_f32_16x16x32_bf16 v[108:111], v[220:223], v[248:251], v[108:111]
    v_mfma_f32_16x16x32_bf16 v[136:139], v[220:223], v[252:255], v[136:139]
    ds_read_b128 v[228:231], v1 offset:21504
    s_waitcnt vmcnt(12)
    v_mfma_f32_16x16x32_bf16 v[56:59], v[164:167], v[240:243], v[56:59]
    v_mfma_f32_16x16x32_bf16 v[84:87], v[164:167], v[244:247], v[84:87]
    ds_read_b128 v[220:223], v0 offset:7168
    v_mfma_f32_16x16x32_bf16 v[112:115], v[164:167], v[248:251], v[112:115]
    v_mfma_f32_16x16x32_bf16 v[140:143], v[164:167], v[252:255], v[140:143]
    ds_read_b128 v[232:235], v1 offset:35840
    v_mfma_f32_16x16x32_bf16 v[60:63], v[168:171], v[240:243], v[60:63]
    v_mfma_f32_16x16x32_bf16 v[88:91], v[168:171], v[244:247], v[88:91]
    buffer_load_dwordx4 v[164:167], v219, s[8:11], s66 offen offset:2048
    v_mfma_f32_16x16x32_bf16 v[116:119], v[168:171], v[248:251], v[116:119]
    v_mfma_f32_16x16x32_bf16 v[144:147], v[168:171], v[252:255], v[144:147]
    ds_read_b128 v[236:239], v1 offset:50176
    s_waitcnt vmcnt(11)
    v_mfma_f32_16x16x32_bf16 v[64:67], v[172:175], v[240:243], v[64:67]
    v_mfma_f32_16x16x32_bf16 v[92:95], v[172:175], v[244:247], v[92:95]
    buffer_load_dwordx4 v[168:171], v13, s[8:11], s65 offen offset:2048
    v_mfma_f32_16x16x32_bf16 v[120:123], v[172:175], v[248:251], v[120:123]
    v_mfma_f32_16x16x32_bf16 v[148:151], v[172:175], v[252:255], v[148:151]
    v_mfma_f32_16x16x32_bf16 v[68:71], v[196:199], v[240:243], v[68:71]
    v_mfma_f32_16x16x32_bf16 v[96:99], v[196:199], v[244:247], v[96:99]
    buffer_load_dwordx4 v[172:175], v13, s[8:11], s65 offen offset:3072
    v_mfma_f32_16x16x32_bf16 v[124:127], v[196:199], v[248:251], v[124:127]
    v_mfma_f32_16x16x32_bf16 v[152:155], v[196:199], v[252:255], v[152:155]
    s_waitcnt vmcnt(12)
    v_mfma_f32_16x16x32_bf16 v[72:75], v[200:203], v[240:243], v[72:75]
    v_mfma_f32_16x16x32_bf16 v[100:103], v[200:203], v[244:247], v[100:103]
    buffer_load_dwordx4 v[196:199], v219, s[8:11], s65 offen offset:0
    v_mfma_f32_16x16x32_bf16 v[128:131], v[200:203], v[248:251], v[128:131]
    v_mfma_f32_16x16x32_bf16 v[156:159], v[200:203], v[252:255], v[156:159]
    s_waitcnt lgkmcnt(0)
    v_mfma_f32_16x16x32_bf16 v[48:51], a[28:31], v[224:227], v[48:51]
    v_mfma_f32_16x16x32_bf16 v[76:79], a[28:31], v[228:231], v[76:79]
    buffer_load_dwordx4 v[200:203], v219, s[8:11], s65 offen offset:1024
    v_mfma_f32_16x16x32_bf16 v[104:107], a[28:31], v[232:235], v[104:107]
    v_mfma_f32_16x16x32_bf16 v[132:135], a[28:31], v[236:239], v[132:135]
    ds_read_b128 v[240:243], v1 offset:6144
    v_mfma_f32_16x16x32_bf16 v[52:55], v[220:223], v[224:227], v[52:55]
    v_mfma_f32_16x16x32_bf16 v[80:83], v[220:223], v[228:231], v[80:83]
    v_mfma_f32_16x16x32_bf16 v[108:111], v[220:223], v[232:235], v[108:111]
    v_mfma_f32_16x16x32_bf16 v[136:139], v[220:223], v[236:239], v[136:139]
    ds_read_b128 v[244:247], v1 offset:20480
    s_waitcnt vmcnt(12)
    v_mfma_f32_16x16x32_bf16 v[56:59], v[204:207], v[224:227], v[56:59]
    v_mfma_f32_16x16x32_bf16 v[84:87], v[204:207], v[228:231], v[84:87]
    ds_read_b128 v[220:223], v0 offset:6144
    v_mfma_f32_16x16x32_bf16 v[112:115], v[204:207], v[232:235], v[112:115]
    v_mfma_f32_16x16x32_bf16 v[140:143], v[204:207], v[236:239], v[140:143]
    ds_read_b128 v[248:251], v1 offset:34816
    v_mfma_f32_16x16x32_bf16 v[60:63], v[208:211], v[224:227], v[60:63]
    v_mfma_f32_16x16x32_bf16 v[88:91], v[208:211], v[228:231], v[88:91]
    buffer_load_dwordx4 v[204:207], v219, s[8:11], s65 offen offset:2048
    v_mfma_f32_16x16x32_bf16 v[116:119], v[208:211], v[232:235], v[116:119]
    v_mfma_f32_16x16x32_bf16 v[144:147], v[208:211], v[236:239], v[144:147]
    ds_read_b128 v[252:255], v1 offset:49152
    s_waitcnt vmcnt(11)
    v_mfma_f32_16x16x32_bf16 v[64:67], v[212:215], v[224:227], v[64:67]
    v_mfma_f32_16x16x32_bf16 v[92:95], v[212:215], v[228:231], v[92:95]
    buffer_load_dwordx4 v[208:211], v13, s[8:11], s64 offen offset:2048
    v_mfma_f32_16x16x32_bf16 v[120:123], v[212:215], v[232:235], v[120:123]
    v_mfma_f32_16x16x32_bf16 v[148:151], v[212:215], v[236:239], v[148:151]
    v_mfma_f32_16x16x32_bf16 v[68:71], v[176:179], v[224:227], v[68:71]
    v_mfma_f32_16x16x32_bf16 v[96:99], v[176:179], v[228:231], v[96:99]
    buffer_load_dwordx4 v[212:215], v13, s[8:11], s64 offen offset:3072
    v_mfma_f32_16x16x32_bf16 v[124:127], v[176:179], v[232:235], v[124:127]
    v_mfma_f32_16x16x32_bf16 v[152:155], v[176:179], v[236:239], v[152:155]
    s_waitcnt vmcnt(12)
    v_mfma_f32_16x16x32_bf16 v[72:75], v[180:183], v[224:227], v[72:75]
    v_mfma_f32_16x16x32_bf16 v[100:103], v[180:183], v[228:231], v[100:103]
    buffer_load_dwordx4 v[176:179], v219, s[8:11], s64 offen offset:0
    v_mfma_f32_16x16x32_bf16 v[128:131], v[180:183], v[232:235], v[128:131]
    v_mfma_f32_16x16x32_bf16 v[156:159], v[180:183], v[236:239], v[156:159]
    s_waitcnt lgkmcnt(0)
    v_mfma_f32_16x16x32_bf16 v[48:51], a[24:27], v[240:243], v[48:51]
    v_mfma_f32_16x16x32_bf16 v[76:79], a[24:27], v[244:247], v[76:79]
    buffer_load_dwordx4 v[180:183], v219, s[8:11], s64 offen offset:1024
    v_mfma_f32_16x16x32_bf16 v[104:107], a[24:27], v[248:251], v[104:107]
    v_mfma_f32_16x16x32_bf16 v[132:135], a[24:27], v[252:255], v[132:135]
    ds_read_b128 v[224:227], v1 offset:5120
    v_mfma_f32_16x16x32_bf16 v[52:55], v[220:223], v[240:243], v[52:55]
    v_mfma_f32_16x16x32_bf16 v[80:83], v[220:223], v[244:247], v[80:83]
    v_mfma_f32_16x16x32_bf16 v[108:111], v[220:223], v[248:251], v[108:111]
    v_mfma_f32_16x16x32_bf16 v[136:139], v[220:223], v[252:255], v[136:139]
    ds_read_b128 v[228:231], v1 offset:19456
    s_waitcnt vmcnt(12)
    v_mfma_f32_16x16x32_bf16 v[56:59], v[184:187], v[240:243], v[56:59]
    v_mfma_f32_16x16x32_bf16 v[84:87], v[184:187], v[244:247], v[84:87]
    ds_read_b128 v[220:223], v0 offset:5120
    v_mfma_f32_16x16x32_bf16 v[112:115], v[184:187], v[248:251], v[112:115]
    v_mfma_f32_16x16x32_bf16 v[140:143], v[184:187], v[252:255], v[140:143]
    ds_read_b128 v[232:235], v1 offset:33792
    v_mfma_f32_16x16x32_bf16 v[60:63], v[188:191], v[240:243], v[60:63]
    v_mfma_f32_16x16x32_bf16 v[88:91], v[188:191], v[244:247], v[88:91]
    buffer_load_dwordx4 v[184:187], v219, s[8:11], s64 offen offset:2048
    v_mfma_f32_16x16x32_bf16 v[116:119], v[188:191], v[248:251], v[116:119]
    v_mfma_f32_16x16x32_bf16 v[144:147], v[188:191], v[252:255], v[144:147]
    ds_read_b128 v[236:239], v1 offset:48128
    s_waitcnt vmcnt(11)
    v_mfma_f32_16x16x32_bf16 v[64:67], v[192:195], v[240:243], v[64:67]
    v_mfma_f32_16x16x32_bf16 v[92:95], v[192:195], v[244:247], v[92:95]
    buffer_load_dwordx4 v[188:191], v13, s[8:11], s63 offen offset:2048
    v_mfma_f32_16x16x32_bf16 v[120:123], v[192:195], v[248:251], v[120:123]
    v_mfma_f32_16x16x32_bf16 v[148:151], v[192:195], v[252:255], v[148:151]
    v_mfma_f32_16x16x32_bf16 v[68:71], v[160:163], v[240:243], v[68:71]
    v_mfma_f32_16x16x32_bf16 v[96:99], v[160:163], v[244:247], v[96:99]
    buffer_load_dwordx4 v[192:195], v13, s[8:11], s63 offen offset:3072
    v_mfma_f32_16x16x32_bf16 v[124:127], v[160:163], v[248:251], v[124:127]
    v_mfma_f32_16x16x32_bf16 v[152:155], v[160:163], v[252:255], v[152:155]
    s_waitcnt vmcnt(12)
    v_mfma_f32_16x16x32_bf16 v[72:75], v[164:167], v[240:243], v[72:75]
    v_mfma_f32_16x16x32_bf16 v[100:103], v[164:167], v[244:247], v[100:103]
    buffer_load_dwordx4 v[160:163], v219, s[8:11], s63 offen offset:0
    v_mfma_f32_16x16x32_bf16 v[128:131], v[164:167], v[248:251], v[128:131]
    v_mfma_f32_16x16x32_bf16 v[156:159], v[164:167], v[252:255], v[156:159]
    s_waitcnt lgkmcnt(0)
    v_mfma_f32_16x16x32_bf16 v[48:51], a[20:23], v[224:227], v[48:51]
    v_mfma_f32_16x16x32_bf16 v[76:79], a[20:23], v[228:231], v[76:79]
    buffer_load_dwordx4 v[164:167], v219, s[8:11], s63 offen offset:1024
    v_mfma_f32_16x16x32_bf16 v[104:107], a[20:23], v[232:235], v[104:107]
    v_mfma_f32_16x16x32_bf16 v[132:135], a[20:23], v[236:239], v[132:135]
    ds_read_b128 v[240:243], v1 offset:4096
    v_mfma_f32_16x16x32_bf16 v[52:55], v[220:223], v[224:227], v[52:55]
    v_mfma_f32_16x16x32_bf16 v[80:83], v[220:223], v[228:231], v[80:83]
    v_mfma_f32_16x16x32_bf16 v[108:111], v[220:223], v[232:235], v[108:111]
    v_mfma_f32_16x16x32_bf16 v[136:139], v[220:223], v[236:239], v[136:139]
    ds_read_b128 v[244:247], v1 offset:18432
    s_waitcnt vmcnt(12)
    v_mfma_f32_16x16x32_bf16 v[56:59], v[168:171], v[224:227], v[56:59]
    v_mfma_f32_16x16x32_bf16 v[84:87], v[168:171], v[228:231], v[84:87]
    ds_read_b128 v[220:223], v0 offset:4096
    v_mfma_f32_16x16x32_bf16 v[112:115], v[168:171], v[232:235], v[112:115]
    v_mfma_f32_16x16x32_bf16 v[140:143], v[168:171], v[236:239], v[140:143]
    ds_read_b128 v[248:251], v1 offset:32768
    v_mfma_f32_16x16x32_bf16 v[60:63], v[172:175], v[224:227], v[60:63]
    v_mfma_f32_16x16x32_bf16 v[88:91], v[172:175], v[228:231], v[88:91]
    buffer_load_dwordx4 v[168:171], v219, s[8:11], s63 offen offset:2048
    v_mfma_f32_16x16x32_bf16 v[116:119], v[172:175], v[232:235], v[116:119]
    v_mfma_f32_16x16x32_bf16 v[144:147], v[172:175], v[236:239], v[144:147]
    ds_read_b128 v[252:255], v1 offset:47104
    s_waitcnt vmcnt(11)
    v_mfma_f32_16x16x32_bf16 v[64:67], v[196:199], v[224:227], v[64:67]
    v_mfma_f32_16x16x32_bf16 v[92:95], v[196:199], v[228:231], v[92:95]
    buffer_load_dwordx4 v[172:175], v13, s[8:11], s62 offen offset:2048
    v_mfma_f32_16x16x32_bf16 v[120:123], v[196:199], v[232:235], v[120:123]
    v_mfma_f32_16x16x32_bf16 v[148:151], v[196:199], v[236:239], v[148:151]
    v_mfma_f32_16x16x32_bf16 v[68:71], v[200:203], v[224:227], v[68:71]
    v_mfma_f32_16x16x32_bf16 v[96:99], v[200:203], v[228:231], v[96:99]
    buffer_load_dwordx4 v[196:199], v13, s[8:11], s62 offen offset:3072
    v_mfma_f32_16x16x32_bf16 v[124:127], v[200:203], v[232:235], v[124:127]
    v_mfma_f32_16x16x32_bf16 v[152:155], v[200:203], v[236:239], v[152:155]
    s_waitcnt vmcnt(12)
    v_mfma_f32_16x16x32_bf16 v[72:75], v[204:207], v[224:227], v[72:75]
    v_mfma_f32_16x16x32_bf16 v[100:103], v[204:207], v[228:231], v[100:103]
    buffer_load_dwordx4 v[200:203], v219, s[8:11], s62 offen offset:0
    v_mfma_f32_16x16x32_bf16 v[128:131], v[204:207], v[232:235], v[128:131]
    v_mfma_f32_16x16x32_bf16 v[156:159], v[204:207], v[236:239], v[156:159]
    s_waitcnt lgkmcnt(0)
    v_mfma_f32_16x16x32_bf16 v[48:51], a[16:19], v[240:243], v[48:51]
    v_mfma_f32_16x16x32_bf16 v[76:79], a[16:19], v[244:247], v[76:79]
    buffer_load_dwordx4 v[204:207], v219, s[8:11], s62 offen offset:1024
    v_mfma_f32_16x16x32_bf16 v[104:107], a[16:19], v[248:251], v[104:107]
    s_add_u32 s51, s50, L_ab1-interleave_layers__ssm_conv_h3__glu_gated_bilinear__prompt_kernel
    buffer_load_dword v46, off, s[4:7], s51
    v_mfma_f32_16x16x32_bf16 v[132:135], a[16:19], v[252:255], v[132:135]
    ds_read_b128 v[224:227], v1 offset:3072
    v_mfma_f32_16x16x32_bf16 v[52:55], v[220:223], v[240:243], v[52:55]
    v_mfma_f32_16x16x32_bf16 v[80:83], v[220:223], v[244:247], v[80:83]
    v_mfma_f32_16x16x32_bf16 v[108:111], v[220:223], v[248:251], v[108:111]
    v_mfma_f32_16x16x32_bf16 v[136:139], v[220:223], v[252:255], v[136:139]
    ds_read_b128 v[228:231], v1 offset:17408
    s_waitcnt vmcnt(13)
    v_mfma_f32_16x16x32_bf16 v[56:59], v[208:211], v[240:243], v[56:59]
    v_mfma_f32_16x16x32_bf16 v[84:87], v[208:211], v[244:247], v[84:87]
    ds_read_b128 v[220:223], v0 offset:3072
    v_mfma_f32_16x16x32_bf16 v[112:115], v[208:211], v[248:251], v[112:115]
    v_mfma_f32_16x16x32_bf16 v[140:143], v[208:211], v[252:255], v[140:143]
    ds_read_b128 v[232:235], v1 offset:31744
    v_mfma_f32_16x16x32_bf16 v[60:63], v[212:215], v[240:243], v[60:63]
    v_mfma_f32_16x16x32_bf16 v[88:91], v[212:215], v[244:247], v[88:91]
    buffer_load_dwordx4 v[208:211], v219, s[8:11], s62 offen offset:2048
    v_mfma_f32_16x16x32_bf16 v[116:119], v[212:215], v[248:251], v[116:119]
    v_mfma_f32_16x16x32_bf16 v[144:147], v[212:215], v[252:255], v[144:147]
    ds_read_b128 v[236:239], v1 offset:46080
    s_waitcnt vmcnt(12)
    v_mfma_f32_16x16x32_bf16 v[64:67], v[176:179], v[240:243], v[64:67]
    v_mfma_f32_16x16x32_bf16 v[92:95], v[176:179], v[244:247], v[92:95]
    buffer_load_dwordx4 v[212:215], v13, s[8:11], s61 offen offset:2048
    v_mfma_f32_16x16x32_bf16 v[120:123], v[176:179], v[248:251], v[120:123]
    v_mfma_f32_16x16x32_bf16 v[148:151], v[176:179], v[252:255], v[148:151]
    v_mfma_f32_16x16x32_bf16 v[68:71], v[180:183], v[240:243], v[68:71]
    v_mfma_f32_16x16x32_bf16 v[96:99], v[180:183], v[244:247], v[96:99]
    buffer_load_dwordx4 v[176:179], v13, s[8:11], s61 offen offset:3072
    v_mfma_f32_16x16x32_bf16 v[124:127], v[180:183], v[248:251], v[124:127]
    v_mfma_f32_16x16x32_bf16 v[152:155], v[180:183], v[252:255], v[152:155]
    s_waitcnt vmcnt(13)
    v_mfma_f32_16x16x32_bf16 v[72:75], v[184:187], v[240:243], v[72:75]
    v_mfma_f32_16x16x32_bf16 v[100:103], v[184:187], v[244:247], v[100:103]
    buffer_load_dwordx4 v[180:183], v219, s[8:11], s61 offen offset:0
    v_mfma_f32_16x16x32_bf16 v[128:131], v[184:187], v[248:251], v[128:131]
    v_mfma_f32_16x16x32_bf16 v[156:159], v[184:187], v[252:255], v[156:159]
    s_waitcnt lgkmcnt(0)
    v_mfma_f32_16x16x32_bf16 v[48:51], a[12:15], v[224:227], v[48:51]
    v_mfma_f32_16x16x32_bf16 v[76:79], a[12:15], v[228:231], v[76:79]
    buffer_load_dwordx4 v[184:187], v219, s[8:11], s61 offen offset:1024
    v_mfma_f32_16x16x32_bf16 v[104:107], a[12:15], v[232:235], v[104:107]
    v_mfma_f32_16x16x32_bf16 v[132:135], a[12:15], v[236:239], v[132:135]
    ds_read_b128 v[240:243], v1 offset:2048
    v_mfma_f32_16x16x32_bf16 v[52:55], v[220:223], v[224:227], v[52:55]
    v_mfma_f32_16x16x32_bf16 v[80:83], v[220:223], v[228:231], v[80:83]
    v_mfma_f32_16x16x32_bf16 v[108:111], v[220:223], v[232:235], v[108:111]
    v_mfma_f32_16x16x32_bf16 v[136:139], v[220:223], v[236:239], v[136:139]
    ds_read_b128 v[244:247], v1 offset:16384
    s_waitcnt vmcnt(13)
    v_mfma_f32_16x16x32_bf16 v[56:59], v[188:191], v[224:227], v[56:59]
    v_mfma_f32_16x16x32_bf16 v[84:87], v[188:191], v[228:231], v[84:87]
    ds_read_b128 v[220:223], v0 offset:2048
    v_mfma_f32_16x16x32_bf16 v[112:115], v[188:191], v[232:235], v[112:115]
    v_mfma_f32_16x16x32_bf16 v[140:143], v[188:191], v[236:239], v[140:143]
    ds_read_b128 v[248:251], v1 offset:30720
    v_mfma_f32_16x16x32_bf16 v[60:63], v[192:195], v[224:227], v[60:63]
    v_mfma_f32_16x16x32_bf16 v[88:91], v[192:195], v[228:231], v[88:91]
    buffer_load_dwordx4 v[188:191], v219, s[8:11], s61 offen offset:2048
    v_mfma_f32_16x16x32_bf16 v[116:119], v[192:195], v[232:235], v[116:119]
    v_mfma_f32_16x16x32_bf16 v[144:147], v[192:195], v[236:239], v[144:147]
    ds_read_b128 v[252:255], v1 offset:45056
    s_waitcnt vmcnt(12)
    v_mfma_f32_16x16x32_bf16 v[64:67], v[160:163], v[224:227], v[64:67]
    v_mfma_f32_16x16x32_bf16 v[92:95], v[160:163], v[228:231], v[92:95]
    buffer_load_dwordx4 v[192:195], v13, s[8:11], s60 offen offset:2048
    v_mfma_f32_16x16x32_bf16 v[120:123], v[160:163], v[232:235], v[120:123]
    v_mfma_f32_16x16x32_bf16 v[148:151], v[160:163], v[236:239], v[148:151]
    v_mfma_f32_16x16x32_bf16 v[68:71], v[164:167], v[224:227], v[68:71]
    v_mfma_f32_16x16x32_bf16 v[96:99], v[164:167], v[228:231], v[96:99]
    buffer_load_dwordx4 v[160:163], v13, s[8:11], s60 offen offset:3072
    v_mfma_f32_16x16x32_bf16 v[124:127], v[164:167], v[232:235], v[124:127]
    v_mfma_f32_16x16x32_bf16 v[152:155], v[164:167], v[236:239], v[152:155]
    s_waitcnt vmcnt(13)
    v_mfma_f32_16x16x32_bf16 v[72:75], v[168:171], v[224:227], v[72:75]
    v_mfma_f32_16x16x32_bf16 v[100:103], v[168:171], v[228:231], v[100:103]
    buffer_load_dwordx4 v[164:167], v219, s[8:11], s60 offen offset:0
    v_mfma_f32_16x16x32_bf16 v[128:131], v[168:171], v[232:235], v[128:131]
    v_mfma_f32_16x16x32_bf16 v[156:159], v[168:171], v[236:239], v[156:159]
    s_waitcnt lgkmcnt(0)
    v_mfma_f32_16x16x32_bf16 v[48:51], a[8:11], v[240:243], v[48:51]
    v_mfma_f32_16x16x32_bf16 v[76:79], a[8:11], v[244:247], v[76:79]
    buffer_load_dwordx4 v[168:171], v219, s[8:11], s60 offen offset:1024
    v_mfma_f32_16x16x32_bf16 v[104:107], a[8:11], v[248:251], v[104:107]
    v_mfma_f32_16x16x32_bf16 v[132:135], a[8:11], v[252:255], v[132:135]
    ds_read_b128 v[224:227], v1 offset:1024
    v_mfma_f32_16x16x32_bf16 v[52:55], v[220:223], v[240:243], v[52:55]
    v_mfma_f32_16x16x32_bf16 v[80:83], v[220:223], v[244:247], v[80:83]
    v_mfma_f32_16x16x32_bf16 v[108:111], v[220:223], v[248:251], v[108:111]
    v_mfma_f32_16x16x32_bf16 v[136:139], v[220:223], v[252:255], v[136:139]
    ds_read_b128 v[228:231], v1 offset:15360
    s_waitcnt vmcnt(13)
    v_mfma_f32_16x16x32_bf16 v[56:59], v[172:175], v[240:243], v[56:59]
    v_mfma_f32_16x16x32_bf16 v[84:87], v[172:175], v[244:247], v[84:87]
    ds_read_b128 v[220:223], v0 offset:1024
    v_mfma_f32_16x16x32_bf16 v[112:115], v[172:175], v[248:251], v[112:115]
    v_mfma_f32_16x16x32_bf16 v[140:143], v[172:175], v[252:255], v[140:143]
    ds_read_b128 v[232:235], v1 offset:29696
    v_mfma_f32_16x16x32_bf16 v[60:63], v[196:199], v[240:243], v[60:63]
    v_mfma_f32_16x16x32_bf16 v[88:91], v[196:199], v[244:247], v[88:91]
    buffer_load_dwordx4 v[172:175], v219, s[8:11], s60 offen offset:2048
    v_mfma_f32_16x16x32_bf16 v[116:119], v[196:199], v[248:251], v[116:119]
    v_mfma_f32_16x16x32_bf16 v[144:147], v[196:199], v[252:255], v[144:147]
    ds_read_b128 v[236:239], v1 offset:44032
    s_waitcnt vmcnt(12)
    v_mfma_f32_16x16x32_bf16 v[64:67], v[200:203], v[240:243], v[64:67]
    v_mfma_f32_16x16x32_bf16 v[92:95], v[200:203], v[244:247], v[92:95]
    v_mfma_f32_16x16x32_bf16 v[120:123], v[200:203], v[248:251], v[120:123]
    v_mfma_f32_16x16x32_bf16 v[148:151], v[200:203], v[252:255], v[148:151]
    v_mfma_f32_16x16x32_bf16 v[68:71], v[204:207], v[240:243], v[68:71]
    v_mfma_f32_16x16x32_bf16 v[96:99], v[204:207], v[244:247], v[96:99]
    v_mfma_f32_16x16x32_bf16 v[124:127], v[204:207], v[248:251], v[124:127]
    v_mfma_f32_16x16x32_bf16 v[152:155], v[204:207], v[252:255], v[152:155]
    s_waitcnt vmcnt(10)
    v_mfma_f32_16x16x32_bf16 v[72:75], v[208:211], v[240:243], v[72:75]
    v_mfma_f32_16x16x32_bf16 v[100:103], v[208:211], v[244:247], v[100:103]
    v_mfma_f32_16x16x32_bf16 v[128:131], v[208:211], v[248:251], v[128:131]
    v_mfma_f32_16x16x32_bf16 v[156:159], v[208:211], v[252:255], v[156:159]
    s_waitcnt lgkmcnt(0)
    v_mfma_f32_16x16x32_bf16 v[48:51], a[4:7], v[224:227], v[48:51]
    v_mfma_f32_16x16x32_bf16 v[76:79], a[4:7], v[228:231], v[76:79]
    v_mfma_f32_16x16x32_bf16 v[104:107], a[4:7], v[232:235], v[104:107]
    v_mfma_f32_16x16x32_bf16 v[132:135], a[4:7], v[236:239], v[132:135]
    ds_read_b128 v[240:243], v1 offset:0
    v_mfma_f32_16x16x32_bf16 v[52:55], v[220:223], v[224:227], v[52:55]
    v_mfma_f32_16x16x32_bf16 v[80:83], v[220:223], v[228:231], v[80:83]
    v_mfma_f32_16x16x32_bf16 v[108:111], v[220:223], v[232:235], v[108:111]
    v_mfma_f32_16x16x32_bf16 v[136:139], v[220:223], v[236:239], v[136:139]
    ds_read_b128 v[244:247], v1 offset:14336
    s_waitcnt vmcnt(8)
    v_mfma_f32_16x16x32_bf16 v[56:59], v[212:215], v[224:227], v[56:59]
    v_mfma_f32_16x16x32_bf16 v[84:87], v[212:215], v[228:231], v[84:87]
    ds_read_b128 v[220:223], v0 offset:0
    v_mfma_f32_16x16x32_bf16 v[112:115], v[212:215], v[232:235], v[112:115]
    v_mfma_f32_16x16x32_bf16 v[140:143], v[212:215], v[236:239], v[140:143]
    ds_read_b128 v[248:251], v1 offset:28672
    v_mfma_f32_16x16x32_bf16 v[60:63], v[176:179], v[224:227], v[60:63]
    v_mfma_f32_16x16x32_bf16 v[88:91], v[176:179], v[228:231], v[88:91]
    v_mfma_f32_16x16x32_bf16 v[116:119], v[176:179], v[232:235], v[116:119]
    v_mfma_f32_16x16x32_bf16 v[144:147], v[176:179], v[236:239], v[144:147]
    ds_read_b128 v[252:255], v1 offset:43008
    s_waitcnt vmcnt(6)
    v_mfma_f32_16x16x32_bf16 v[64:67], v[180:183], v[224:227], v[64:67]
    v_mfma_f32_16x16x32_bf16 v[92:95], v[180:183], v[228:231], v[92:95]
    v_mfma_f32_16x16x32_bf16 v[120:123], v[180:183], v[232:235], v[120:123]
    v_mfma_f32_16x16x32_bf16 v[148:151], v[180:183], v[236:239], v[148:151]
    v_mfma_f32_16x16x32_bf16 v[68:71], v[184:187], v[224:227], v[68:71]
    v_mfma_f32_16x16x32_bf16 v[96:99], v[184:187], v[228:231], v[96:99]
    v_mfma_f32_16x16x32_bf16 v[124:127], v[184:187], v[232:235], v[124:127]
    v_mfma_f32_16x16x32_bf16 v[152:155], v[184:187], v[236:239], v[152:155]
    s_waitcnt vmcnt(5)
    v_mfma_f32_16x16x32_bf16 v[72:75], v[188:191], v[224:227], v[72:75]
    v_mfma_f32_16x16x32_bf16 v[100:103], v[188:191], v[228:231], v[100:103]
    v_mfma_f32_16x16x32_bf16 v[128:131], v[188:191], v[232:235], v[128:131]
    v_mfma_f32_16x16x32_bf16 v[156:159], v[188:191], v[236:239], v[156:159]
L_ab1:
    s_waitcnt lgkmcnt(4)
    v_mfma_f32_16x16x32_bf16 v[48:51], a[0:3], v[240:243], v[48:51]
    s_waitcnt lgkmcnt(2)
    v_mfma_f32_16x16x32_bf16 v[52:55], v[220:223], v[240:243], v[52:55]
    s_waitcnt vmcnt(4)
    v_mfma_f32_16x16x32_bf16 v[56:59], v[192:195], v[240:243], v[56:59]
    s_waitcnt vmcnt(3)
    v_mfma_f32_16x16x32_bf16 v[60:63], v[160:163], v[240:243], v[60:63]
    s_waitcnt vmcnt(2)
    v_mfma_f32_16x16x32_bf16 v[64:67], v[164:167], v[240:243], v[64:67]
    s_waitcnt vmcnt(1)
    v_mfma_f32_16x16x32_bf16 v[68:71], v[168:171], v[240:243], v[68:71]
    s_waitcnt vmcnt(0)
    v_mfma_f32_16x16x32_bf16 v[72:75], v[172:175], v[240:243], v[72:75]
    v_mfma_f32_16x16x32_bf16 v[76:79], a[0:3], v[244:247], v[76:79]
    v_mfma_f32_16x16x32_bf16 v[80:83], v[220:223], v[244:247], v[80:83]
    v_mul_f32 v48, v48, v52
    v_mul_f32 v49, v49, v53
    v_mfma_f32_16x16x32_bf16 v[84:87], v[192:195], v[244:247], v[84:87]
    v_mul_f32 v50, v50, v54
    v_mul_f32 v51, v51, v55
    v_cvt_pk_bf16_f32 v240, v48, v49
    v_mfma_f32_16x16x32_bf16 v[88:91], v[160:163], v[244:247], v[88:91]
    v_cvt_pk_bf16_f32 v241, v50, v51
    v_mul_f32 v56, v56, v60
    v_mul_f32 v57, v57, v61
    v_mfma_f32_16x16x32_bf16 v[92:95], v[164:167], v[244:247], v[92:95]
    v_mul_f32 v58, v58, v62
    v_mul_f32 v59, v59, v63
    v_mfma_f32_16x16x32_bf16 v[96:99], v[168:171], v[244:247], v[96:99]
    v_cvt_pk_bf16_f32 v242, v56, v57
    v_cvt_pk_bf16_f32 v243, v58, v59
    ds_write_b128 v6, v[240:243] offset:0
    v_mfma_f32_16x16x32_bf16 v[100:103], v[172:175], v[244:247], v[100:103]
    v_mul_f32 v64, v64, v68
    v_mul_f32 v65, v65, v69
    v_mul_f32 v66, v66, v70
    s_waitcnt lgkmcnt(2)
    v_mfma_f32_16x16x32_bf16 v[104:107], a[0:3], v[248:251], v[104:107]
    v_mul_f32 v67, v67, v71
    v_cvt_pk_bf16_f32 v64, v64, v65
    v_mfma_f32_16x16x32_bf16 v[108:111], v[220:223], v[248:251], v[108:111]
    v_cvt_pk_bf16_f32 v65, v66, v67
    v_permlane32_swap_b32 v72, v74
    v_permlane32_swap_b32 v73, v75
    v_mfma_f32_16x16x32_bf16 v[112:115], v[192:195], v[248:251], v[112:115]
    v_mul_f32 v72, v72, v74
    v_mul_f32 v73, v73, v75
    v_cvt_pk_bf16_f32 v66, v72, v73
    v_mfma_f32_16x16x32_bf16 v[116:119], v[160:163], v[248:251], v[116:119]
    ds_write_b64 v7, v[64:65] offset:0
    ds_write_b32 v8, v66 offset:0
    v_mul_f32 v76, v76, v80
    v_mfma_f32_16x16x32_bf16 v[120:123], v[164:167], v[248:251], v[120:123]
    v_mul_f32 v77, v77, v81
    v_mul_f32 v78, v78, v82
    v_mfma_f32_16x16x32_bf16 v[124:127], v[168:171], v[248:251], v[124:127]
    v_mul_f32 v79, v79, v83
    v_cvt_pk_bf16_f32 v244, v76, v77
    v_cvt_pk_bf16_f32 v245, v78, v79
    v_mfma_f32_16x16x32_bf16 v[128:131], v[172:175], v[248:251], v[128:131]
    v_mul_f32 v84, v84, v88
    v_mul_f32 v85, v85, v89
    v_mul_f32 v86, v86, v90
    s_waitcnt lgkmcnt(3)
    v_mfma_f32_16x16x32_bf16 v[132:135], a[0:3], v[252:255], v[132:135]
    v_mul_f32 v87, v87, v91
    v_cvt_pk_bf16_f32 v246, v84, v85
    v_mfma_f32_16x16x32_bf16 v[136:139], v[220:223], v[252:255], v[136:139]
    v_cvt_pk_bf16_f32 v247, v86, v87
    ds_write_b128 v6, v[244:247] offset:7168
    v_mul_f32 v92, v92, v96
    v_mfma_f32_16x16x32_bf16 v[140:143], v[192:195], v[252:255], v[140:143]
    v_mul_f32 v93, v93, v97
    v_mul_f32 v94, v94, v98
    v_mul_f32 v95, v95, v99
    v_mfma_f32_16x16x32_bf16 v[144:147], v[160:163], v[252:255], v[144:147]
    v_cvt_pk_bf16_f32 v92, v92, v93
    v_cvt_pk_bf16_f32 v93, v94, v95
    v_mfma_f32_16x16x32_bf16 v[148:151], v[164:167], v[252:255], v[148:151]
    v_permlane32_swap_b32 v100, v102
    v_permlane32_swap_b32 v101, v103
    v_mul_f32 v100, v100, v102
    v_mfma_f32_16x16x32_bf16 v[152:155], v[168:171], v[252:255], v[152:155]
    v_mul_f32 v101, v101, v103
    v_cvt_pk_bf16_f32 v94, v100, v101
    ds_write_b64 v7, v[92:93] offset:7168
    v_mfma_f32_16x16x32_bf16 v[156:159], v[172:175], v[252:255], v[156:159]
    ds_write_b32 v8, v94 offset:7168
    v_mul_f32 v104, v104, v108
    v_mul_f32 v105, v105, v109
    v_mfma_f32_16x16x32_bf16 v[48:51], a[56:59], v[240:243], 0
    v_mul_f32 v106, v106, v110
    v_mul_f32 v107, v107, v111
    v_mfma_f32_16x16x32_bf16 v[52:55], a[60:63], v[240:243], 0
    v_cvt_pk_bf16_f32 v248, v104, v105
    v_cvt_pk_bf16_f32 v249, v106, v107
    v_mul_f32 v112, v112, v116
    v_mfma_f32_16x16x32_bf16 v[56:59], a[64:67], v[240:243], 0
    v_mul_f32 v113, v113, v117
    v_mul_f32 v114, v114, v118
    v_mul_f32 v115, v115, v119
    v_mfma_f32_16x16x32_bf16 v[60:63], a[68:71], v[240:243], 0
    v_cvt_pk_bf16_f32 v250, v112, v113
    v_cvt_pk_bf16_f32 v251, v114, v115
    v_mfma_f32_16x16x32_bf16 v[64:67], a[72:75], v[240:243], 0
    ds_write_b128 v6, v[248:251] offset:14336
    v_mul_f32 v120, v120, v124
    v_mul_f32 v121, v121, v125
    v_mfma_f32_16x16x32_bf16 v[68:71], a[76:79], v[240:243], 0
    v_mul_f32 v122, v122, v126
    v_mul_f32 v123, v123, v127
    v_cvt_pk_bf16_f32 v120, v120, v121
    v_mfma_f32_16x16x32_bf16 v[72:75], a[80:83], v[240:243], 0
    v_cvt_pk_bf16_f32 v121, v122, v123
    v_permlane32_swap_b32 v128, v130
    v_mfma_f32_16x16x32_bf16 v[76:79], a[56:59], v[244:247], 0
    v_permlane32_swap_b32 v129, v131
    v_mul_f32 v128, v128, v130
    v_mul_f32 v129, v129, v131
    v_mfma_f32_16x16x32_bf16 v[80:83], a[60:63], v[244:247], 0
    v_cvt_pk_bf16_f32 v122, v128, v129
    ds_write_b64 v7, v[120:121] offset:14336
    ds_write_b32 v8, v122 offset:14336
    v_mfma_f32_16x16x32_bf16 v[84:87], a[64:67], v[244:247], 0
    v_mul_f32 v132, v132, v136
    v_mul_f32 v133, v133, v137
    v_mul_f32 v134, v134, v138
    v_mfma_f32_16x16x32_bf16 v[88:91], a[68:71], v[244:247], 0
    v_mul_f32 v135, v135, v139
    v_cvt_pk_bf16_f32 v252, v132, v133
    v_mfma_f32_16x16x32_bf16 v[92:95], a[72:75], v[244:247], 0
    v_cvt_pk_bf16_f32 v253, v134, v135
    v_mul_f32 v140, v140, v144
    v_mul_f32 v141, v141, v145
    v_mfma_f32_16x16x32_bf16 v[96:99], a[76:79], v[244:247], 0
    v_mul_f32 v142, v142, v146
    v_mul_f32 v143, v143, v147
    v_cvt_pk_bf16_f32 v254, v140, v141
    v_mfma_f32_16x16x32_bf16 v[100:103], a[80:83], v[244:247], 0
    v_cvt_pk_bf16_f32 v255, v142, v143
    ds_write_b128 v6, v[252:255] offset:21504
    v_mfma_f32_16x16x32_bf16 v[104:107], a[56:59], v[248:251], 0
    v_mul_f32 v148, v148, v152
    v_mul_f32 v149, v149, v153
    v_mul_f32 v150, v150, v154
    v_mfma_f32_16x16x32_bf16 v[108:111], a[60:63], v[248:251], 0
    v_mul_f32 v151, v151, v155
    v_cvt_pk_bf16_f32 v148, v148, v149
    v_cvt_pk_bf16_f32 v149, v150, v151
    v_mfma_f32_16x16x32_bf16 v[112:115], a[64:67], v[248:251], 0
    v_permlane32_swap_b32 v156, v158
    v_permlane32_swap_b32 v157, v159
    v_mfma_f32_16x16x32_bf16 v[116:119], a[68:71], v[248:251], 0
    v_mul_f32 v156, v156, v158
    v_mul_f32 v157, v157, v159
    v_cvt_pk_bf16_f32 v150, v156, v157
    v_mfma_f32_16x16x32_bf16 v[120:123], a[72:75], v[248:251], 0
    ds_write_b64 v7, v[148:149] offset:21504
    ds_write_b32 v8, v150 offset:21504
    v_mfma_f32_16x16x32_bf16 v[124:127], a[76:79], v[248:251], 0
    v_mfma_f32_16x16x32_bf16 v[128:131], a[80:83], v[248:251], 0
    s_waitcnt lgkmcnt(0)
    s_barrier
    v_mfma_f32_16x16x32_bf16 v[132:135], a[56:59], v[252:255], 0
    ds_read_b128 v[224:227], v3 offset:0
    v_mfma_f32_16x16x32_bf16 v[136:139], a[60:63], v[252:255], 0
    ds_read_b128 v[228:231], v3 offset:7168
    v_mfma_f32_16x16x32_bf16 v[140:143], a[64:67], v[252:255], 0
    ds_read_b128 v[232:235], v3 offset:14336
    v_mfma_f32_16x16x32_bf16 v[144:147], a[68:71], v[252:255], 0
    ds_read_b128 v[236:239], v3 offset:21504
    v_mfma_f32_16x16x32_bf16 v[148:151], a[72:75], v[252:255], 0
    v_mfma_f32_16x16x32_bf16 v[152:155], a[76:79], v[252:255], 0
    v_mfma_f32_16x16x32_bf16 v[156:159], a[80:83], v[252:255], 0
    s_waitcnt lgkmcnt(3)
    v_mfma_f32_16x16x32_bf16 v[48:51], a[84:87], v[224:227], v[48:51]
    ds_read_b128 v[240:243], v4 offset:0
    s_waitcnt lgkmcnt(3)
    v_mfma_f32_16x16x32_bf16 v[76:79], a[84:87], v[228:231], v[76:79]
    ds_read_b128 v[244:247], v4 offset:7168
    s_waitcnt lgkmcnt(3)
    v_mfma_f32_16x16x32_bf16 v[104:107], a[84:87], v[232:235], v[104:107]
    ds_read_b128 v[248:251], v4 offset:14336
    s_waitcnt lgkmcnt(3)
    v_mfma_f32_16x16x32_bf16 v[132:135], a[84:87], v[236:239], v[132:135]
    ds_read_b128 v[252:255], v4 offset:21504
    v_mfma_f32_16x16x32_bf16 v[52:55], a[88:91], v[224:227], v[52:55]
    s_mul_i32 s26, s22, 1792
    s_add_u32 s26, s26, 146944
    v_mfma_f32_16x16x32_bf16 v[80:83], a[88:91], v[228:231], v[80:83]
    v_and_b32 v220, 48, v1
    v_mfma_f32_16x16x32_bf16 v[108:111], a[88:91], v[232:235], v[108:111]
    v_lshrrev_b32 v221, 8, v1
    v_mfma_f32_16x16x32_bf16 v[136:139], a[88:91], v[236:239], v[136:139]
    v_lshl_add_u32 v220, v221, 6, v220
    v_mfma_f32_16x16x32_bf16 v[56:59], a[92:95], v[224:227], v[56:59]
    v_add_u32 v220, s26, v220
    v_mfma_f32_16x16x32_bf16 v[84:87], a[92:95], v[228:231], v[84:87]
    v_mfma_f32_16x16x32_bf16 v[112:115], a[92:95], v[232:235], v[112:115]
    v_mfma_f32_16x16x32_bf16 v[140:143], a[92:95], v[236:239], v[140:143]
    s_waitcnt lgkmcnt(0)
    v_mfma_f32_16x16x32_bf16 v[48:51], a[96:99], v[240:243], v[48:51]
    ds_read_b128 v[224:227], v5 offset:0
    v_mfma_f32_16x16x32_bf16 v[76:79], a[96:99], v[244:247], v[76:79]
    ds_read_b128 v[228:231], v5 offset:7168
    v_mfma_f32_16x16x32_bf16 v[104:107], a[96:99], v[248:251], v[104:107]
    ds_read_b128 v[232:235], v5 offset:14336
    v_mfma_f32_16x16x32_bf16 v[132:135], a[96:99], v[252:255], v[132:135]
    ds_read_b128 v[236:239], v5 offset:21504
    v_mfma_f32_16x16x32_bf16 v[52:55], a[100:103], v[240:243], v[52:55]
    v_mfma_f32_16x16x32_bf16 v[80:83], a[100:103], v[244:247], v[80:83]
    v_mfma_f32_16x16x32_bf16 v[108:111], a[100:103], v[248:251], v[108:111]
    v_mfma_f32_16x16x32_bf16 v[136:139], a[100:103], v[252:255], v[136:139]
    v_mfma_f32_16x16x32_bf16 v[56:59], a[104:107], v[240:243], v[56:59]
    v_mfma_f32_16x16x32_bf16 v[84:87], a[104:107], v[244:247], v[84:87]
    v_mfma_f32_16x16x32_bf16 v[112:115], a[104:107], v[248:251], v[112:115]
    v_mfma_f32_16x16x32_bf16 v[140:143], a[104:107], v[252:255], v[140:143]
    s_waitcnt lgkmcnt(0)
    v_mfma_f32_16x16x32_bf16 v[48:51], a[108:111], v[224:227], v[48:51]
    ds_read_b128 v[240:243], v2 offset:4096
    v_mfma_f32_16x16x32_bf16 v[76:79], a[108:111], v[228:231], v[76:79]
    ds_read_b128 v[244:247], v2 offset:11264
    v_mfma_f32_16x16x32_bf16 v[104:107], a[108:111], v[232:235], v[104:107]
    ds_read_b128 v[248:251], v2 offset:18432
    v_mfma_f32_16x16x32_bf16 v[132:135], a[108:111], v[236:239], v[132:135]
    ds_read_b128 v[252:255], v2 offset:25600
    v_mfma_f32_16x16x32_bf16 v[52:55], a[112:115], v[224:227], v[52:55]
    v_mfma_f32_16x16x32_bf16 v[80:83], a[112:115], v[228:231], v[80:83]
    v_mfma_f32_16x16x32_bf16 v[108:111], a[112:115], v[232:235], v[108:111]
    v_mfma_f32_16x16x32_bf16 v[136:139], a[112:115], v[236:239], v[136:139]
    v_mfma_f32_16x16x32_bf16 v[56:59], a[116:119], v[224:227], v[56:59]
    v_mfma_f32_16x16x32_bf16 v[84:87], a[116:119], v[228:231], v[84:87]
    v_mfma_f32_16x16x32_bf16 v[112:115], a[116:119], v[232:235], v[112:115]
    v_mfma_f32_16x16x32_bf16 v[140:143], a[116:119], v[236:239], v[140:143]
    s_waitcnt lgkmcnt(0)
    v_mfma_f32_16x16x32_bf16 v[48:51], a[120:123], v[240:243], v[48:51]
    ds_read_b128 v[224:227], v2 offset:5120
    v_mfma_f32_16x16x32_bf16 v[76:79], a[120:123], v[244:247], v[76:79]
    ds_read_b128 v[228:231], v2 offset:12288
    v_mfma_f32_16x16x32_bf16 v[104:107], a[120:123], v[248:251], v[104:107]
    ds_read_b128 v[232:235], v2 offset:19456
    v_mfma_f32_16x16x32_bf16 v[132:135], a[120:123], v[252:255], v[132:135]
    ds_read_b128 v[236:239], v2 offset:26624
    v_mfma_f32_16x16x32_bf16 v[52:55], a[124:127], v[240:243], v[52:55]
    v_mfma_f32_16x16x32_bf16 v[80:83], a[124:127], v[244:247], v[80:83]
    v_mfma_f32_16x16x32_bf16 v[108:111], a[124:127], v[248:251], v[108:111]
    v_mfma_f32_16x16x32_bf16 v[136:139], a[124:127], v[252:255], v[136:139]
    v_mfma_f32_16x16x32_bf16 v[56:59], a[128:131], v[240:243], v[56:59]
    v_mfma_f32_16x16x32_bf16 v[84:87], a[128:131], v[244:247], v[84:87]
    v_mfma_f32_16x16x32_bf16 v[112:115], a[128:131], v[248:251], v[112:115]
    v_mfma_f32_16x16x32_bf16 v[140:143], a[128:131], v[252:255], v[140:143]
    s_waitcnt lgkmcnt(0)
    v_mfma_f32_16x16x32_bf16 v[48:51], a[132:135], v[224:227], v[48:51]
    ds_read_b128 v[240:243], v2 offset:6144
    v_mfma_f32_16x16x32_bf16 v[76:79], a[132:135], v[228:231], v[76:79]
    ds_read_b128 v[244:247], v2 offset:13312
    v_mfma_f32_16x16x32_bf16 v[104:107], a[132:135], v[232:235], v[104:107]
    ds_read_b128 v[248:251], v2 offset:20480
    v_mfma_f32_16x16x32_bf16 v[132:135], a[132:135], v[236:239], v[132:135]
    ds_read_b128 v[252:255], v2 offset:27648
    v_mfma_f32_16x16x32_bf16 v[52:55], a[136:139], v[224:227], v[52:55]
    v_mfma_f32_16x16x32_bf16 v[80:83], a[136:139], v[228:231], v[80:83]
    v_mfma_f32_16x16x32_bf16 v[108:111], a[136:139], v[232:235], v[108:111]
    v_mfma_f32_16x16x32_bf16 v[136:139], a[136:139], v[236:239], v[136:139]
    v_mfma_f32_16x16x32_bf16 v[56:59], a[140:143], v[224:227], v[56:59]
    v_mfma_f32_16x16x32_bf16 v[84:87], a[140:143], v[228:231], v[84:87]
    v_mfma_f32_16x16x32_bf16 v[112:115], a[140:143], v[232:235], v[112:115]
    v_mfma_f32_16x16x32_bf16 v[140:143], a[140:143], v[236:239], v[140:143]
    s_waitcnt lgkmcnt(0)
    v_mfma_f32_16x16x32_bf16 v[48:51], a[144:147], v[240:243], v[48:51]
    ds_read_b128 v[224:227], v3 offset:0
    v_mfma_f32_16x16x32_bf16 v[76:79], a[144:147], v[244:247], v[76:79]
    ds_read_b128 v[228:231], v3 offset:7168
    v_mfma_f32_16x16x32_bf16 v[104:107], a[144:147], v[248:251], v[104:107]
    ds_read_b128 v[232:235], v3 offset:14336
    v_mfma_f32_16x16x32_bf16 v[132:135], a[144:147], v[252:255], v[132:135]
    ds_read_b128 v[236:239], v3 offset:21504
    v_mfma_f32_16x16x32_bf16 v[52:55], a[148:151], v[240:243], v[52:55]
    v_mfma_f32_16x16x32_bf16 v[80:83], a[148:151], v[244:247], v[80:83]
    v_mfma_f32_16x16x32_bf16 v[108:111], a[148:151], v[248:251], v[108:111]
    v_mfma_f32_16x16x32_bf16 v[136:139], a[148:151], v[252:255], v[136:139]
    v_mfma_f32_16x16x32_bf16 v[56:59], a[152:155], v[240:243], v[56:59]
    v_mfma_f32_16x16x32_bf16 v[84:87], a[152:155], v[244:247], v[84:87]
    v_mfma_f32_16x16x32_bf16 v[112:115], a[152:155], v[248:251], v[112:115]
    v_mfma_f32_16x16x32_bf16 v[140:143], a[152:155], v[252:255], v[140:143]
    s_waitcnt lgkmcnt(0)
    v_mfma_f32_16x16x32_bf16 v[60:63], a[156:159], v[224:227], v[60:63]
    ds_read_b128 v[240:243], v4 offset:0
    v_mfma_f32_16x16x32_bf16 v[88:91], a[156:159], v[228:231], v[88:91]
    ds_read_b128 v[244:247], v4 offset:7168
    v_mfma_f32_16x16x32_bf16 v[116:119], a[156:159], v[232:235], v[116:119]
    ds_read_b128 v[248:251], v4 offset:14336
    v_mfma_f32_16x16x32_bf16 v[144:147], a[156:159], v[236:239], v[144:147]
    ds_read_b128 v[252:255], v4 offset:21504
    v_mfma_f32_16x16x32_bf16 v[64:67], a[160:163], v[224:227], v[64:67]
    v_cvt_pk_bf16_f32 v48, v48, v49
    v_mfma_f32_16x16x32_bf16 v[92:95], a[160:163], v[228:231], v[92:95]
    v_cvt_pk_bf16_f32 v49, v50, v51
    v_mfma_f32_16x16x32_bf16 v[120:123], a[160:163], v[232:235], v[120:123]
    v_cvt_pk_bf16_f32 v50, v76, v77
    v_mfma_f32_16x16x32_bf16 v[148:151], a[160:163], v[236:239], v[148:151]
    v_cvt_pk_bf16_f32 v51, v78, v79
    s_waitcnt lgkmcnt(0)
    v_mfma_f32_16x16x32_bf16 v[60:63], a[164:167], v[240:243], v[60:63]
    ds_read_b128 v[224:227], v5 offset:0
    buffer_store_dwordx4 v[48:51], v9, s[8:11], s38 offen offset:0 sc1
    v_mfma_f32_16x16x32_bf16 v[88:91], a[164:167], v[244:247], v[88:91]
    ds_read_b128 v[228:231], v5 offset:7168
    s_mov_b64 exec, s[44:45]
    ds_write_b128 v220, v[48:51] offset:0
    s_mov_b64 exec, -1
    v_mfma_f32_16x16x32_bf16 v[116:119], a[164:167], v[248:251], v[116:119]
    ds_read_b128 v[232:235], v5 offset:14336
    v_cvt_pk_bf16_f32 v104, v104, v105
    v_mfma_f32_16x16x32_bf16 v[144:147], a[164:167], v[252:255], v[144:147]
    ds_read_b128 v[236:239], v5 offset:21504
    v_cvt_pk_bf16_f32 v105, v106, v107
    v_mfma_f32_16x16x32_bf16 v[64:67], a[168:171], v[240:243], v[64:67]
    v_cvt_pk_bf16_f32 v106, v132, v133
    v_mfma_f32_16x16x32_bf16 v[92:95], a[168:171], v[244:247], v[92:95]
    v_cvt_pk_bf16_f32 v107, v134, v135
    v_mfma_f32_16x16x32_bf16 v[120:123], a[168:171], v[248:251], v[120:123]
    buffer_store_dwordx4 v[104:107], v218, s[8:11], s39 offen offset:0 sc1
    v_mfma_f32_16x16x32_bf16 v[148:151], a[168:171], v[252:255], v[148:151]
    s_mov_b64 exec, s[46:47]
    ds_write_b128 v220, v[104:107] offset:0
    s_mov_b64 exec, -1
    s_waitcnt lgkmcnt(1)
    v_mfma_f32_16x16x32_bf16 v[60:63], a[172:175], v[224:227], v[60:63]
    ds_read_b128 v[240:243], v2 offset:4096
    v_cvt_pk_bf16_f32 v52, v52, v53
    v_mfma_f32_16x16x32_bf16 v[88:91], a[172:175], v[228:231], v[88:91]
    ds_read_b128 v[244:247], v2 offset:11264
    v_cvt_pk_bf16_f32 v53, v54, v55
    v_mfma_f32_16x16x32_bf16 v[116:119], a[172:175], v[232:235], v[116:119]
    ds_read_b128 v[248:251], v2 offset:18432
    v_cvt_pk_bf16_f32 v54, v80, v81
    v_mfma_f32_16x16x32_bf16 v[144:147], a[172:175], v[236:239], v[144:147]
    ds_read_b128 v[252:255], v2 offset:25600
    v_cvt_pk_bf16_f32 v55, v82, v83
    v_mfma_f32_16x16x32_bf16 v[64:67], a[176:179], v[224:227], v[64:67]
    buffer_store_dwordx4 v[52:55], v9, s[8:11], s38 offen offset:256 sc1
    v_mfma_f32_16x16x32_bf16 v[92:95], a[176:179], v[228:231], v[92:95]
    s_mov_b64 exec, s[44:45]
    ds_write_b128 v220, v[52:55] offset:256
    s_mov_b64 exec, -1
    v_mfma_f32_16x16x32_bf16 v[120:123], a[176:179], v[232:235], v[120:123]
    v_cvt_pk_bf16_f32 v108, v108, v109
    v_mfma_f32_16x16x32_bf16 v[148:151], a[176:179], v[236:239], v[148:151]
    v_cvt_pk_bf16_f32 v109, v110, v111
    s_waitcnt lgkmcnt(1)
    v_mfma_f32_16x16x32_bf16 v[60:63], a[180:183], v[240:243], v[60:63]
    ds_read_b128 v[224:227], v2 offset:5120
    v_cvt_pk_bf16_f32 v110, v136, v137
    v_mfma_f32_16x16x32_bf16 v[88:91], a[180:183], v[244:247], v[88:91]
    ds_read_b128 v[228:231], v2 offset:12288
    v_cvt_pk_bf16_f32 v111, v138, v139
    v_mfma_f32_16x16x32_bf16 v[116:119], a[180:183], v[248:251], v[116:119]
    ds_read_b128 v[232:235], v2 offset:19456
    buffer_store_dwordx4 v[108:111], v218, s[8:11], s39 offen offset:256 sc1
    v_mfma_f32_16x16x32_bf16 v[144:147], a[180:183], v[252:255], v[144:147]
    ds_read_b128 v[236:239], v2 offset:26624
    s_mov_b64 exec, s[46:47]
    ds_write_b128 v220, v[108:111] offset:256
    s_mov_b64 exec, -1
    v_mfma_f32_16x16x32_bf16 v[64:67], a[184:187], v[240:243], v[64:67]
    v_cvt_pk_bf16_f32 v56, v56, v57
    v_mfma_f32_16x16x32_bf16 v[92:95], a[184:187], v[244:247], v[92:95]
    v_cvt_pk_bf16_f32 v57, v58, v59
    v_mfma_f32_16x16x32_bf16 v[120:123], a[184:187], v[248:251], v[120:123]
    v_cvt_pk_bf16_f32 v58, v84, v85
    v_mfma_f32_16x16x32_bf16 v[148:151], a[184:187], v[252:255], v[148:151]
    v_cvt_pk_bf16_f32 v59, v86, v87
    s_waitcnt lgkmcnt(1)
    v_mfma_f32_16x16x32_bf16 v[60:63], a[188:191], v[224:227], v[60:63]
    ds_read_b128 v[240:243], v2 offset:6144
    buffer_store_dwordx4 v[56:59], v9, s[8:11], s38 offen offset:512 sc1
    v_mfma_f32_16x16x32_bf16 v[88:91], a[188:191], v[228:231], v[88:91]
    ds_read_b128 v[244:247], v2 offset:13312
    s_mov_b64 exec, s[44:45]
    ds_write_b128 v220, v[56:59] offset:512
    s_mov_b64 exec, -1
    v_mfma_f32_16x16x32_bf16 v[116:119], a[188:191], v[232:235], v[116:119]
    ds_read_b128 v[248:251], v2 offset:20480
    v_cvt_pk_bf16_f32 v112, v112, v113
    v_mfma_f32_16x16x32_bf16 v[144:147], a[188:191], v[236:239], v[144:147]
    ds_read_b128 v[252:255], v2 offset:27648
    v_cvt_pk_bf16_f32 v113, v114, v115
    v_mfma_f32_16x16x32_bf16 v[64:67], a[192:195], v[224:227], v[64:67]
    v_cvt_pk_bf16_f32 v114, v140, v141
    v_mfma_f32_16x16x32_bf16 v[92:95], a[192:195], v[228:231], v[92:95]
    v_cvt_pk_bf16_f32 v115, v142, v143
    v_mfma_f32_16x16x32_bf16 v[120:123], a[192:195], v[232:235], v[120:123]
    buffer_store_dwordx4 v[112:115], v218, s[8:11], s39 offen offset:512 sc1
    v_mfma_f32_16x16x32_bf16 v[148:151], a[192:195], v[236:239], v[148:151]
    s_mov_b64 exec, s[46:47]
    ds_write_b128 v220, v[112:115] offset:512
    s_mov_b64 exec, -1
    s_waitcnt lgkmcnt(1)
    v_mfma_f32_16x16x32_bf16 v[60:63], a[196:199], v[240:243], v[60:63]
    ds_read_b128 v[224:227], v3 offset:0
    v_mfma_f32_16x16x32_bf16 v[88:91], a[196:199], v[244:247], v[88:91]
    ds_read_b128 v[228:231], v3 offset:7168
    v_mfma_f32_16x16x32_bf16 v[116:119], a[196:199], v[248:251], v[116:119]
    ds_read_b128 v[232:235], v3 offset:14336
    v_mfma_f32_16x16x32_bf16 v[144:147], a[196:199], v[252:255], v[144:147]
    ds_read_b128 v[236:239], v3 offset:21504
    v_mfma_f32_16x16x32_bf16 v[64:67], a[200:203], v[240:243], v[64:67]
    v_mfma_f32_16x16x32_bf16 v[92:95], a[200:203], v[244:247], v[92:95]
    v_mfma_f32_16x16x32_bf16 v[120:123], a[200:203], v[248:251], v[120:123]
    v_mfma_f32_16x16x32_bf16 v[148:151], a[200:203], v[252:255], v[148:151]
    s_waitcnt lgkmcnt(0)
    v_mfma_f32_16x16x32_bf16 v[68:71], a[204:207], v[224:227], v[68:71]
    ds_read_b128 v[240:243], v4 offset:0
    v_mfma_f32_16x16x32_bf16 v[96:99], a[204:207], v[228:231], v[96:99]
    ds_read_b128 v[244:247], v4 offset:7168
    v_mfma_f32_16x16x32_bf16 v[124:127], a[204:207], v[232:235], v[124:127]
    ds_read_b128 v[248:251], v4 offset:14336
    v_mfma_f32_16x16x32_bf16 v[152:155], a[204:207], v[236:239], v[152:155]
    ds_read_b128 v[252:255], v4 offset:21504
    v_mfma_f32_16x16x32_bf16 v[72:75], a[208:211], v[224:227], v[72:75]
    v_cvt_pk_bf16_f32 v60, v60, v61
    v_mfma_f32_16x16x32_bf16 v[100:103], a[208:211], v[228:231], v[100:103]
    v_cvt_pk_bf16_f32 v61, v62, v63
    v_mfma_f32_16x16x32_bf16 v[128:131], a[208:211], v[232:235], v[128:131]
    v_cvt_pk_bf16_f32 v62, v88, v89
    v_mfma_f32_16x16x32_bf16 v[156:159], a[208:211], v[236:239], v[156:159]
    v_cvt_pk_bf16_f32 v63, v90, v91
    s_waitcnt lgkmcnt(0)
    v_mfma_f32_16x16x32_bf16 v[68:71], a[212:215], v[240:243], v[68:71]
    ds_read_b128 v[224:227], v5 offset:0
    buffer_store_dwordx4 v[60:63], v9, s[8:11], s38 offen offset:768
    v_mfma_f32_16x16x32_bf16 v[96:99], a[212:215], v[244:247], v[96:99]
    ds_read_b128 v[228:231], v5 offset:7168
    s_mov_b64 exec, s[44:45]
    ds_write_b128 v220, v[60:63] offset:768
    s_mov_b64 exec, -1
    v_mfma_f32_16x16x32_bf16 v[124:127], a[212:215], v[248:251], v[124:127]
    ds_read_b128 v[232:235], v5 offset:14336
    v_cvt_pk_bf16_f32 v116, v116, v117
    v_mfma_f32_16x16x32_bf16 v[152:155], a[212:215], v[252:255], v[152:155]
    ds_read_b128 v[236:239], v5 offset:21504
    v_cvt_pk_bf16_f32 v117, v118, v119
    v_mfma_f32_16x16x32_bf16 v[72:75], a[216:219], v[240:243], v[72:75]
    v_cvt_pk_bf16_f32 v118, v144, v145
    v_mfma_f32_16x16x32_bf16 v[100:103], a[216:219], v[244:247], v[100:103]
    v_cvt_pk_bf16_f32 v119, v146, v147
    v_mfma_f32_16x16x32_bf16 v[128:131], a[216:219], v[248:251], v[128:131]
    buffer_store_dwordx4 v[116:119], v218, s[8:11], s39 offen offset:768
    v_mfma_f32_16x16x32_bf16 v[156:159], a[216:219], v[252:255], v[156:159]
    s_mov_b64 exec, s[46:47]
    ds_write_b128 v220, v[116:119] offset:768
    s_mov_b64 exec, -1
    s_waitcnt lgkmcnt(1)
    v_mfma_f32_16x16x32_bf16 v[68:71], a[220:223], v[224:227], v[68:71]
    ds_read_b128 v[240:243], v2 offset:4096
    v_cvt_pk_bf16_f32 v64, v64, v65
    v_mfma_f32_16x16x32_bf16 v[96:99], a[220:223], v[228:231], v[96:99]
    ds_read_b128 v[244:247], v2 offset:11264
    v_cvt_pk_bf16_f32 v65, v66, v67
    v_mfma_f32_16x16x32_bf16 v[124:127], a[220:223], v[232:235], v[124:127]
    ds_read_b128 v[248:251], v2 offset:18432
    v_cvt_pk_bf16_f32 v66, v92, v93
    v_mfma_f32_16x16x32_bf16 v[152:155], a[220:223], v[236:239], v[152:155]
    ds_read_b128 v[252:255], v2 offset:25600
    v_cvt_pk_bf16_f32 v67, v94, v95
    v_mfma_f32_16x16x32_bf16 v[72:75], a[224:227], v[224:227], v[72:75]
    buffer_store_dwordx4 v[64:67], v9, s[8:11], s38 offen offset:1024
    v_mfma_f32_16x16x32_bf16 v[100:103], a[224:227], v[228:231], v[100:103]
    s_mov_b64 exec, s[44:45]
    ds_write_b128 v220, v[64:67] offset:1024
    s_mov_b64 exec, -1
    v_mfma_f32_16x16x32_bf16 v[128:131], a[224:227], v[232:235], v[128:131]
    v_cvt_pk_bf16_f32 v120, v120, v121
    v_mfma_f32_16x16x32_bf16 v[156:159], a[224:227], v[236:239], v[156:159]
    v_cvt_pk_bf16_f32 v121, v122, v123
    s_waitcnt lgkmcnt(1)
    v_mfma_f32_16x16x32_bf16 v[68:71], a[228:231], v[240:243], v[68:71]
    ds_read_b128 v[224:227], v2 offset:5120
    v_cvt_pk_bf16_f32 v122, v148, v149
    v_mfma_f32_16x16x32_bf16 v[96:99], a[228:231], v[244:247], v[96:99]
    ds_read_b128 v[228:231], v2 offset:12288
    v_cvt_pk_bf16_f32 v123, v150, v151
    v_mfma_f32_16x16x32_bf16 v[124:127], a[228:231], v[248:251], v[124:127]
    ds_read_b128 v[232:235], v2 offset:19456
    buffer_store_dwordx4 v[120:123], v218, s[8:11], s39 offen offset:1024
    v_mfma_f32_16x16x32_bf16 v[152:155], a[228:231], v[252:255], v[152:155]
    ds_read_b128 v[236:239], v2 offset:26624
    s_mov_b64 exec, s[46:47]
    ds_write_b128 v220, v[120:123] offset:1024
    s_mov_b64 exec, -1
    v_mfma_f32_16x16x32_bf16 v[72:75], a[232:235], v[240:243], v[72:75]
    v_mfma_f32_16x16x32_bf16 v[100:103], a[232:235], v[244:247], v[100:103]
    v_mfma_f32_16x16x32_bf16 v[128:131], a[232:235], v[248:251], v[128:131]
    v_mfma_f32_16x16x32_bf16 v[156:159], a[232:235], v[252:255], v[156:159]
    s_waitcnt lgkmcnt(1)
    v_mfma_f32_16x16x32_bf16 v[68:71], a[236:239], v[224:227], v[68:71]
    ds_read_b128 v[240:243], v2 offset:6144
    v_mfma_f32_16x16x32_bf16 v[96:99], a[236:239], v[228:231], v[96:99]
    ds_read_b128 v[244:247], v2 offset:13312
    v_mfma_f32_16x16x32_bf16 v[124:127], a[236:239], v[232:235], v[124:127]
    ds_read_b128 v[248:251], v2 offset:20480
    v_mfma_f32_16x16x32_bf16 v[152:155], a[236:239], v[236:239], v[152:155]
    ds_read_b128 v[252:255], v2 offset:27648
    v_mfma_f32_16x16x32_bf16 v[72:75], a[240:243], v[224:227], v[72:75]
    v_mfma_f32_16x16x32_bf16 v[100:103], a[240:243], v[228:231], v[100:103]
    v_mfma_f32_16x16x32_bf16 v[128:131], a[240:243], v[232:235], v[128:131]
    v_mfma_f32_16x16x32_bf16 v[156:159], a[240:243], v[236:239], v[156:159]
    s_waitcnt lgkmcnt(0)
    v_mfma_f32_16x16x32_bf16 v[68:71], a[244:247], v[240:243], v[68:71]
    v_mfma_f32_16x16x32_bf16 v[96:99], a[244:247], v[244:247], v[96:99]
    v_mfma_f32_16x16x32_bf16 v[124:127], a[244:247], v[248:251], v[124:127]
    v_mfma_f32_16x16x32_bf16 v[152:155], a[244:247], v[252:255], v[152:155]
    v_mfma_f32_16x16x32_bf16 v[72:75], a[248:251], v[240:243], v[72:75]
    s_nop 3
    v_cvt_pk_bf16_f32 v68, v68, v69
    v_cvt_pk_bf16_f32 v69, v70, v71
    v_mfma_f32_16x16x32_bf16 v[100:103], a[248:251], v[244:247], v[100:103]
    v_cvt_pk_bf16_f32 v70, v96, v97
    v_cvt_pk_bf16_f32 v71, v98, v99
    v_mfma_f32_16x16x32_bf16 v[128:131], a[248:251], v[248:251], v[128:131]
    buffer_store_dwordx4 v[68:71], v9, s[8:11], s38 offen offset:1280
    s_mov_b64 exec, s[44:45]
    ds_write_b128 v220, v[68:71] offset:1280
    s_mov_b64 exec, -1
    v_mfma_f32_16x16x32_bf16 v[156:159], a[248:251], v[252:255], v[156:159]
    v_cvt_pk_bf16_f32 v124, v124, v125
    v_cvt_pk_bf16_f32 v125, v126, v127
L_x1:
    v_cvt_pk_bf16_f32 v126, v152, v153
    v_cvt_pk_bf16_f32 v127, v154, v155
    buffer_store_dwordx4 v[124:127], v218, s[8:11], s39 offen offset:1280
    s_mov_b64 exec, s[46:47]
    ds_write_b128 v220, v[124:127] offset:1280
    s_mov_b64 exec, -1
    v_cvt_pk_bf16_f32 v72, v72, v73
    v_cvt_pk_bf16_f32 v73, v74, v75
    v_cvt_pk_bf16_f32 v74, v100, v101
    v_cvt_pk_bf16_f32 v75, v102, v103
    buffer_store_dwordx4 v[72:75], v9, s[8:11], s38 offen offset:1536
    s_mov_b64 exec, s[44:45]
    ds_write_b128 v220, v[72:75] offset:1536
    s_mov_b64 exec, -1
    v_cvt_pk_bf16_f32 v128, v128, v129
    v_cvt_pk_bf16_f32 v129, v130, v131
    v_cvt_pk_bf16_f32 v130, v156, v157
    v_cvt_pk_bf16_f32 v131, v158, v159
    buffer_store_dwordx4 v[128:131], v218, s[8:11], s39 offen offset:1536
    s_mov_b64 exec, s[46:47]
    ds_write_b128 v220, v[128:131] offset:1536
    s_mov_b64 exec, -1
    s_mov_b32 s33, 32768
    s_lshl_b32 s26, s22, 11
    s_add_u32 s26, s26, 146944
    v_lshrrev_b32 v220, 8, v1
    v_lshl_add_u32 v220, v220, 8, v1
    v_add_u32 v220, s26, v220
    s_waitcnt lgkmcnt(0)
    s_barrier
    ds_read_b128 v[104:107], v220 offset:0
    ds_read_b128 v[108:111], v220 offset:256
    s_waitcnt vmcnt(0)
    s_mov_b64 exec, 1
    buffer_store_dword v43, v14, s[8:11], s33 offen offset:0
    s_mov_b64 exec, -1
    s_waitcnt lgkmcnt(1)
    v_dot2_f32_bf16 v16, v104, s40, v16
    v_dot2_f32_bf16 v17, v104, s41, v17
    v_dot2_f32_bf16 v18, v105, s40, v18
    v_dot2_f32_bf16 v19, v105, s41, v19
    v_dot2_f32_bf16 v24, v106, s40, v24
    v_dot2_f32_bf16 v25, v106, s41, v25
    v_dot2_f32_bf16 v26, v107, s40, v26
    v_dot2_f32_bf16 v27, v107, s41, v27
    s_waitcnt lgkmcnt(0)
    v_dot2_f32_bf16 v20, v108, s40, v20
    v_dot2_f32_bf16 v21, v108, s41, v21
    v_dot2_f32_bf16 v22, v109, s40, v22
    v_dot2_f32_bf16 v23, v109, s41, v23
    v_dot2_f32_bf16 v28, v110, s40, v28
    v_dot2_f32_bf16 v29, v110, s41, v29
    v_dot2_f32_bf16 v30, v111, s40, v30
    v_dot2_f32_bf16 v31, v111, s41, v31
    s_lshl_b32 s26, s22, 11
    s_add_u32 s26, s26, 155136
    v_add_u32 v222, s26, v1
    v_lshrrev_b32 v221, 2, v1
    v_and_b32 v221, 0xf0, v221
    v_and_b32 v223, 48, v1
    v_lshl_add_u32 v221, v223, 4, v221
    v_add_u32 v221, s26, v221
    s_mov_b32 s34, 0
    buffer_load_dword v42, v15, s[8:11], s33 offen sc1
L_pp_6:
    buffer_load_dword v47, v15, s[8:11], s33 offen sc1
    s_waitcnt vmcnt(1)
    v_and_b32 v46, -16, v42
    v_cmp_ne_u32 vcc, s42, v46
    s_cbranch_vccz L_pp_6_x
    buffer_load_dword v42, v15, s[8:11], s33 offen sc1
    s_waitcnt vmcnt(1)
    v_and_b32 v46, -16, v47
    v_cmp_ne_u32 vcc, s42, v46
    s_cbranch_vccz L_pp_6_x
    s_add_u32 s34, s34, 1
    s_cmp_lt_u32 s34, 1048576
    s_cbranch_scc1 L_pp_6
L_pp_6_x:
    s_mov_b32 s33, 18874368
    buffer_load_dwordx4 v[48:51], v10, s[8:11], s33 offen offset:0 sc1
    buffer_load_dwordx4 v[52:55], v10, s[8:11], s33 offen offset:256 sc1
    s_mov_b32 s33, 18881536
    buffer_load_dwordx4 v[56:59], v10, s[8:11], s33 offen offset:0 sc1
    buffer_load_dwordx4 v[60:63], v10, s[8:11], s33 offen offset:256 sc1
    s_mov_b32 s33, 18888704
    buffer_load_dwordx4 v[64:67], v10, s[8:11], s33 offen offset:0 sc1
    buffer_load_dwordx4 v[68:71], v10, s[8:11], s33 offen offset:256 sc1
    s_mov_b32 s33, 18895872
    buffer_load_dwordx4 v[72:75], v10, s[8:11], s33 offen offset:0 sc1
    buffer_load_dwordx4 v[76:79], v10, s[8:11], s33 offen offset:256 sc1
    s_mov_b32 s33, 18903040
    buffer_load_dwordx4 v[80:83], v10, s[8:11], s33 offen offset:0 sc1
    buffer_load_dwordx4 v[84:87], v10, s[8:11], s33 offen offset:256 sc1
    s_mov_b32 s33, 18910208
    buffer_load_dwordx4 v[88:91], v10, s[8:11], s33 offen offset:0 sc1
    buffer_load_dwordx4 v[92:95], v10, s[8:11], s33 offen offset:256 sc1
    s_mov_b32 s33, 18917376
    buffer_load_dwordx4 v[96:99], v10, s[8:11], s33 offen offset:0 sc1
    buffer_load_dwordx4 v[100:103], v10, s[8:11], s33 offen offset:256 sc1
    s_waitcnt vmcnt(13)
    v_dot2_f32_bf16 v16, v48, s40, v16
    v_dot2_f32_bf16 v17, v48, s41, v17
    v_dot2_f32_bf16 v18, v49, s40, v18
    v_dot2_f32_bf16 v19, v49, s41, v19
    v_dot2_f32_bf16 v24, v50, s40, v24
    v_dot2_f32_bf16 v25, v50, s41, v25
    v_dot2_f32_bf16 v26, v51, s40, v26
    v_dot2_f32_bf16 v27, v51, s41, v27
    s_waitcnt vmcnt(12)
    v_dot2_f32_bf16 v20, v52, s40, v20
    v_dot2_f32_bf16 v21, v52, s41, v21
    v_dot2_f32_bf16 v22, v53, s40, v22
    v_dot2_f32_bf16 v23, v53, s41, v23
    v_dot2_f32_bf16 v28, v54, s40, v28
    v_dot2_f32_bf16 v29, v54, s41, v29
    v_dot2_f32_bf16 v30, v55, s40, v30
    v_dot2_f32_bf16 v31, v55, s41, v31
    s_waitcnt vmcnt(11)
    v_dot2_f32_bf16 v16, v56, s40, v16
    v_dot2_f32_bf16 v17, v56, s41, v17
    v_dot2_f32_bf16 v18, v57, s40, v18
    v_dot2_f32_bf16 v19, v57, s41, v19
    v_dot2_f32_bf16 v24, v58, s40, v24
    v_dot2_f32_bf16 v25, v58, s41, v25
    v_dot2_f32_bf16 v26, v59, s40, v26
    v_dot2_f32_bf16 v27, v59, s41, v27
    s_waitcnt vmcnt(10)
    v_dot2_f32_bf16 v20, v60, s40, v20
    v_dot2_f32_bf16 v21, v60, s41, v21
    v_dot2_f32_bf16 v22, v61, s40, v22
    v_dot2_f32_bf16 v23, v61, s41, v23
    v_dot2_f32_bf16 v28, v62, s40, v28
    v_dot2_f32_bf16 v29, v62, s41, v29
    v_dot2_f32_bf16 v30, v63, s40, v30
    v_dot2_f32_bf16 v31, v63, s41, v31
    s_waitcnt vmcnt(9)
    v_dot2_f32_bf16 v16, v64, s40, v16
    v_dot2_f32_bf16 v17, v64, s41, v17
    v_dot2_f32_bf16 v18, v65, s40, v18
    v_dot2_f32_bf16 v19, v65, s41, v19
    v_dot2_f32_bf16 v24, v66, s40, v24
    v_dot2_f32_bf16 v25, v66, s41, v25
    v_dot2_f32_bf16 v26, v67, s40, v26
    v_dot2_f32_bf16 v27, v67, s41, v27
    s_waitcnt vmcnt(8)
    v_dot2_f32_bf16 v20, v68, s40, v20
    v_dot2_f32_bf16 v21, v68, s41, v21
    v_dot2_f32_bf16 v22, v69, s40, v22
    v_dot2_f32_bf16 v23, v69, s41, v23
    v_dot2_f32_bf16 v28, v70, s40, v28
    v_dot2_f32_bf16 v29, v70, s41, v29
    v_dot2_f32_bf16 v30, v71, s40, v30
    v_dot2_f32_bf16 v31, v71, s41, v31
    s_waitcnt vmcnt(7)
    v_dot2_f32_bf16 v16, v72, s40, v16
    v_dot2_f32_bf16 v17, v72, s41, v17
    v_dot2_f32_bf16 v18, v73, s40, v18
    v_dot2_f32_bf16 v19, v73, s41, v19
    v_dot2_f32_bf16 v24, v74, s40, v24
    v_dot2_f32_bf16 v25, v74, s41, v25
    v_dot2_f32_bf16 v26, v75, s40, v26
    v_dot2_f32_bf16 v27, v75, s41, v27
    s_waitcnt vmcnt(6)
    v_dot2_f32_bf16 v20, v76, s40, v20
    v_dot2_f32_bf16 v21, v76, s41, v21
    v_dot2_f32_bf16 v22, v77, s40, v22
    v_dot2_f32_bf16 v23, v77, s41, v23
    v_dot2_f32_bf16 v28, v78, s40, v28
    v_dot2_f32_bf16 v29, v78, s41, v29
    v_dot2_f32_bf16 v30, v79, s40, v30
    v_dot2_f32_bf16 v31, v79, s41, v31
    s_waitcnt vmcnt(5)
    v_dot2_f32_bf16 v16, v80, s40, v16
    v_dot2_f32_bf16 v17, v80, s41, v17
    v_dot2_f32_bf16 v18, v81, s40, v18
    v_dot2_f32_bf16 v19, v81, s41, v19
    v_dot2_f32_bf16 v24, v82, s40, v24
    v_dot2_f32_bf16 v25, v82, s41, v25
    v_dot2_f32_bf16 v26, v83, s40, v26
    v_dot2_f32_bf16 v27, v83, s41, v27
    s_waitcnt vmcnt(4)
    v_dot2_f32_bf16 v20, v84, s40, v20
    v_dot2_f32_bf16 v21, v84, s41, v21
    v_dot2_f32_bf16 v22, v85, s40, v22
    v_dot2_f32_bf16 v23, v85, s41, v23
    v_dot2_f32_bf16 v28, v86, s40, v28
    v_dot2_f32_bf16 v29, v86, s41, v29
    v_dot2_f32_bf16 v30, v87, s40, v30
    v_dot2_f32_bf16 v31, v87, s41, v31
    s_waitcnt vmcnt(3)
    v_dot2_f32_bf16 v16, v88, s40, v16
    v_dot2_f32_bf16 v17, v88, s41, v17
    v_dot2_f32_bf16 v18, v89, s40, v18
    v_dot2_f32_bf16 v19, v89, s41, v19
    v_dot2_f32_bf16 v24, v90, s40, v24
    v_dot2_f32_bf16 v25, v90, s41, v25
    v_dot2_f32_bf16 v26, v91, s40, v26
    v_dot2_f32_bf16 v27, v91, s41, v27
    s_waitcnt vmcnt(2)
    v_dot2_f32_bf16 v20, v92, s40, v20
    v_dot2_f32_bf16 v21, v92, s41, v21
    v_dot2_f32_bf16 v22, v93, s40, v22
    v_dot2_f32_bf16 v23, v93, s41, v23
    v_dot2_f32_bf16 v28, v94, s40, v28
    v_dot2_f32_bf16 v29, v94, s41, v29
    v_dot2_f32_bf16 v30, v95, s40, v30
    v_dot2_f32_bf16 v31, v95, s41, v31
    s_waitcnt vmcnt(1)
    v_dot2_f32_bf16 v16, v96, s40, v16
    v_dot2_f32_bf16 v17, v96, s41, v17
    v_dot2_f32_bf16 v18, v97, s40, v18
    v_dot2_f32_bf16 v19, v97, s41, v19
    v_dot2_f32_bf16 v24, v98, s40, v24
    v_dot2_f32_bf16 v25, v98, s41, v25
    v_dot2_f32_bf16 v26, v99, s40, v26
    v_dot2_f32_bf16 v27, v99, s41, v27
    s_waitcnt vmcnt(0)
    v_dot2_f32_bf16 v20, v100, s40, v20
    v_dot2_f32_bf16 v21, v100, s41, v21
    v_dot2_f32_bf16 v22, v101, s40, v22
    v_dot2_f32_bf16 v23, v101, s41, v23
    v_dot2_f32_bf16 v28, v102, s40, v28
    v_dot2_f32_bf16 v29, v102, s41, v29
    v_dot2_f32_bf16 v30, v103, s40, v30
    v_dot2_f32_bf16 v31, v103, s41, v31
    v_cvt_pk_bf16_f32 v144, v16, v17
    v_cvt_pk_bf16_f32 v145, v18, v19
    v_cvt_pk_bf16_f32 v146, v20, v21
    v_cvt_pk_bf16_f32 v147, v22, v23
    ds_write_b128 v221, v[144:147] offset:0
    v_cvt_pk_bf16_f32 v148, v24, v25
    v_cvt_pk_bf16_f32 v149, v26, v27
    v_cvt_pk_bf16_f32 v150, v28, v29
    v_cvt_pk_bf16_f32 v151, v30, v31
    ds_write_b128 v221, v[148:151] offset:1024
    ds_read_b128 v[144:147], v222 offset:0
    ds_read_b128 v[148:151], v222 offset:1024
    s_waitcnt lgkmcnt(1)
    buffer_store_dwordx4 v[144:147], v12, s[52:55], 0 offen offset:0
    s_waitcnt lgkmcnt(0)
    buffer_store_dwordx4 v[148:151], v12, s[52:55], 0 offen offset:896
    s_add_u32 s43, s43, 1
    v_mov_b32 v43, s43
    s_cmp_eq_u32 s2, 0
    s_cselect_b32 s26, 0, 2147483648
    s_mov_b64 exec, 1
    buffer_store_dword v43, off, s[8:11], s26
    s_mov_b64 exec, -1
L_end:
    s_endpgm
L_code_end:
L_global:
    s_mov_b32 s38, 18874368
    s_mov_b32 s39, 19103744
    ds_read_b128 v[224:227], v1 offset:0
    ds_read_b128 v[228:231], v1 offset:14336
    ds_read_b128 v[232:235], v1 offset:28672
    ds_read_b128 v[236:239], v1 offset:43008
    ds_read_b128 v[220:223], v0 offset:0
    s_waitcnt lgkmcnt(4)
    v_mfma_f32_16x16x32_bf16 v[48:51], a[0:3], v[224:227], 0
    s_waitcnt lgkmcnt(3)
    v_mfma_f32_16x16x32_bf16 v[76:79], a[0:3], v[228:231], 0
    s_waitcnt lgkmcnt(2)
    v_mfma_f32_16x16x32_bf16 v[104:107], a[0:3], v[232:235], 0
    s_waitcnt lgkmcnt(1)
    v_mfma_f32_16x16x32_bf16 v[132:135], a[0:3], v[236:239], 0
    ds_read_b128 v[240:243], v1 offset:1024
    s_waitcnt lgkmcnt(1)
    v_mfma_f32_16x16x32_bf16 v[52:55], v[220:223], v[224:227], 0
    v_mfma_f32_16x16x32_bf16 v[80:83], v[220:223], v[228:231], 0
    buffer_load_dwordx4 a[28:31], v13, s[8:11], s67 offen offset:0
    v_mfma_f32_16x16x32_bf16 v[108:111], v[220:223], v[232:235], 0
    v_mfma_f32_16x16x32_bf16 v[136:139], v[220:223], v[236:239], 0
    ds_read_b128 v[244:247], v1 offset:15360
    v_mfma_f32_16x16x32_bf16 v[56:59], v[160:163], v[224:227], 0
    v_mfma_f32_16x16x32_bf16 v[84:87], v[160:163], v[228:231], 0
    ds_read_b128 v[220:223], v0 offset:1024
    v_mfma_f32_16x16x32_bf16 v[112:115], v[160:163], v[232:235], 0
    v_mfma_f32_16x16x32_bf16 v[140:143], v[160:163], v[236:239], 0
    ds_read_b128 v[248:251], v1 offset:29696
    v_mfma_f32_16x16x32_bf16 v[60:63], v[164:167], v[224:227], 0
    v_mfma_f32_16x16x32_bf16 v[88:91], v[164:167], v[228:231], 0
    buffer_load_dwordx4 v[160:163], v219, s[8:11], s62 offen offset:2048
    v_mfma_f32_16x16x32_bf16 v[116:119], v[164:167], v[232:235], 0
    v_mfma_f32_16x16x32_bf16 v[144:147], v[164:167], v[236:239], 0
    ds_read_b128 v[252:255], v1 offset:44032
    v_mfma_f32_16x16x32_bf16 v[64:67], v[168:171], v[224:227], 0
    v_mfma_f32_16x16x32_bf16 v[92:95], v[168:171], v[228:231], 0
    buffer_load_dwordx4 v[164:167], v13, s[8:11], s63 offen offset:2048
    v_mfma_f32_16x16x32_bf16 v[120:123], v[168:171], v[232:235], 0
    v_mfma_f32_16x16x32_bf16 v[148:151], v[168:171], v[236:239], 0
    s_add_u32 m0, s57, 7168
    s_nop 0
    buffer_load_dwordx4 v13, s[8:11], s67 offen offset:1024 lds
    v_mfma_f32_16x16x32_bf16 v[68:71], v[172:175], v[224:227], 0
    v_mfma_f32_16x16x32_bf16 v[96:99], v[172:175], v[228:231], 0
    buffer_load_dwordx4 v[168:171], v13, s[8:11], s63 offen offset:3072
    v_mfma_f32_16x16x32_bf16 v[124:127], v[172:175], v[232:235], 0
    v_mfma_f32_16x16x32_bf16 v[152:155], v[172:175], v[236:239], 0
    v_mfma_f32_16x16x32_bf16 v[72:75], v[176:179], v[224:227], 0
    v_mfma_f32_16x16x32_bf16 v[100:103], v[176:179], v[228:231], 0
    buffer_load_dwordx4 v[172:175], v219, s[8:11], s63 offen offset:0
    v_mfma_f32_16x16x32_bf16 v[128:131], v[176:179], v[232:235], 0
    v_mfma_f32_16x16x32_bf16 v[156:159], v[176:179], v[236:239], 0
    s_waitcnt lgkmcnt(0)
    v_mfma_f32_16x16x32_bf16 v[48:51], a[4:7], v[240:243], v[48:51]
    v_mfma_f32_16x16x32_bf16 v[76:79], a[4:7], v[244:247], v[76:79]
    buffer_load_dwordx4 v[176:179], v219, s[8:11], s63 offen offset:1024
    v_mfma_f32_16x16x32_bf16 v[104:107], a[4:7], v[248:251], v[104:107]
    v_mfma_f32_16x16x32_bf16 v[132:135], a[4:7], v[252:255], v[132:135]
    ds_read_b128 v[224:227], v1 offset:2048
    v_mfma_f32_16x16x32_bf16 v[52:55], v[220:223], v[240:243], v[52:55]
    v_mfma_f32_16x16x32_bf16 v[80:83], v[220:223], v[244:247], v[80:83]
    buffer_load_dwordx4 a[32:35], v13, s[8:11], s68 offen offset:0
    v_mfma_f32_16x16x32_bf16 v[108:111], v[220:223], v[248:251], v[108:111]
    v_mfma_f32_16x16x32_bf16 v[136:139], v[220:223], v[252:255], v[136:139]
    ds_read_b128 v[228:231], v1 offset:16384
    v_mfma_f32_16x16x32_bf16 v[56:59], v[180:183], v[240:243], v[56:59]
    v_mfma_f32_16x16x32_bf16 v[84:87], v[180:183], v[244:247], v[84:87]
    ds_read_b128 v[220:223], v0 offset:2048
    v_mfma_f32_16x16x32_bf16 v[112:115], v[180:183], v[248:251], v[112:115]
    v_mfma_f32_16x16x32_bf16 v[140:143], v[180:183], v[252:255], v[140:143]
    ds_read_b128 v[232:235], v1 offset:30720
    v_mfma_f32_16x16x32_bf16 v[60:63], v[184:187], v[240:243], v[60:63]
    v_mfma_f32_16x16x32_bf16 v[88:91], v[184:187], v[244:247], v[88:91]
    buffer_load_dwordx4 v[180:183], v219, s[8:11], s63 offen offset:2048
    v_mfma_f32_16x16x32_bf16 v[116:119], v[184:187], v[248:251], v[116:119]
    v_mfma_f32_16x16x32_bf16 v[144:147], v[184:187], v[252:255], v[144:147]
    ds_read_b128 v[236:239], v1 offset:45056
    v_mfma_f32_16x16x32_bf16 v[64:67], v[188:191], v[240:243], v[64:67]
    v_mfma_f32_16x16x32_bf16 v[92:95], v[188:191], v[244:247], v[92:95]
    buffer_load_dwordx4 v[184:187], v13, s[8:11], s64 offen offset:2048
    v_mfma_f32_16x16x32_bf16 v[120:123], v[188:191], v[248:251], v[120:123]
    v_mfma_f32_16x16x32_bf16 v[148:151], v[188:191], v[252:255], v[148:151]
    s_add_u32 m0, s57, 8192
    s_nop 0
    buffer_load_dwordx4 v13, s[8:11], s68 offen offset:1024 lds
    v_mfma_f32_16x16x32_bf16 v[68:71], v[192:195], v[240:243], v[68:71]
    v_mfma_f32_16x16x32_bf16 v[96:99], v[192:195], v[244:247], v[96:99]
    buffer_load_dwordx4 v[188:191], v13, s[8:11], s64 offen offset:3072
    v_mfma_f32_16x16x32_bf16 v[124:127], v[192:195], v[248:251], v[124:127]
    v_mfma_f32_16x16x32_bf16 v[152:155], v[192:195], v[252:255], v[152:155]
    v_mfma_f32_16x16x32_bf16 v[72:75], v[196:199], v[240:243], v[72:75]
    v_mfma_f32_16x16x32_bf16 v[100:103], v[196:199], v[244:247], v[100:103]
    buffer_load_dwordx4 v[192:195], v219, s[8:11], s64 offen offset:0
    v_mfma_f32_16x16x32_bf16 v[128:131], v[196:199], v[248:251], v[128:131]
    v_mfma_f32_16x16x32_bf16 v[156:159], v[196:199], v[252:255], v[156:159]
    s_waitcnt lgkmcnt(0)
    v_mfma_f32_16x16x32_bf16 v[48:51], a[8:11], v[224:227], v[48:51]
    v_mfma_f32_16x16x32_bf16 v[76:79], a[8:11], v[228:231], v[76:79]
    buffer_load_dwordx4 v[196:199], v219, s[8:11], s64 offen offset:1024
    v_mfma_f32_16x16x32_bf16 v[104:107], a[8:11], v[232:235], v[104:107]
    s_waitcnt vmcnt(18)
    s_barrier
    v_mfma_f32_16x16x32_bf16 v[132:135], a[8:11], v[236:239], v[132:135]
    ds_read_b128 v[240:243], v1 offset:3072
    v_mfma_f32_16x16x32_bf16 v[52:55], v[220:223], v[224:227], v[52:55]
    v_mfma_f32_16x16x32_bf16 v[80:83], v[220:223], v[228:231], v[80:83]
    buffer_load_dwordx4 a[36:39], v13, s[8:11], s69 offen offset:0
    v_mfma_f32_16x16x32_bf16 v[108:111], v[220:223], v[232:235], v[108:111]
    v_mfma_f32_16x16x32_bf16 v[136:139], v[220:223], v[236:239], v[136:139]
    ds_read_b128 v[244:247], v1 offset:17408
    v_mfma_f32_16x16x32_bf16 v[56:59], v[200:203], v[224:227], v[56:59]
    v_mfma_f32_16x16x32_bf16 v[84:87], v[200:203], v[228:231], v[84:87]
    ds_read_b128 v[220:223], v0 offset:3072
    v_mfma_f32_16x16x32_bf16 v[112:115], v[200:203], v[232:235], v[112:115]
    v_mfma_f32_16x16x32_bf16 v[140:143], v[200:203], v[236:239], v[140:143]
    ds_read_b128 v[248:251], v1 offset:31744
    v_mfma_f32_16x16x32_bf16 v[60:63], v[204:207], v[224:227], v[60:63]
    v_mfma_f32_16x16x32_bf16 v[88:91], v[204:207], v[228:231], v[88:91]
    buffer_load_dwordx4 v[200:203], v219, s[8:11], s64 offen offset:2048
    v_mfma_f32_16x16x32_bf16 v[116:119], v[204:207], v[232:235], v[116:119]
    v_mfma_f32_16x16x32_bf16 v[144:147], v[204:207], v[236:239], v[144:147]
    ds_read_b128 v[252:255], v1 offset:46080
    v_mfma_f32_16x16x32_bf16 v[64:67], v[208:211], v[224:227], v[64:67]
    v_mfma_f32_16x16x32_bf16 v[92:95], v[208:211], v[228:231], v[92:95]
    buffer_load_dwordx4 v[204:207], v13, s[8:11], s65 offen offset:2048
    v_mfma_f32_16x16x32_bf16 v[120:123], v[208:211], v[232:235], v[120:123]
    v_mfma_f32_16x16x32_bf16 v[148:151], v[208:211], v[236:239], v[148:151]
    s_add_u32 m0, s57, 9216
    s_nop 0
    buffer_load_dwordx4 v13, s[8:11], s69 offen offset:1024 lds
    v_mfma_f32_16x16x32_bf16 v[68:71], v[212:215], v[224:227], v[68:71]
    v_mfma_f32_16x16x32_bf16 v[96:99], v[212:215], v[228:231], v[96:99]
    buffer_load_dwordx4 v[208:211], v13, s[8:11], s65 offen offset:3072
    v_mfma_f32_16x16x32_bf16 v[124:127], v[212:215], v[232:235], v[124:127]
    v_mfma_f32_16x16x32_bf16 v[152:155], v[212:215], v[236:239], v[152:155]
    s_waitcnt vmcnt(17)
    v_mfma_f32_16x16x32_bf16 v[72:75], v[160:163], v[224:227], v[72:75]
    v_mfma_f32_16x16x32_bf16 v[100:103], v[160:163], v[228:231], v[100:103]
    buffer_load_dwordx4 v[212:215], v219, s[8:11], s65 offen offset:0
    v_mfma_f32_16x16x32_bf16 v[128:131], v[160:163], v[232:235], v[128:131]
    v_mfma_f32_16x16x32_bf16 v[156:159], v[160:163], v[236:239], v[156:159]
    s_waitcnt lgkmcnt(0)
    v_mfma_f32_16x16x32_bf16 v[48:51], a[12:15], v[240:243], v[48:51]
    v_mfma_f32_16x16x32_bf16 v[76:79], a[12:15], v[244:247], v[76:79]
    buffer_load_dwordx4 v[160:163], v219, s[8:11], s65 offen offset:1024
    v_mfma_f32_16x16x32_bf16 v[104:107], a[12:15], v[248:251], v[104:107]
    v_mfma_f32_16x16x32_bf16 v[132:135], a[12:15], v[252:255], v[132:135]
    ds_read_b128 v[224:227], v1 offset:4096
    v_mfma_f32_16x16x32_bf16 v[52:55], v[220:223], v[240:243], v[52:55]
    v_mfma_f32_16x16x32_bf16 v[80:83], v[220:223], v[244:247], v[80:83]
    buffer_load_dwordx4 a[40:43], v13, s[8:11], s70 offen offset:0
    v_mfma_f32_16x16x32_bf16 v[108:111], v[220:223], v[248:251], v[108:111]
    v_mfma_f32_16x16x32_bf16 v[136:139], v[220:223], v[252:255], v[136:139]
    ds_read_b128 v[228:231], v1 offset:18432
    s_waitcnt vmcnt(17)
    v_mfma_f32_16x16x32_bf16 v[56:59], v[164:167], v[240:243], v[56:59]
    v_mfma_f32_16x16x32_bf16 v[84:87], v[164:167], v[244:247], v[84:87]
    ds_read_b128 v[220:223], v0 offset:4096
    v_mfma_f32_16x16x32_bf16 v[112:115], v[164:167], v[248:251], v[112:115]
    v_mfma_f32_16x16x32_bf16 v[140:143], v[164:167], v[252:255], v[140:143]
    ds_read_b128 v[232:235], v1 offset:32768
    v_mfma_f32_16x16x32_bf16 v[60:63], v[168:171], v[240:243], v[60:63]
    v_mfma_f32_16x16x32_bf16 v[88:91], v[168:171], v[244:247], v[88:91]
    buffer_load_dwordx4 v[164:167], v219, s[8:11], s65 offen offset:2048
    v_mfma_f32_16x16x32_bf16 v[116:119], v[168:171], v[248:251], v[116:119]
    buffer_load_dword v47, v216, s[8:11], 0 offen sc1
    v_mfma_f32_16x16x32_bf16 v[144:147], v[168:171], v[252:255], v[144:147]
    ds_read_b128 v[236:239], v1 offset:47104
    s_waitcnt vmcnt(17)
    v_mfma_f32_16x16x32_bf16 v[64:67], v[172:175], v[240:243], v[64:67]
    v_mfma_f32_16x16x32_bf16 v[92:95], v[172:175], v[244:247], v[92:95]
    buffer_load_dwordx4 v[168:171], v13, s[8:11], s66 offen offset:2048
    v_mfma_f32_16x16x32_bf16 v[120:123], v[172:175], v[248:251], v[120:123]
    v_mfma_f32_16x16x32_bf16 v[148:151], v[172:175], v[252:255], v[148:151]
    s_add_u32 m0, s57, 10240
    s_nop 0
    buffer_load_dwordx4 v13, s[8:11], s70 offen offset:1024 lds
    v_mfma_f32_16x16x32_bf16 v[68:71], v[176:179], v[240:243], v[68:71]
    v_mfma_f32_16x16x32_bf16 v[96:99], v[176:179], v[244:247], v[96:99]
    buffer_load_dwordx4 v[172:175], v13, s[8:11], s66 offen offset:3072
    v_mfma_f32_16x16x32_bf16 v[124:127], v[176:179], v[248:251], v[124:127]
    v_mfma_f32_16x16x32_bf16 v[152:155], v[176:179], v[252:255], v[152:155]
    s_waitcnt vmcnt(18)
    v_mfma_f32_16x16x32_bf16 v[72:75], v[180:183], v[240:243], v[72:75]
    v_mfma_f32_16x16x32_bf16 v[100:103], v[180:183], v[244:247], v[100:103]
    buffer_load_dwordx4 v[176:179], v219, s[8:11], s66 offen offset:0
    v_mfma_f32_16x16x32_bf16 v[128:131], v[180:183], v[248:251], v[128:131]
    v_mfma_f32_16x16x32_bf16 v[156:159], v[180:183], v[252:255], v[156:159]
    s_waitcnt lgkmcnt(0)
    v_mfma_f32_16x16x32_bf16 v[48:51], a[16:19], v[224:227], v[48:51]
    v_mfma_f32_16x16x32_bf16 v[76:79], a[16:19], v[228:231], v[76:79]
    buffer_load_dwordx4 v[180:183], v219, s[8:11], s66 offen offset:1024
    v_mfma_f32_16x16x32_bf16 v[104:107], a[16:19], v[232:235], v[104:107]
    v_mfma_f32_16x16x32_bf16 v[132:135], a[16:19], v[236:239], v[132:135]
    ds_read_b128 v[240:243], v1 offset:5120
    v_mfma_f32_16x16x32_bf16 v[52:55], v[220:223], v[224:227], v[52:55]
    v_mfma_f32_16x16x32_bf16 v[80:83], v[220:223], v[228:231], v[80:83]
    buffer_load_dwordx4 a[44:47], v13, s[8:11], s71 offen offset:0
    v_mfma_f32_16x16x32_bf16 v[108:111], v[220:223], v[232:235], v[108:111]
    v_mfma_f32_16x16x32_bf16 v[136:139], v[220:223], v[236:239], v[136:139]
    ds_read_b128 v[244:247], v1 offset:19456
    s_waitcnt vmcnt(18)
    v_mfma_f32_16x16x32_bf16 v[56:59], v[184:187], v[224:227], v[56:59]
    v_mfma_f32_16x16x32_bf16 v[84:87], v[184:187], v[228:231], v[84:87]
    ds_read_b128 v[220:223], v0 offset:5120
    v_mfma_f32_16x16x32_bf16 v[112:115], v[184:187], v[232:235], v[112:115]
    v_mfma_f32_16x16x32_bf16 v[140:143], v[184:187], v[236:239], v[140:143]
    ds_read_b128 v[248:251], v1 offset:33792
    v_mfma_f32_16x16x32_bf16 v[60:63], v[188:191], v[224:227], v[60:63]
    v_mfma_f32_16x16x32_bf16 v[88:91], v[188:191], v[228:231], v[88:91]
    buffer_load_dwordx4 v[184:187], v219, s[8:11], s66 offen offset:2048
    v_mfma_f32_16x16x32_bf16 v[116:119], v[188:191], v[232:235], v[116:119]
    v_mfma_f32_16x16x32_bf16 v[144:147], v[188:191], v[236:239], v[144:147]
    ds_read_b128 v[252:255], v1 offset:48128
    s_waitcnt vmcnt(17)
    v_mfma_f32_16x16x32_bf16 v[64:67], v[192:195], v[224:227], v[64:67]
    v_mfma_f32_16x16x32_bf16 v[92:95], v[192:195], v[228:231], v[92:95]
    buffer_load_dwordx4 v[188:191], v13, s[8:11], s67 offen offset:2048
    v_mfma_f32_16x16x32_bf16 v[120:123], v[192:195], v[232:235], v[120:123]
    v_mfma_f32_16x16x32_bf16 v[148:151], v[192:195], v[236:239], v[148:151]
    s_add_u32 m0, s57, 11264
    s_nop 0
    buffer_load_dwordx4 v13, s[8:11], s71 offen offset:1024 lds
    v_mfma_f32_16x16x32_bf16 v[68:71], v[196:199], v[224:227], v[68:71]
    v_mfma_f32_16x16x32_bf16 v[96:99], v[196:199], v[228:231], v[96:99]
    buffer_load_dwordx4 v[192:195], v13, s[8:11], s67 offen offset:3072
    v_mfma_f32_16x16x32_bf16 v[124:127], v[196:199], v[232:235], v[124:127]
    v_mfma_f32_16x16x32_bf16 v[152:155], v[196:199], v[236:239], v[152:155]
    s_waitcnt vmcnt(18)
    v_mfma_f32_16x16x32_bf16 v[72:75], v[200:203], v[224:227], v[72:75]
    v_mfma_f32_16x16x32_bf16 v[100:103], v[200:203], v[228:231], v[100:103]
    buffer_load_dwordx4 v[196:199], v219, s[8:11], s67 offen offset:0
    v_mfma_f32_16x16x32_bf16 v[128:131], v[200:203], v[232:235], v[128:131]
    v_mfma_f32_16x16x32_bf16 v[156:159], v[200:203], v[236:239], v[156:159]
    s_waitcnt lgkmcnt(0)
    v_mfma_f32_16x16x32_bf16 v[48:51], a[20:23], v[240:243], v[48:51]
    v_mfma_f32_16x16x32_bf16 v[76:79], a[20:23], v[244:247], v[76:79]
    buffer_load_dwordx4 v[200:203], v219, s[8:11], s67 offen offset:1024
    v_mfma_f32_16x16x32_bf16 v[104:107], a[20:23], v[248:251], v[104:107]
    v_mfma_f32_16x16x32_bf16 v[132:135], a[20:23], v[252:255], v[132:135]
    ds_read_b128 v[224:227], v1 offset:6144
    v_mfma_f32_16x16x32_bf16 v[52:55], v[220:223], v[240:243], v[52:55]
    v_mfma_f32_16x16x32_bf16 v[80:83], v[220:223], v[244:247], v[80:83]
    buffer_load_dwordx4 a[48:51], v13, s[8:11], s72 offen offset:0
    v_mfma_f32_16x16x32_bf16 v[108:111], v[220:223], v[248:251], v[108:111]
    v_mfma_f32_16x16x32_bf16 v[136:139], v[220:223], v[252:255], v[136:139]
    ds_read_b128 v[228:231], v1 offset:20480
    s_waitcnt vmcnt(18)
    v_mfma_f32_16x16x32_bf16 v[56:59], v[204:207], v[240:243], v[56:59]
    v_mfma_f32_16x16x32_bf16 v[84:87], v[204:207], v[244:247], v[84:87]
    ds_read_b128 v[220:223], v0 offset:6144
    v_mfma_f32_16x16x32_bf16 v[112:115], v[204:207], v[248:251], v[112:115]
    v_mfma_f32_16x16x32_bf16 v[140:143], v[204:207], v[252:255], v[140:143]
    ds_read_b128 v[232:235], v1 offset:34816
    v_mfma_f32_16x16x32_bf16 v[60:63], v[208:211], v[240:243], v[60:63]
    v_mfma_f32_16x16x32_bf16 v[88:91], v[208:211], v[244:247], v[88:91]
    buffer_load_dwordx4 v[204:207], v219, s[8:11], s67 offen offset:2048
    v_mfma_f32_16x16x32_bf16 v[116:119], v[208:211], v[248:251], v[116:119]
    v_mfma_f32_16x16x32_bf16 v[144:147], v[208:211], v[252:255], v[144:147]
    ds_read_b128 v[236:239], v1 offset:49152
    s_waitcnt vmcnt(17)
    v_mfma_f32_16x16x32_bf16 v[64:67], v[212:215], v[240:243], v[64:67]
    v_mfma_f32_16x16x32_bf16 v[92:95], v[212:215], v[244:247], v[92:95]
    buffer_load_dwordx4 v[208:211], v13, s[8:11], s68 offen offset:2048
    v_mfma_f32_16x16x32_bf16 v[120:123], v[212:215], v[248:251], v[120:123]
    v_mfma_f32_16x16x32_bf16 v[148:151], v[212:215], v[252:255], v[148:151]
    s_add_u32 m0, s57, 12288
    s_nop 0
    buffer_load_dwordx4 v13, s[8:11], s72 offen offset:1024 lds
    v_mfma_f32_16x16x32_bf16 v[68:71], v[160:163], v[240:243], v[68:71]
    v_mfma_f32_16x16x32_bf16 v[96:99], v[160:163], v[244:247], v[96:99]
    buffer_load_dwordx4 v[212:215], v13, s[8:11], s68 offen offset:3072
    v_mfma_f32_16x16x32_bf16 v[124:127], v[160:163], v[248:251], v[124:127]
    v_mfma_f32_16x16x32_bf16 v[152:155], v[160:163], v[252:255], v[152:155]
    s_waitcnt vmcnt(18)
    v_mfma_f32_16x16x32_bf16 v[72:75], v[164:167], v[240:243], v[72:75]
    v_mfma_f32_16x16x32_bf16 v[100:103], v[164:167], v[244:247], v[100:103]
    buffer_load_dwordx4 v[160:163], v219, s[8:11], s68 offen offset:0
    v_mfma_f32_16x16x32_bf16 v[128:131], v[164:167], v[248:251], v[128:131]
    v_mfma_f32_16x16x32_bf16 v[156:159], v[164:167], v[252:255], v[156:159]
    s_waitcnt lgkmcnt(0)
    v_mfma_f32_16x16x32_bf16 v[48:51], a[24:27], v[224:227], v[48:51]
    v_mfma_f32_16x16x32_bf16 v[76:79], a[24:27], v[228:231], v[76:79]
    buffer_load_dwordx4 v[164:167], v219, s[8:11], s68 offen offset:1024
    v_mfma_f32_16x16x32_bf16 v[104:107], a[24:27], v[232:235], v[104:107]
    v_mfma_f32_16x16x32_bf16 v[132:135], a[24:27], v[236:239], v[132:135]
    ds_read_b128 v[240:243], v1 offset:7168
    v_mfma_f32_16x16x32_bf16 v[52:55], v[220:223], v[224:227], v[52:55]
    v_mfma_f32_16x16x32_bf16 v[80:83], v[220:223], v[228:231], v[80:83]
    buffer_load_dwordx4 a[52:55], v13, s[8:11], s73 offen offset:0
    v_mfma_f32_16x16x32_bf16 v[108:111], v[220:223], v[232:235], v[108:111]
    v_mfma_f32_16x16x32_bf16 v[136:139], v[220:223], v[236:239], v[136:139]
    ds_read_b128 v[244:247], v1 offset:21504
    s_waitcnt vmcnt(17)
    v_mfma_f32_16x16x32_bf16 v[56:59], v[168:171], v[224:227], v[56:59]
    v_mfma_f32_16x16x32_bf16 v[84:87], v[168:171], v[228:231], v[84:87]
    ds_read_b128 v[220:223], v0 offset:7168
    v_mfma_f32_16x16x32_bf16 v[112:115], v[168:171], v[232:235], v[112:115]
    v_mfma_f32_16x16x32_bf16 v[140:143], v[168:171], v[236:239], v[140:143]
    ds_read_b128 v[248:251], v1 offset:35840
    v_mfma_f32_16x16x32_bf16 v[60:63], v[172:175], v[224:227], v[60:63]
    v_mfma_f32_16x16x32_bf16 v[88:91], v[172:175], v[228:231], v[88:91]
    buffer_load_dwordx4 v[168:171], v219, s[8:11], s68 offen offset:2048
    v_mfma_f32_16x16x32_bf16 v[116:119], v[172:175], v[232:235], v[116:119]
    v_and_b32 v47, -16, v47
    v_cmp_ne_u32 vcc, s42, v47
    s_cbranch_vccz L_wcG_ok
    s_mov_b32 s34, 0
L_wcG_7:
    buffer_load_dword v42, v216, s[8:11], 0 offen sc1
    s_waitcnt vmcnt(0)
    v_and_b32 v46, -16, v42
    v_cmp_ne_u32 vcc, s42, v46
    s_cbranch_vccz L_wcG_7_x
    s_add_u32 s34, s34, 1
    s_cmp_lt_u32 s34, 1048576
    s_cbranch_scc1 L_wcG_7
L_wcG_7_x:
    s_waitcnt vmcnt(0)
L_wcG_ok:
    v_mfma_f32_16x16x32_bf16 v[144:147], v[172:175], v[236:239], v[144:147]
    ds_read_b128 v[252:255], v1 offset:50176
    s_waitcnt vmcnt(16)
    v_mfma_f32_16x16x32_bf16 v[64:67], v[176:179], v[224:227], v[64:67]
    v_mfma_f32_16x16x32_bf16 v[92:95], v[176:179], v[228:231], v[92:95]
    buffer_load_dwordx4 v[172:175], v13, s[8:11], s69 offen offset:2048
    v_mfma_f32_16x16x32_bf16 v[120:123], v[176:179], v[232:235], v[120:123]
    v_mfma_f32_16x16x32_bf16 v[148:151], v[176:179], v[236:239], v[148:151]
    s_add_u32 m0, s57, 13312
    s_nop 0
    buffer_load_dwordx4 v13, s[8:11], s73 offen offset:1024 lds
    v_mfma_f32_16x16x32_bf16 v[68:71], v[180:183], v[224:227], v[68:71]
    v_mfma_f32_16x16x32_bf16 v[96:99], v[180:183], v[228:231], v[96:99]
    buffer_load_dwordx4 v[176:179], v13, s[8:11], s69 offen offset:3072
    v_mfma_f32_16x16x32_bf16 v[124:127], v[180:183], v[232:235], v[124:127]
    v_mfma_f32_16x16x32_bf16 v[152:155], v[180:183], v[236:239], v[152:155]
    s_waitcnt vmcnt(17)
    v_mfma_f32_16x16x32_bf16 v[72:75], v[184:187], v[224:227], v[72:75]
    v_mfma_f32_16x16x32_bf16 v[100:103], v[184:187], v[228:231], v[100:103]
    buffer_load_dwordx4 v[180:183], v219, s[8:11], s69 offen offset:0
    v_mfma_f32_16x16x32_bf16 v[128:131], v[184:187], v[232:235], v[128:131]
    v_mfma_f32_16x16x32_bf16 v[156:159], v[184:187], v[236:239], v[156:159]
    s_waitcnt lgkmcnt(0)
    v_mfma_f32_16x16x32_bf16 v[48:51], a[28:31], v[240:243], v[48:51]
    v_mfma_f32_16x16x32_bf16 v[76:79], a[28:31], v[244:247], v[76:79]
    buffer_load_dwordx4 v[184:187], v219, s[8:11], s69 offen offset:1024
    v_mfma_f32_16x16x32_bf16 v[104:107], a[28:31], v[248:251], v[104:107]
    v_mfma_f32_16x16x32_bf16 v[132:135], a[28:31], v[252:255], v[132:135]
    ds_read_b128 v[224:227], v1 offset:8192
    v_mfma_f32_16x16x32_bf16 v[52:55], v[220:223], v[240:243], v[52:55]
    v_mfma_f32_16x16x32_bf16 v[80:83], v[220:223], v[244:247], v[80:83]
    s_mov_b32 s31, 7700480
    buffer_load_dwordx4 a[56:59], v13, s[8:11], s31 offen offset:2048
    v_mfma_f32_16x16x32_bf16 v[108:111], v[220:223], v[248:251], v[108:111]
    v_mfma_f32_16x16x32_bf16 v[136:139], v[220:223], v[252:255], v[136:139]
    ds_read_b128 v[228:231], v1 offset:22528
    s_waitcnt vmcnt(17)
    v_mfma_f32_16x16x32_bf16 v[56:59], v[188:191], v[240:243], v[56:59]
    v_mfma_f32_16x16x32_bf16 v[84:87], v[188:191], v[244:247], v[84:87]
    ds_read_b128 v[220:223], v0 offset:8192
    v_mfma_f32_16x16x32_bf16 v[112:115], v[188:191], v[248:251], v[112:115]
    v_mfma_f32_16x16x32_bf16 v[140:143], v[188:191], v[252:255], v[140:143]
    ds_read_b128 v[232:235], v1 offset:36864
    v_mfma_f32_16x16x32_bf16 v[60:63], v[192:195], v[240:243], v[60:63]
    v_mfma_f32_16x16x32_bf16 v[88:91], v[192:195], v[244:247], v[88:91]
    buffer_load_dwordx4 v[188:191], v219, s[8:11], s69 offen offset:2048
    v_mfma_f32_16x16x32_bf16 v[116:119], v[192:195], v[248:251], v[116:119]
    v_mfma_f32_16x16x32_bf16 v[144:147], v[192:195], v[252:255], v[144:147]
    ds_read_b128 v[236:239], v1 offset:51200
    s_waitcnt vmcnt(16)
    v_mfma_f32_16x16x32_bf16 v[64:67], v[196:199], v[240:243], v[64:67]
    v_mfma_f32_16x16x32_bf16 v[92:95], v[196:199], v[244:247], v[92:95]
    buffer_load_dwordx4 v[192:195], v13, s[8:11], s70 offen offset:2048
    v_mfma_f32_16x16x32_bf16 v[120:123], v[196:199], v[248:251], v[120:123]
    v_mfma_f32_16x16x32_bf16 v[148:151], v[196:199], v[252:255], v[148:151]
    buffer_load_dwordx4 a[60:63], v13, s[8:11], s31 offen offset:3072
    v_mfma_f32_16x16x32_bf16 v[68:71], v[200:203], v[240:243], v[68:71]
    v_mfma_f32_16x16x32_bf16 v[96:99], v[200:203], v[244:247], v[96:99]
    buffer_load_dwordx4 v[196:199], v13, s[8:11], s70 offen offset:3072
    v_mfma_f32_16x16x32_bf16 v[124:127], v[200:203], v[248:251], v[124:127]
    v_mfma_f32_16x16x32_bf16 v[152:155], v[200:203], v[252:255], v[152:155]
    s_waitcnt vmcnt(17)
    v_mfma_f32_16x16x32_bf16 v[72:75], v[204:207], v[240:243], v[72:75]
    v_mfma_f32_16x16x32_bf16 v[100:103], v[204:207], v[244:247], v[100:103]
    buffer_load_dwordx4 v[200:203], v219, s[8:11], s70 offen offset:0
    v_mfma_f32_16x16x32_bf16 v[128:131], v[204:207], v[248:251], v[128:131]
    v_mfma_f32_16x16x32_bf16 v[156:159], v[204:207], v[252:255], v[156:159]
    s_waitcnt lgkmcnt(0)
    v_mfma_f32_16x16x32_bf16 v[48:51], a[32:35], v[224:227], v[48:51]
    v_mfma_f32_16x16x32_bf16 v[76:79], a[32:35], v[228:231], v[76:79]
    buffer_load_dwordx4 v[204:207], v219, s[8:11], s70 offen offset:1024
    v_mfma_f32_16x16x32_bf16 v[104:107], a[32:35], v[232:235], v[104:107]
    v_mfma_f32_16x16x32_bf16 v[132:135], a[32:35], v[236:239], v[132:135]
    ds_read_b128 v[240:243], v1 offset:9216
    v_mfma_f32_16x16x32_bf16 v[52:55], v[220:223], v[224:227], v[52:55]
    v_mfma_f32_16x16x32_bf16 v[80:83], v[220:223], v[228:231], v[80:83]
    s_mov_b32 s31, 7704576
    buffer_load_dwordx4 a[64:67], v13, s[8:11], s31 offen offset:0
    v_mfma_f32_16x16x32_bf16 v[108:111], v[220:223], v[232:235], v[108:111]
    v_mfma_f32_16x16x32_bf16 v[136:139], v[220:223], v[236:239], v[136:139]
    ds_read_b128 v[244:247], v1 offset:23552
    s_waitcnt vmcnt(17)
    v_mfma_f32_16x16x32_bf16 v[56:59], v[208:211], v[224:227], v[56:59]
    v_mfma_f32_16x16x32_bf16 v[84:87], v[208:211], v[228:231], v[84:87]
    ds_read_b128 v[220:223], v0 offset:9216
    v_mfma_f32_16x16x32_bf16 v[112:115], v[208:211], v[232:235], v[112:115]
    v_mfma_f32_16x16x32_bf16 v[140:143], v[208:211], v[236:239], v[140:143]
    ds_read_b128 v[248:251], v1 offset:37888
    v_mfma_f32_16x16x32_bf16 v[60:63], v[212:215], v[224:227], v[60:63]
    v_mfma_f32_16x16x32_bf16 v[88:91], v[212:215], v[228:231], v[88:91]
    buffer_load_dwordx4 v[208:211], v219, s[8:11], s70 offen offset:2048
    v_mfma_f32_16x16x32_bf16 v[116:119], v[212:215], v[232:235], v[116:119]
    v_mfma_f32_16x16x32_bf16 v[144:147], v[212:215], v[236:239], v[144:147]
    ds_read_b128 v[252:255], v1 offset:52224
    s_waitcnt vmcnt(16)
    v_mfma_f32_16x16x32_bf16 v[64:67], v[160:163], v[224:227], v[64:67]
    v_mfma_f32_16x16x32_bf16 v[92:95], v[160:163], v[228:231], v[92:95]
    buffer_load_dwordx4 v[212:215], v13, s[8:11], s71 offen offset:2048
    v_mfma_f32_16x16x32_bf16 v[120:123], v[160:163], v[232:235], v[120:123]
    v_mfma_f32_16x16x32_bf16 v[148:151], v[160:163], v[236:239], v[148:151]
    buffer_load_dwordx4 a[68:71], v13, s[8:11], s31 offen offset:1024
    v_mfma_f32_16x16x32_bf16 v[68:71], v[164:167], v[224:227], v[68:71]
    v_mfma_f32_16x16x32_bf16 v[96:99], v[164:167], v[228:231], v[96:99]
    buffer_load_dwordx4 v[160:163], v13, s[8:11], s71 offen offset:3072
    v_mfma_f32_16x16x32_bf16 v[124:127], v[164:167], v[232:235], v[124:127]
    v_mfma_f32_16x16x32_bf16 v[152:155], v[164:167], v[236:239], v[152:155]
    s_waitcnt vmcnt(17)
    v_mfma_f32_16x16x32_bf16 v[72:75], v[168:171], v[224:227], v[72:75]
    v_mfma_f32_16x16x32_bf16 v[100:103], v[168:171], v[228:231], v[100:103]
    buffer_load_dwordx4 v[164:167], v219, s[8:11], s71 offen offset:0
    v_mfma_f32_16x16x32_bf16 v[128:131], v[168:171], v[232:235], v[128:131]
    v_mfma_f32_16x16x32_bf16 v[156:159], v[168:171], v[236:239], v[156:159]
    s_waitcnt lgkmcnt(0)
    v_mfma_f32_16x16x32_bf16 v[48:51], a[36:39], v[240:243], v[48:51]
    v_mfma_f32_16x16x32_bf16 v[76:79], a[36:39], v[244:247], v[76:79]
    buffer_load_dwordx4 v[168:171], v219, s[8:11], s71 offen offset:1024
    v_mfma_f32_16x16x32_bf16 v[104:107], a[36:39], v[248:251], v[104:107]
    v_mfma_f32_16x16x32_bf16 v[132:135], a[36:39], v[252:255], v[132:135]
    ds_read_b128 v[224:227], v1 offset:10240
    v_mfma_f32_16x16x32_bf16 v[52:55], v[220:223], v[240:243], v[52:55]
    v_mfma_f32_16x16x32_bf16 v[80:83], v[220:223], v[244:247], v[80:83]
    buffer_load_dwordx4 a[72:75], v13, s[8:11], s31 offen offset:2048
    v_mfma_f32_16x16x32_bf16 v[108:111], v[220:223], v[248:251], v[108:111]
    v_mfma_f32_16x16x32_bf16 v[136:139], v[220:223], v[252:255], v[136:139]
    ds_read_b128 v[228:231], v1 offset:24576
    s_waitcnt vmcnt(17)
    v_mfma_f32_16x16x32_bf16 v[56:59], v[172:175], v[240:243], v[56:59]
    v_mfma_f32_16x16x32_bf16 v[84:87], v[172:175], v[244:247], v[84:87]
    ds_read_b128 v[220:223], v0 offset:10240
    v_mfma_f32_16x16x32_bf16 v[112:115], v[172:175], v[248:251], v[112:115]
    v_mfma_f32_16x16x32_bf16 v[140:143], v[172:175], v[252:255], v[140:143]
    ds_read_b128 v[232:235], v1 offset:38912
    v_mfma_f32_16x16x32_bf16 v[60:63], v[176:179], v[240:243], v[60:63]
    v_mfma_f32_16x16x32_bf16 v[88:91], v[176:179], v[244:247], v[88:91]
    buffer_load_dwordx4 v[172:175], v219, s[8:11], s71 offen offset:2048
    v_mfma_f32_16x16x32_bf16 v[116:119], v[176:179], v[248:251], v[116:119]
    v_mfma_f32_16x16x32_bf16 v[144:147], v[176:179], v[252:255], v[144:147]
    ds_read_b128 v[236:239], v1 offset:53248
    s_waitcnt vmcnt(16)
    v_mfma_f32_16x16x32_bf16 v[64:67], v[180:183], v[240:243], v[64:67]
    v_mfma_f32_16x16x32_bf16 v[92:95], v[180:183], v[244:247], v[92:95]
    buffer_load_dwordx4 v[176:179], v13, s[8:11], s72 offen offset:2048
    v_mfma_f32_16x16x32_bf16 v[120:123], v[180:183], v[248:251], v[120:123]
    v_mfma_f32_16x16x32_bf16 v[148:151], v[180:183], v[252:255], v[148:151]
    buffer_load_dwordx4 a[76:79], v13, s[8:11], s31 offen offset:3072
    v_mfma_f32_16x16x32_bf16 v[68:71], v[184:187], v[240:243], v[68:71]
    v_mfma_f32_16x16x32_bf16 v[96:99], v[184:187], v[244:247], v[96:99]
    buffer_load_dwordx4 v[180:183], v13, s[8:11], s72 offen offset:3072
    v_mfma_f32_16x16x32_bf16 v[124:127], v[184:187], v[248:251], v[124:127]
    v_mfma_f32_16x16x32_bf16 v[152:155], v[184:187], v[252:255], v[152:155]
    s_mov_b32 s31, 7708672
    buffer_load_dwordx4 a[80:83], v13, s[8:11], s31 offen offset:0
    s_waitcnt vmcnt(18)
    v_mfma_f32_16x16x32_bf16 v[72:75], v[188:191], v[240:243], v[72:75]
    v_mfma_f32_16x16x32_bf16 v[100:103], v[188:191], v[244:247], v[100:103]
    buffer_load_dwordx4 v[184:187], v219, s[8:11], s72 offen offset:0
    v_mfma_f32_16x16x32_bf16 v[128:131], v[188:191], v[248:251], v[128:131]
    v_mfma_f32_16x16x32_bf16 v[156:159], v[188:191], v[252:255], v[156:159]
    s_waitcnt lgkmcnt(0)
    v_mfma_f32_16x16x32_bf16 v[48:51], a[40:43], v[224:227], v[48:51]
    v_mfma_f32_16x16x32_bf16 v[76:79], a[40:43], v[228:231], v[76:79]
    buffer_load_dwordx4 v[188:191], v219, s[8:11], s72 offen offset:1024
    v_mfma_f32_16x16x32_bf16 v[104:107], a[40:43], v[232:235], v[104:107]
    v_mfma_f32_16x16x32_bf16 v[132:135], a[40:43], v[236:239], v[132:135]
    ds_read_b128 v[240:243], v1 offset:11264
    v_mfma_f32_16x16x32_bf16 v[52:55], v[220:223], v[224:227], v[52:55]
    v_mfma_f32_16x16x32_bf16 v[80:83], v[220:223], v[228:231], v[80:83]
    buffer_load_dwordx4 a[84:87], v13, s[8:11], s31 offen offset:1024
    v_mfma_f32_16x16x32_bf16 v[108:111], v[220:223], v[232:235], v[108:111]
    v_mfma_f32_16x16x32_bf16 v[136:139], v[220:223], v[236:239], v[136:139]
    ds_read_b128 v[244:247], v1 offset:25600
    s_waitcnt vmcnt(18)
    v_mfma_f32_16x16x32_bf16 v[56:59], v[192:195], v[224:227], v[56:59]
    v_mfma_f32_16x16x32_bf16 v[84:87], v[192:195], v[228:231], v[84:87]
    ds_read_b128 v[220:223], v0 offset:11264
    v_mfma_f32_16x16x32_bf16 v[112:115], v[192:195], v[232:235], v[112:115]
    v_mfma_f32_16x16x32_bf16 v[140:143], v[192:195], v[236:239], v[140:143]
    ds_read_b128 v[248:251], v1 offset:39936
    v_mfma_f32_16x16x32_bf16 v[60:63], v[196:199], v[224:227], v[60:63]
    v_mfma_f32_16x16x32_bf16 v[88:91], v[196:199], v[228:231], v[88:91]
    buffer_load_dwordx4 v[192:195], v219, s[8:11], s72 offen offset:2048
    v_mfma_f32_16x16x32_bf16 v[116:119], v[196:199], v[232:235], v[116:119]
    v_mfma_f32_16x16x32_bf16 v[144:147], v[196:199], v[236:239], v[144:147]
    ds_read_b128 v[252:255], v1 offset:54272
    s_waitcnt vmcnt(17)
    v_mfma_f32_16x16x32_bf16 v[64:67], v[200:203], v[224:227], v[64:67]
    v_mfma_f32_16x16x32_bf16 v[92:95], v[200:203], v[228:231], v[92:95]
    buffer_load_dwordx4 v[196:199], v13, s[8:11], s73 offen offset:2048
    v_mfma_f32_16x16x32_bf16 v[120:123], v[200:203], v[232:235], v[120:123]
    v_mfma_f32_16x16x32_bf16 v[148:151], v[200:203], v[236:239], v[148:151]
    buffer_load_dwordx4 a[88:91], v13, s[8:11], s31 offen offset:2048
    v_mfma_f32_16x16x32_bf16 v[68:71], v[204:207], v[224:227], v[68:71]
    v_mfma_f32_16x16x32_bf16 v[96:99], v[204:207], v[228:231], v[96:99]
    buffer_load_dwordx4 v[200:203], v13, s[8:11], s73 offen offset:3072
    v_mfma_f32_16x16x32_bf16 v[124:127], v[204:207], v[232:235], v[124:127]
    v_mfma_f32_16x16x32_bf16 v[152:155], v[204:207], v[236:239], v[152:155]
    buffer_load_dwordx4 a[92:95], v13, s[8:11], s31 offen offset:3072
    s_waitcnt vmcnt(19)
    v_mfma_f32_16x16x32_bf16 v[72:75], v[208:211], v[224:227], v[72:75]
    v_mfma_f32_16x16x32_bf16 v[100:103], v[208:211], v[228:231], v[100:103]
    buffer_load_dwordx4 v[204:207], v219, s[8:11], s73 offen offset:0
    v_mfma_f32_16x16x32_bf16 v[128:131], v[208:211], v[232:235], v[128:131]
    v_mfma_f32_16x16x32_bf16 v[156:159], v[208:211], v[236:239], v[156:159]
    s_waitcnt lgkmcnt(0)
    v_mfma_f32_16x16x32_bf16 v[48:51], a[44:47], v[240:243], v[48:51]
    v_mfma_f32_16x16x32_bf16 v[76:79], a[44:47], v[244:247], v[76:79]
    buffer_load_dwordx4 v[208:211], v219, s[8:11], s73 offen offset:1024
    v_mfma_f32_16x16x32_bf16 v[104:107], a[44:47], v[248:251], v[104:107]
    v_mfma_f32_16x16x32_bf16 v[132:135], a[44:47], v[252:255], v[132:135]
    ds_read_b128 v[224:227], v1 offset:12288
    v_mfma_f32_16x16x32_bf16 v[52:55], v[220:223], v[240:243], v[52:55]
    v_mfma_f32_16x16x32_bf16 v[80:83], v[220:223], v[244:247], v[80:83]
    s_mov_b32 s31, 7712768
    buffer_load_dwordx4 a[96:99], v13, s[8:11], s31 offen offset:0
    v_mfma_f32_16x16x32_bf16 v[108:111], v[220:223], v[248:251], v[108:111]
    v_mfma_f32_16x16x32_bf16 v[136:139], v[220:223], v[252:255], v[136:139]
    ds_read_b128 v[228:231], v1 offset:26624
    s_waitcnt vmcnt(19)
    v_mfma_f32_16x16x32_bf16 v[56:59], v[212:215], v[240:243], v[56:59]
    v_mfma_f32_16x16x32_bf16 v[84:87], v[212:215], v[244:247], v[84:87]
    ds_read_b128 v[220:223], v0 offset:12288
    v_mfma_f32_16x16x32_bf16 v[112:115], v[212:215], v[248:251], v[112:115]
    v_mfma_f32_16x16x32_bf16 v[140:143], v[212:215], v[252:255], v[140:143]
    ds_read_b128 v[232:235], v1 offset:40960
    v_mfma_f32_16x16x32_bf16 v[60:63], v[160:163], v[240:243], v[60:63]
    v_mfma_f32_16x16x32_bf16 v[88:91], v[160:163], v[244:247], v[88:91]
    buffer_load_dwordx4 v[212:215], v219, s[8:11], s73 offen offset:2048
    v_mfma_f32_16x16x32_bf16 v[116:119], v[160:163], v[248:251], v[116:119]
    v_mfma_f32_16x16x32_bf16 v[144:147], v[160:163], v[252:255], v[144:147]
    ds_read_b128 v[236:239], v1 offset:55296
    s_waitcnt vmcnt(18)
    v_mfma_f32_16x16x32_bf16 v[64:67], v[164:167], v[240:243], v[64:67]
    v_mfma_f32_16x16x32_bf16 v[92:95], v[164:167], v[244:247], v[92:95]
    v_mfma_f32_16x16x32_bf16 v[120:123], v[164:167], v[248:251], v[120:123]
    v_mfma_f32_16x16x32_bf16 v[148:151], v[164:167], v[252:255], v[148:151]
    buffer_load_dwordx4 a[100:103], v13, s[8:11], s31 offen offset:1024
    v_mfma_f32_16x16x32_bf16 v[68:71], v[168:171], v[240:243], v[68:71]
    v_mfma_f32_16x16x32_bf16 v[96:99], v[168:171], v[244:247], v[96:99]
    v_mfma_f32_16x16x32_bf16 v[124:127], v[168:171], v[248:251], v[124:127]
    v_mfma_f32_16x16x32_bf16 v[152:155], v[168:171], v[252:255], v[152:155]
    buffer_load_dwordx4 a[104:107], v13, s[8:11], s31 offen offset:2048
    s_waitcnt vmcnt(18)
    v_mfma_f32_16x16x32_bf16 v[72:75], v[172:175], v[240:243], v[72:75]
    v_mfma_f32_16x16x32_bf16 v[100:103], v[172:175], v[244:247], v[100:103]
    v_mfma_f32_16x16x32_bf16 v[128:131], v[172:175], v[248:251], v[128:131]
    v_mfma_f32_16x16x32_bf16 v[156:159], v[172:175], v[252:255], v[156:159]
    s_waitcnt lgkmcnt(0)
    v_mfma_f32_16x16x32_bf16 v[48:51], a[48:51], v[224:227], v[48:51]
    v_mfma_f32_16x16x32_bf16 v[76:79], a[48:51], v[228:231], v[76:79]
    v_mfma_f32_16x16x32_bf16 v[104:107], a[48:51], v[232:235], v[104:107]
    v_mfma_f32_16x16x32_bf16 v[132:135], a[48:51], v[236:239], v[132:135]
    ds_read_b128 v[240:243], v1 offset:13312
    v_mfma_f32_16x16x32_bf16 v[52:55], v[220:223], v[224:227], v[52:55]
    v_mfma_f32_16x16x32_bf16 v[80:83], v[220:223], v[228:231], v[80:83]
    buffer_load_dwordx4 a[108:111], v13, s[8:11], s31 offen offset:3072
    v_mfma_f32_16x16x32_bf16 v[108:111], v[220:223], v[232:235], v[108:111]
    v_mfma_f32_16x16x32_bf16 v[136:139], v[220:223], v[236:239], v[136:139]
    ds_read_b128 v[244:247], v1 offset:27648
    s_waitcnt vmcnt(16)
    v_mfma_f32_16x16x32_bf16 v[56:59], v[176:179], v[224:227], v[56:59]
    v_mfma_f32_16x16x32_bf16 v[84:87], v[176:179], v[228:231], v[84:87]
    ds_read_b128 v[220:223], v0 offset:13312
    v_mfma_f32_16x16x32_bf16 v[112:115], v[176:179], v[232:235], v[112:115]
    v_mfma_f32_16x16x32_bf16 v[140:143], v[176:179], v[236:239], v[140:143]
    ds_read_b128 v[248:251], v1 offset:41984
    v_mfma_f32_16x16x32_bf16 v[60:63], v[180:183], v[224:227], v[60:63]
    v_mfma_f32_16x16x32_bf16 v[88:91], v[180:183], v[228:231], v[88:91]
    v_mfma_f32_16x16x32_bf16 v[116:119], v[180:183], v[232:235], v[116:119]
    v_mfma_f32_16x16x32_bf16 v[144:147], v[180:183], v[236:239], v[144:147]
    ds_read_b128 v[252:255], v1 offset:56320
    s_waitcnt vmcnt(13)
    v_mfma_f32_16x16x32_bf16 v[64:67], v[184:187], v[224:227], v[64:67]
    v_mfma_f32_16x16x32_bf16 v[92:95], v[184:187], v[228:231], v[92:95]
    v_mfma_f32_16x16x32_bf16 v[120:123], v[184:187], v[232:235], v[120:123]
    v_mfma_f32_16x16x32_bf16 v[148:151], v[184:187], v[236:239], v[148:151]
    s_mov_b32 s31, 7716864
    buffer_load_dwordx4 a[112:115], v13, s[8:11], s31 offen offset:0
    v_mfma_f32_16x16x32_bf16 v[68:71], v[188:191], v[224:227], v[68:71]
    v_mfma_f32_16x16x32_bf16 v[96:99], v[188:191], v[228:231], v[96:99]
    v_mfma_f32_16x16x32_bf16 v[124:127], v[188:191], v[232:235], v[124:127]
    v_mfma_f32_16x16x32_bf16 v[152:155], v[188:191], v[236:239], v[152:155]
    buffer_load_dwordx4 a[116:119], v13, s[8:11], s31 offen offset:1024
    s_waitcnt vmcnt(13)
    v_mfma_f32_16x16x32_bf16 v[72:75], v[192:195], v[224:227], v[72:75]
    v_mfma_f32_16x16x32_bf16 v[100:103], v[192:195], v[228:231], v[100:103]
    v_mfma_f32_16x16x32_bf16 v[128:131], v[192:195], v[232:235], v[128:131]
    v_mfma_f32_16x16x32_bf16 v[156:159], v[192:195], v[236:239], v[156:159]
    s_waitcnt lgkmcnt(4)
    v_mfma_f32_16x16x32_bf16 v[48:51], a[52:55], v[240:243], v[48:51]
    s_waitcnt lgkmcnt(2)
    v_mfma_f32_16x16x32_bf16 v[52:55], v[220:223], v[240:243], v[52:55]
    s_waitcnt vmcnt(12)
    v_mfma_f32_16x16x32_bf16 v[56:59], v[196:199], v[240:243], v[56:59]
    buffer_load_dwordx4 a[120:123], v13, s[8:11], s31 offen offset:2048
    s_waitcnt vmcnt(11)
    v_mfma_f32_16x16x32_bf16 v[60:63], v[200:203], v[240:243], v[60:63]
    s_waitcnt vmcnt(9)
    v_mfma_f32_16x16x32_bf16 v[64:67], v[204:207], v[240:243], v[64:67]
    s_waitcnt vmcnt(8)
    v_mfma_f32_16x16x32_bf16 v[68:71], v[208:211], v[240:243], v[68:71]
    buffer_load_dwordx4 a[124:127], v13, s[8:11], s31 offen offset:3072
    s_waitcnt vmcnt(7)
    v_mfma_f32_16x16x32_bf16 v[72:75], v[212:215], v[240:243], v[72:75]
    v_mfma_f32_16x16x32_bf16 v[76:79], a[52:55], v[244:247], v[76:79]
    v_mfma_f32_16x16x32_bf16 v[80:83], v[220:223], v[244:247], v[80:83]
    v_mul_f32 v48, v48, v52
    v_mul_f32 v49, v49, v53
    v_mfma_f32_16x16x32_bf16 v[84:87], v[196:199], v[244:247], v[84:87]
    s_mov_b32 s31, 7720960
    buffer_load_dwordx4 a[128:131], v13, s[8:11], s31 offen offset:0
    v_mul_f32 v50, v50, v54
    v_mul_f32 v51, v51, v55
    v_cvt_pk_bf16_f32 v240, v48, v49
    v_mfma_f32_16x16x32_bf16 v[88:91], v[200:203], v[244:247], v[88:91]
    v_cvt_pk_bf16_f32 v241, v50, v51
    v_mul_f32 v56, v56, v60
    v_mul_f32 v57, v57, v61
    v_mfma_f32_16x16x32_bf16 v[92:95], v[204:207], v[244:247], v[92:95]
    v_mul_f32 v58, v58, v62
    v_mul_f32 v59, v59, v63
    v_mfma_f32_16x16x32_bf16 v[96:99], v[208:211], v[244:247], v[96:99]
    buffer_load_dwordx4 a[132:135], v13, s[8:11], s31 offen offset:1024
    v_cvt_pk_bf16_f32 v242, v56, v57
    v_cvt_pk_bf16_f32 v243, v58, v59
    ds_write_b128 v6, v[240:243] offset:0
    v_mfma_f32_16x16x32_bf16 v[100:103], v[212:215], v[244:247], v[100:103]
    v_mul_f32 v64, v64, v68
    v_mul_f32 v65, v65, v69
    v_mul_f32 v66, v66, v70
    s_waitcnt lgkmcnt(2)
    v_mfma_f32_16x16x32_bf16 v[104:107], a[52:55], v[248:251], v[104:107]
    v_mul_f32 v67, v67, v71
    v_cvt_pk_bf16_f32 v64, v64, v65
    v_mfma_f32_16x16x32_bf16 v[108:111], v[220:223], v[248:251], v[108:111]
    v_cvt_pk_bf16_f32 v65, v66, v67
    v_permlane32_swap_b32 v72, v74
    v_permlane32_swap_b32 v73, v75
    v_mfma_f32_16x16x32_bf16 v[112:115], v[196:199], v[248:251], v[112:115]
    buffer_load_dwordx4 a[136:139], v13, s[8:11], s31 offen offset:2048
    v_mul_f32 v72, v72, v74
    v_mul_f32 v73, v73, v75
    v_cvt_pk_bf16_f32 v66, v72, v73
    v_mfma_f32_16x16x32_bf16 v[116:119], v[200:203], v[248:251], v[116:119]
    ds_write_b64 v7, v[64:65] offset:0
    ds_write_b32 v8, v66 offset:0
    v_mul_f32 v76, v76, v80
    v_mfma_f32_16x16x32_bf16 v[120:123], v[204:207], v[248:251], v[120:123]
    v_mul_f32 v77, v77, v81
    v_mul_f32 v78, v78, v82
    v_mfma_f32_16x16x32_bf16 v[124:127], v[208:211], v[248:251], v[124:127]
    buffer_load_dwordx4 a[140:143], v13, s[8:11], s31 offen offset:3072
    v_mul_f32 v79, v79, v83
    v_cvt_pk_bf16_f32 v244, v76, v77
    v_cvt_pk_bf16_f32 v245, v78, v79
    v_mfma_f32_16x16x32_bf16 v[128:131], v[212:215], v[248:251], v[128:131]
    v_mul_f32 v84, v84, v88
    v_mul_f32 v85, v85, v89
    v_mul_f32 v86, v86, v90
    s_waitcnt lgkmcnt(3)
    v_mfma_f32_16x16x32_bf16 v[132:135], a[52:55], v[252:255], v[132:135]
    v_mul_f32 v87, v87, v91
    v_cvt_pk_bf16_f32 v246, v84, v85
    v_mfma_f32_16x16x32_bf16 v[136:139], v[220:223], v[252:255], v[136:139]
    v_cvt_pk_bf16_f32 v247, v86, v87
    ds_write_b128 v6, v[244:247] offset:7168
    v_mul_f32 v92, v92, v96
    v_mfma_f32_16x16x32_bf16 v[140:143], v[196:199], v[252:255], v[140:143]
    s_mov_b32 s31, 7725056
    buffer_load_dwordx4 a[144:147], v13, s[8:11], s31 offen offset:0
    v_mul_f32 v93, v93, v97
    v_mul_f32 v94, v94, v98
    v_mul_f32 v95, v95, v99
    v_mfma_f32_16x16x32_bf16 v[144:147], v[200:203], v[252:255], v[144:147]
    v_cvt_pk_bf16_f32 v92, v92, v93
    v_cvt_pk_bf16_f32 v93, v94, v95
    v_mfma_f32_16x16x32_bf16 v[148:151], v[204:207], v[252:255], v[148:151]
    v_permlane32_swap_b32 v100, v102
    v_permlane32_swap_b32 v101, v103
    v_mul_f32 v100, v100, v102
    v_mfma_f32_16x16x32_bf16 v[152:155], v[208:211], v[252:255], v[152:155]
    buffer_load_dwordx4 a[148:151], v13, s[8:11], s31 offen offset:1024
    v_mul_f32 v101, v101, v103
    v_cvt_pk_bf16_f32 v94, v100, v101
    ds_write_b64 v7, v[92:93] offset:7168
    v_mfma_f32_16x16x32_bf16 v[156:159], v[212:215], v[252:255], v[156:159]
    ds_write_b32 v8, v94 offset:7168
    v_mul_f32 v104, v104, v108
    v_mul_f32 v105, v105, v109
    v_mfma_f32_16x16x32_bf16 v[48:51], a[56:59], v[240:243], 0
    v_mul_f32 v106, v106, v110
    v_mul_f32 v107, v107, v111
    v_mfma_f32_16x16x32_bf16 v[52:55], a[60:63], v[240:243], 0
    v_cvt_pk_bf16_f32 v248, v104, v105
    v_cvt_pk_bf16_f32 v249, v106, v107
    v_mul_f32 v112, v112, v116
    v_mfma_f32_16x16x32_bf16 v[56:59], a[64:67], v[240:243], 0
    buffer_load_dwordx4 a[152:155], v13, s[8:11], s31 offen offset:2048
    v_mul_f32 v113, v113, v117
    v_mul_f32 v114, v114, v118
    v_mul_f32 v115, v115, v119
    v_mfma_f32_16x16x32_bf16 v[60:63], a[68:71], v[240:243], 0
    v_cvt_pk_bf16_f32 v250, v112, v113
    v_cvt_pk_bf16_f32 v251, v114, v115
    v_mfma_f32_16x16x32_bf16 v[64:67], a[72:75], v[240:243], 0
    ds_write_b128 v6, v[248:251] offset:14336
    v_mul_f32 v120, v120, v124
    v_mul_f32 v121, v121, v125
    v_mfma_f32_16x16x32_bf16 v[68:71], a[76:79], v[240:243], 0
    buffer_load_dwordx4 a[156:159], v13, s[8:11], s31 offen offset:3072
    v_mul_f32 v122, v122, v126
    v_mul_f32 v123, v123, v127
    v_cvt_pk_bf16_f32 v120, v120, v121
    v_mfma_f32_16x16x32_bf16 v[72:75], a[80:83], v[240:243], 0
    v_cvt_pk_bf16_f32 v121, v122, v123
    v_permlane32_swap_b32 v128, v130
    v_mfma_f32_16x16x32_bf16 v[76:79], a[56:59], v[244:247], 0
    v_permlane32_swap_b32 v129, v131
    v_mul_f32 v128, v128, v130
    v_mul_f32 v129, v129, v131
    v_mfma_f32_16x16x32_bf16 v[80:83], a[60:63], v[244:247], 0
    v_cvt_pk_bf16_f32 v122, v128, v129
    ds_write_b64 v7, v[120:121] offset:14336
    ds_write_b32 v8, v122 offset:14336
    v_mfma_f32_16x16x32_bf16 v[84:87], a[64:67], v[244:247], 0
    s_mov_b32 s31, 7729152
    buffer_load_dwordx4 a[160:163], v13, s[8:11], s31 offen offset:0
    v_mul_f32 v132, v132, v136
    v_mul_f32 v133, v133, v137
    v_mul_f32 v134, v134, v138
    v_mfma_f32_16x16x32_bf16 v[88:91], a[68:71], v[244:247], 0
    v_mul_f32 v135, v135, v139
    v_cvt_pk_bf16_f32 v252, v132, v133
    v_mfma_f32_16x16x32_bf16 v[92:95], a[72:75], v[244:247], 0
    v_cvt_pk_bf16_f32 v253, v134, v135
    v_mul_f32 v140, v140, v144
    v_mul_f32 v141, v141, v145
    v_mfma_f32_16x16x32_bf16 v[96:99], a[76:79], v[244:247], 0
    buffer_load_dwordx4 a[164:167], v13, s[8:11], s31 offen offset:1024
    v_mul_f32 v142, v142, v146
    v_mul_f32 v143, v143, v147
    v_cvt_pk_bf16_f32 v254, v140, v141
    v_mfma_f32_16x16x32_bf16 v[100:103], a[80:83], v[244:247], 0
    v_cvt_pk_bf16_f32 v255, v142, v143
    ds_write_b128 v6, v[252:255] offset:21504
    v_mfma_f32_16x16x32_bf16 v[104:107], a[56:59], v[248:251], 0
    v_mul_f32 v148, v148, v152
    v_mul_f32 v149, v149, v153
    v_mul_f32 v150, v150, v154
    v_mfma_f32_16x16x32_bf16 v[108:111], a[60:63], v[248:251], 0
    v_mul_f32 v151, v151, v155
    v_cvt_pk_bf16_f32 v148, v148, v149
    v_cvt_pk_bf16_f32 v149, v150, v151
    v_mfma_f32_16x16x32_bf16 v[112:115], a[64:67], v[248:251], 0
    buffer_load_dwordx4 a[168:171], v13, s[8:11], s31 offen offset:2048
    v_permlane32_swap_b32 v156, v158
    v_permlane32_swap_b32 v157, v159
    v_mfma_f32_16x16x32_bf16 v[116:119], a[68:71], v[248:251], 0
    v_mul_f32 v156, v156, v158
    v_mul_f32 v157, v157, v159
    v_cvt_pk_bf16_f32 v150, v156, v157
    v_mfma_f32_16x16x32_bf16 v[120:123], a[72:75], v[248:251], 0
    ds_write_b64 v7, v[148:149] offset:21504
    ds_write_b32 v8, v150 offset:21504
    v_mfma_f32_16x16x32_bf16 v[124:127], a[76:79], v[248:251], 0
    buffer_load_dwordx4 a[172:175], v13, s[8:11], s31 offen offset:3072
    v_mfma_f32_16x16x32_bf16 v[128:131], a[80:83], v[248:251], 0
    s_waitcnt lgkmcnt(0)
    s_barrier
    v_mfma_f32_16x16x32_bf16 v[132:135], a[56:59], v[252:255], 0
    ds_read_b128 v[224:227], v3 offset:0
    v_mfma_f32_16x16x32_bf16 v[136:139], a[60:63], v[252:255], 0
    ds_read_b128 v[228:231], v3 offset:7168
    v_mfma_f32_16x16x32_bf16 v[140:143], a[64:67], v[252:255], 0
    ds_read_b128 v[232:235], v3 offset:14336
    s_mov_b32 s31, 7733248
    buffer_load_dwordx4 a[176:179], v13, s[8:11], s31 offen offset:0
    v_mfma_f32_16x16x32_bf16 v[144:147], a[68:71], v[252:255], 0
    ds_read_b128 v[236:239], v3 offset:21504
    v_mfma_f32_16x16x32_bf16 v[148:151], a[72:75], v[252:255], 0
    v_mfma_f32_16x16x32_bf16 v[152:155], a[76:79], v[252:255], 0
    buffer_load_dwordx4 a[180:183], v13, s[8:11], s31 offen offset:1024
    v_mfma_f32_16x16x32_bf16 v[156:159], a[80:83], v[252:255], 0
    s_waitcnt lgkmcnt(3)
    v_mfma_f32_16x16x32_bf16 v[48:51], a[84:87], v[224:227], v[48:51]
    ds_read_b128 v[240:243], v4 offset:0
    s_waitcnt lgkmcnt(3)
    v_mfma_f32_16x16x32_bf16 v[76:79], a[84:87], v[228:231], v[76:79]
    ds_read_b128 v[244:247], v4 offset:7168
    buffer_load_dwordx4 a[184:187], v13, s[8:11], s31 offen offset:2048
    s_waitcnt lgkmcnt(3)
    v_mfma_f32_16x16x32_bf16 v[104:107], a[84:87], v[232:235], v[104:107]
    ds_read_b128 v[248:251], v4 offset:14336
    s_waitcnt lgkmcnt(3)
    v_mfma_f32_16x16x32_bf16 v[132:135], a[84:87], v[236:239], v[132:135]
    ds_read_b128 v[252:255], v4 offset:21504
    v_mfma_f32_16x16x32_bf16 v[52:55], a[88:91], v[224:227], v[52:55]
    s_mul_i32 s26, s22, 1792
    s_add_u32 s26, s26, 146944
    v_mfma_f32_16x16x32_bf16 v[80:83], a[88:91], v[228:231], v[80:83]
    buffer_load_dwordx4 a[188:191], v13, s[8:11], s31 offen offset:3072
    v_and_b32 v220, 48, v1
    v_mfma_f32_16x16x32_bf16 v[108:111], a[88:91], v[232:235], v[108:111]
    v_lshrrev_b32 v221, 8, v1
    v_mfma_f32_16x16x32_bf16 v[136:139], a[88:91], v[236:239], v[136:139]
    v_lshl_add_u32 v220, v221, 6, v220
    v_mfma_f32_16x16x32_bf16 v[56:59], a[92:95], v[224:227], v[56:59]
    v_add_u32 v220, s26, v220
    v_mfma_f32_16x16x32_bf16 v[84:87], a[92:95], v[228:231], v[84:87]
    s_mov_b32 s31, 7737344
    buffer_load_dwordx4 a[192:195], v13, s[8:11], s31 offen offset:0
    v_mfma_f32_16x16x32_bf16 v[112:115], a[92:95], v[232:235], v[112:115]
    v_mfma_f32_16x16x32_bf16 v[140:143], a[92:95], v[236:239], v[140:143]
    s_waitcnt lgkmcnt(0)
    v_mfma_f32_16x16x32_bf16 v[48:51], a[96:99], v[240:243], v[48:51]
    ds_read_b128 v[224:227], v5 offset:0
    v_mfma_f32_16x16x32_bf16 v[76:79], a[96:99], v[244:247], v[76:79]
    ds_read_b128 v[228:231], v5 offset:7168
    buffer_load_dwordx4 a[196:199], v13, s[8:11], s31 offen offset:1024
    v_mfma_f32_16x16x32_bf16 v[104:107], a[96:99], v[248:251], v[104:107]
    ds_read_b128 v[232:235], v5 offset:14336
    v_mfma_f32_16x16x32_bf16 v[132:135], a[96:99], v[252:255], v[132:135]
    ds_read_b128 v[236:239], v5 offset:21504
    s_waitcnt vmcnt(24)
    v_mfma_f32_16x16x32_bf16 v[52:55], a[100:103], v[240:243], v[52:55]
    v_mfma_f32_16x16x32_bf16 v[80:83], a[100:103], v[244:247], v[80:83]
    buffer_load_dwordx4 a[200:203], v13, s[8:11], s31 offen offset:2048
    v_mfma_f32_16x16x32_bf16 v[108:111], a[100:103], v[248:251], v[108:111]
    v_mfma_f32_16x16x32_bf16 v[136:139], a[100:103], v[252:255], v[136:139]
    s_waitcnt vmcnt(24)
    v_mfma_f32_16x16x32_bf16 v[56:59], a[104:107], v[240:243], v[56:59]
    v_mfma_f32_16x16x32_bf16 v[84:87], a[104:107], v[244:247], v[84:87]
    buffer_load_dwordx4 a[204:207], v13, s[8:11], s31 offen offset:3072
    v_mfma_f32_16x16x32_bf16 v[112:115], a[104:107], v[248:251], v[112:115]
    v_mfma_f32_16x16x32_bf16 v[140:143], a[104:107], v[252:255], v[140:143]
    s_waitcnt vmcnt(24)
    s_waitcnt lgkmcnt(0)
    v_mfma_f32_16x16x32_bf16 v[48:51], a[108:111], v[224:227], v[48:51]
    ds_read_b128 v[240:243], v2 offset:4096
    v_mfma_f32_16x16x32_bf16 v[76:79], a[108:111], v[228:231], v[76:79]
    ds_read_b128 v[244:247], v2 offset:11264
    s_mov_b32 s31, 7741440
    buffer_load_dwordx4 a[208:211], v13, s[8:11], s31 offen offset:0
    v_mfma_f32_16x16x32_bf16 v[104:107], a[108:111], v[232:235], v[104:107]
    ds_read_b128 v[248:251], v2 offset:18432
    v_mfma_f32_16x16x32_bf16 v[132:135], a[108:111], v[236:239], v[132:135]
    ds_read_b128 v[252:255], v2 offset:25600
    s_waitcnt vmcnt(24)
    v_mfma_f32_16x16x32_bf16 v[52:55], a[112:115], v[224:227], v[52:55]
    v_mfma_f32_16x16x32_bf16 v[80:83], a[112:115], v[228:231], v[80:83]
    buffer_load_dwordx4 a[212:215], v13, s[8:11], s31 offen offset:1024
    v_mfma_f32_16x16x32_bf16 v[108:111], a[112:115], v[232:235], v[108:111]
    v_mfma_f32_16x16x32_bf16 v[136:139], a[112:115], v[236:239], v[136:139]
    s_waitcnt vmcnt(24)
    v_mfma_f32_16x16x32_bf16 v[56:59], a[116:119], v[224:227], v[56:59]
    v_mfma_f32_16x16x32_bf16 v[84:87], a[116:119], v[228:231], v[84:87]
    buffer_load_dwordx4 a[216:219], v13, s[8:11], s31 offen offset:2048
    v_mfma_f32_16x16x32_bf16 v[112:115], a[116:119], v[232:235], v[112:115]
    v_mfma_f32_16x16x32_bf16 v[140:143], a[116:119], v[236:239], v[140:143]
    s_waitcnt vmcnt(24)
    s_waitcnt lgkmcnt(0)
    v_mfma_f32_16x16x32_bf16 v[48:51], a[120:123], v[240:243], v[48:51]
    ds_read_b128 v[224:227], v2 offset:5120
    v_mfma_f32_16x16x32_bf16 v[76:79], a[120:123], v[244:247], v[76:79]
    ds_read_b128 v[228:231], v2 offset:12288
    buffer_load_dwordx4 a[220:223], v13, s[8:11], s31 offen offset:3072
    v_mfma_f32_16x16x32_bf16 v[104:107], a[120:123], v[248:251], v[104:107]
    ds_read_b128 v[232:235], v2 offset:19456
    v_mfma_f32_16x16x32_bf16 v[132:135], a[120:123], v[252:255], v[132:135]
    ds_read_b128 v[236:239], v2 offset:26624
    s_waitcnt vmcnt(24)
    v_mfma_f32_16x16x32_bf16 v[52:55], a[124:127], v[240:243], v[52:55]
    v_mfma_f32_16x16x32_bf16 v[80:83], a[124:127], v[244:247], v[80:83]
    s_mov_b32 s31, 7745536
    buffer_load_dwordx4 a[224:227], v13, s[8:11], s31 offen offset:0
    v_mfma_f32_16x16x32_bf16 v[108:111], a[124:127], v[248:251], v[108:111]
    v_mfma_f32_16x16x32_bf16 v[136:139], a[124:127], v[252:255], v[136:139]
    s_waitcnt vmcnt(24)
    v_mfma_f32_16x16x32_bf16 v[56:59], a[128:131], v[240:243], v[56:59]
    v_mfma_f32_16x16x32_bf16 v[84:87], a[128:131], v[244:247], v[84:87]
    buffer_load_dwordx4 a[228:231], v13, s[8:11], s31 offen offset:1024
    v_mfma_f32_16x16x32_bf16 v[112:115], a[128:131], v[248:251], v[112:115]
    v_mfma_f32_16x16x32_bf16 v[140:143], a[128:131], v[252:255], v[140:143]
    s_waitcnt vmcnt(24)
    s_waitcnt lgkmcnt(0)
    v_mfma_f32_16x16x32_bf16 v[48:51], a[132:135], v[224:227], v[48:51]
    ds_read_b128 v[240:243], v2 offset:6144
    v_mfma_f32_16x16x32_bf16 v[76:79], a[132:135], v[228:231], v[76:79]
    ds_read_b128 v[244:247], v2 offset:13312
    buffer_load_dwordx4 a[232:235], v13, s[8:11], s31 offen offset:2048
    v_mfma_f32_16x16x32_bf16 v[104:107], a[132:135], v[232:235], v[104:107]
    ds_read_b128 v[248:251], v2 offset:20480
    v_mfma_f32_16x16x32_bf16 v[132:135], a[132:135], v[236:239], v[132:135]
    ds_read_b128 v[252:255], v2 offset:27648
    s_waitcnt vmcnt(24)
    v_mfma_f32_16x16x32_bf16 v[52:55], a[136:139], v[224:227], v[52:55]
    v_mfma_f32_16x16x32_bf16 v[80:83], a[136:139], v[228:231], v[80:83]
    buffer_load_dwordx4 a[236:239], v13, s[8:11], s31 offen offset:3072
    v_mfma_f32_16x16x32_bf16 v[108:111], a[136:139], v[232:235], v[108:111]
    v_mfma_f32_16x16x32_bf16 v[136:139], a[136:139], v[236:239], v[136:139]
    s_waitcnt vmcnt(24)
    v_mfma_f32_16x16x32_bf16 v[56:59], a[140:143], v[224:227], v[56:59]
    v_mfma_f32_16x16x32_bf16 v[84:87], a[140:143], v[228:231], v[84:87]
    s_mov_b32 s31, 7749632
    buffer_load_dwordx4 a[240:243], v13, s[8:11], s31 offen offset:0
    v_mfma_f32_16x16x32_bf16 v[112:115], a[140:143], v[232:235], v[112:115]
    v_mfma_f32_16x16x32_bf16 v[140:143], a[140:143], v[236:239], v[140:143]
    s_waitcnt vmcnt(24)
    s_waitcnt lgkmcnt(0)
    v_mfma_f32_16x16x32_bf16 v[48:51], a[144:147], v[240:243], v[48:51]
    ds_read_b128 v[224:227], v3 offset:0
    v_mfma_f32_16x16x32_bf16 v[76:79], a[144:147], v[244:247], v[76:79]
    ds_read_b128 v[228:231], v3 offset:7168
    buffer_load_dwordx4 a[244:247], v13, s[8:11], s31 offen offset:1024
    v_mfma_f32_16x16x32_bf16 v[104:107], a[144:147], v[248:251], v[104:107]
    ds_read_b128 v[232:235], v3 offset:14336
    v_mfma_f32_16x16x32_bf16 v[132:135], a[144:147], v[252:255], v[132:135]
    ds_read_b128 v[236:239], v3 offset:21504
    s_waitcnt vmcnt(24)
    v_mfma_f32_16x16x32_bf16 v[52:55], a[148:151], v[240:243], v[52:55]
    v_mfma_f32_16x16x32_bf16 v[80:83], a[148:151], v[244:247], v[80:83]
    buffer_load_dwordx4 a[248:251], v13, s[8:11], s31 offen offset:2048
    v_mfma_f32_16x16x32_bf16 v[108:111], a[148:151], v[248:251], v[108:111]
    v_mfma_f32_16x16x32_bf16 v[136:139], a[148:151], v[252:255], v[136:139]
    s_waitcnt vmcnt(24)
    v_mfma_f32_16x16x32_bf16 v[56:59], a[152:155], v[240:243], v[56:59]
    v_mfma_f32_16x16x32_bf16 v[84:87], a[152:155], v[244:247], v[84:87]
    v_mfma_f32_16x16x32_bf16 v[112:115], a[152:155], v[248:251], v[112:115]
    v_mfma_f32_16x16x32_bf16 v[140:143], a[152:155], v[252:255], v[140:143]
    s_waitcnt vmcnt(23)
    s_waitcnt lgkmcnt(0)
    v_mfma_f32_16x16x32_bf16 v[60:63], a[156:159], v[224:227], v[60:63]
    ds_read_b128 v[240:243], v4 offset:0
    v_mfma_f32_16x16x32_bf16 v[88:91], a[156:159], v[228:231], v[88:91]
    ds_read_b128 v[244:247], v4 offset:7168
    v_mfma_f32_16x16x32_bf16 v[116:119], a[156:159], v[232:235], v[116:119]
    ds_read_b128 v[248:251], v4 offset:14336
    v_mfma_f32_16x16x32_bf16 v[144:147], a[156:159], v[236:239], v[144:147]
    ds_read_b128 v[252:255], v4 offset:21504
    s_waitcnt vmcnt(22)
    v_mfma_f32_16x16x32_bf16 v[64:67], a[160:163], v[224:227], v[64:67]
    v_cvt_pk_bf16_f32 v48, v48, v49
    v_mfma_f32_16x16x32_bf16 v[92:95], a[160:163], v[228:231], v[92:95]
    v_cvt_pk_bf16_f32 v49, v50, v51
    v_mfma_f32_16x16x32_bf16 v[120:123], a[160:163], v[232:235], v[120:123]
    v_cvt_pk_bf16_f32 v50, v76, v77
    v_mfma_f32_16x16x32_bf16 v[148:151], a[160:163], v[236:239], v[148:151]
    v_cvt_pk_bf16_f32 v51, v78, v79
    s_waitcnt vmcnt(21)
    s_waitcnt lgkmcnt(0)
    v_mfma_f32_16x16x32_bf16 v[60:63], a[164:167], v[240:243], v[60:63]
    ds_read_b128 v[224:227], v5 offset:0
    buffer_store_dwordx4 v[48:51], v9, s[8:11], s38 offen offset:0 sc1
    v_mfma_f32_16x16x32_bf16 v[88:91], a[164:167], v[244:247], v[88:91]
    ds_read_b128 v[228:231], v5 offset:7168
    s_mov_b64 exec, s[44:45]
    ds_write_b128 v220, v[48:51] offset:0
    s_mov_b64 exec, -1
    v_mfma_f32_16x16x32_bf16 v[116:119], a[164:167], v[248:251], v[116:119]
    ds_read_b128 v[232:235], v5 offset:14336
    v_cvt_pk_bf16_f32 v104, v104, v105
    v_mfma_f32_16x16x32_bf16 v[144:147], a[164:167], v[252:255], v[144:147]
    ds_read_b128 v[236:239], v5 offset:21504
    v_cvt_pk_bf16_f32 v105, v106, v107
    s_waitcnt vmcnt(21)
    v_mfma_f32_16x16x32_bf16 v[64:67], a[168:171], v[240:243], v[64:67]
    v_cvt_pk_bf16_f32 v106, v132, v133
    v_mfma_f32_16x16x32_bf16 v[92:95], a[168:171], v[244:247], v[92:95]
    v_cvt_pk_bf16_f32 v107, v134, v135
    v_mfma_f32_16x16x32_bf16 v[120:123], a[168:171], v[248:251], v[120:123]
    buffer_store_dwordx4 v[104:107], v218, s[8:11], s39 offen offset:0 sc1
    v_mfma_f32_16x16x32_bf16 v[148:151], a[168:171], v[252:255], v[148:151]
    s_mov_b64 exec, s[46:47]
    ds_write_b128 v220, v[104:107] offset:0
    s_mov_b64 exec, -1
    s_waitcnt vmcnt(21)
    s_waitcnt lgkmcnt(1)
    v_mfma_f32_16x16x32_bf16 v[60:63], a[172:175], v[224:227], v[60:63]
    ds_read_b128 v[240:243], v2 offset:4096
    v_cvt_pk_bf16_f32 v52, v52, v53
    v_mfma_f32_16x16x32_bf16 v[88:91], a[172:175], v[228:231], v[88:91]
    ds_read_b128 v[244:247], v2 offset:11264
    v_cvt_pk_bf16_f32 v53, v54, v55
    v_mfma_f32_16x16x32_bf16 v[116:119], a[172:175], v[232:235], v[116:119]
    ds_read_b128 v[248:251], v2 offset:18432
    v_cvt_pk_bf16_f32 v54, v80, v81
    v_mfma_f32_16x16x32_bf16 v[144:147], a[172:175], v[236:239], v[144:147]
    ds_read_b128 v[252:255], v2 offset:25600
    v_cvt_pk_bf16_f32 v55, v82, v83
    s_waitcnt vmcnt(20)
    v_mfma_f32_16x16x32_bf16 v[64:67], a[176:179], v[224:227], v[64:67]
    buffer_store_dwordx4 v[52:55], v9, s[8:11], s38 offen offset:256 sc1
    v_mfma_f32_16x16x32_bf16 v[92:95], a[176:179], v[228:231], v[92:95]
    s_mov_b64 exec, s[44:45]
    ds_write_b128 v220, v[52:55] offset:256
    s_mov_b64 exec, -1
    v_mfma_f32_16x16x32_bf16 v[120:123], a[176:179], v[232:235], v[120:123]
    v_cvt_pk_bf16_f32 v108, v108, v109
    v_mfma_f32_16x16x32_bf16 v[148:151], a[176:179], v[236:239], v[148:151]
    v_cvt_pk_bf16_f32 v109, v110, v111
    s_waitcnt vmcnt(20)
    s_waitcnt lgkmcnt(1)
    v_mfma_f32_16x16x32_bf16 v[60:63], a[180:183], v[240:243], v[60:63]
    ds_read_b128 v[224:227], v2 offset:5120
    v_cvt_pk_bf16_f32 v110, v136, v137
    v_mfma_f32_16x16x32_bf16 v[88:91], a[180:183], v[244:247], v[88:91]
    ds_read_b128 v[228:231], v2 offset:12288
    v_cvt_pk_bf16_f32 v111, v138, v139
    v_mfma_f32_16x16x32_bf16 v[116:119], a[180:183], v[248:251], v[116:119]
    ds_read_b128 v[232:235], v2 offset:19456
    buffer_store_dwordx4 v[108:111], v218, s[8:11], s39 offen offset:256 sc1
    v_mfma_f32_16x16x32_bf16 v[144:147], a[180:183], v[252:255], v[144:147]
    ds_read_b128 v[236:239], v2 offset:26624
    s_mov_b64 exec, s[46:47]
    ds_write_b128 v220, v[108:111] offset:256
    s_mov_b64 exec, -1
    s_waitcnt vmcnt(20)
    v_mfma_f32_16x16x32_bf16 v[64:67], a[184:187], v[240:243], v[64:67]
    v_cvt_pk_bf16_f32 v56, v56, v57
    v_mfma_f32_16x16x32_bf16 v[92:95], a[184:187], v[244:247], v[92:95]
    v_cvt_pk_bf16_f32 v57, v58, v59
    v_mfma_f32_16x16x32_bf16 v[120:123], a[184:187], v[248:251], v[120:123]
    v_cvt_pk_bf16_f32 v58, v84, v85
    v_mfma_f32_16x16x32_bf16 v[148:151], a[184:187], v[252:255], v[148:151]
    v_cvt_pk_bf16_f32 v59, v86, v87
    s_waitcnt vmcnt(19)
    s_waitcnt lgkmcnt(1)
    v_mfma_f32_16x16x32_bf16 v[60:63], a[188:191], v[224:227], v[60:63]
    ds_read_b128 v[240:243], v2 offset:6144
    buffer_store_dwordx4 v[56:59], v9, s[8:11], s38 offen offset:512 sc1
    v_mfma_f32_16x16x32_bf16 v[88:91], a[188:191], v[228:231], v[88:91]
    ds_read_b128 v[244:247], v2 offset:13312
    s_mov_b64 exec, s[44:45]
    ds_write_b128 v220, v[56:59] offset:512
    s_mov_b64 exec, -1
    v_mfma_f32_16x16x32_bf16 v[116:119], a[188:191], v[232:235], v[116:119]
    ds_read_b128 v[248:251], v2 offset:20480
    v_cvt_pk_bf16_f32 v112, v112, v113
    v_mfma_f32_16x16x32_bf16 v[144:147], a[188:191], v[236:239], v[144:147]
    ds_read_b128 v[252:255], v2 offset:27648
    v_cvt_pk_bf16_f32 v113, v114, v115
    s_waitcnt vmcnt(19)
    v_mfma_f32_16x16x32_bf16 v[64:67], a[192:195], v[224:227], v[64:67]
    v_cvt_pk_bf16_f32 v114, v140, v141
    v_mfma_f32_16x16x32_bf16 v[92:95], a[192:195], v[228:231], v[92:95]
    v_cvt_pk_bf16_f32 v115, v142, v143
    v_mfma_f32_16x16x32_bf16 v[120:123], a[192:195], v[232:235], v[120:123]
    buffer_store_dwordx4 v[112:115], v218, s[8:11], s39 offen offset:512 sc1
    v_mfma_f32_16x16x32_bf16 v[148:151], a[192:195], v[236:239], v[148:151]
    s_mov_b64 exec, s[46:47]
    ds_write_b128 v220, v[112:115] offset:512
    s_mov_b64 exec, -1
    s_waitcnt vmcnt(19)
    s_waitcnt lgkmcnt(1)
    v_mfma_f32_16x16x32_bf16 v[60:63], a[196:199], v[240:243], v[60:63]
    ds_read_b128 v[224:227], v3 offset:0
    v_mfma_f32_16x16x32_bf16 v[88:91], a[196:199], v[244:247], v[88:91]
    ds_read_b128 v[228:231], v3 offset:7168
    v_mfma_f32_16x16x32_bf16 v[116:119], a[196:199], v[248:251], v[116:119]
    ds_read_b128 v[232:235], v3 offset:14336
    v_mfma_f32_16x16x32_bf16 v[144:147], a[196:199], v[252:255], v[144:147]
    ds_read_b128 v[236:239], v3 offset:21504
    s_waitcnt vmcnt(18)
    v_mfma_f32_16x16x32_bf16 v[64:67], a[200:203], v[240:243], v[64:67]
    v_mfma_f32_16x16x32_bf16 v[92:95], a[200:203], v[244:247], v[92:95]
    v_mfma_f32_16x16x32_bf16 v[120:123], a[200:203], v[248:251], v[120:123]
    v_mfma_f32_16x16x32_bf16 v[148:151], a[200:203], v[252:255], v[148:151]
    s_waitcnt vmcnt(17)
    s_waitcnt lgkmcnt(0)
    v_mfma_f32_16x16x32_bf16 v[68:71], a[204:207], v[224:227], v[68:71]
    ds_read_b128 v[240:243], v4 offset:0
    v_mfma_f32_16x16x32_bf16 v[96:99], a[204:207], v[228:231], v[96:99]
    ds_read_b128 v[244:247], v4 offset:7168
    v_mfma_f32_16x16x32_bf16 v[124:127], a[204:207], v[232:235], v[124:127]
    ds_read_b128 v[248:251], v4 offset:14336
    v_mfma_f32_16x16x32_bf16 v[152:155], a[204:207], v[236:239], v[152:155]
    ds_read_b128 v[252:255], v4 offset:21504
    s_waitcnt vmcnt(16)
    v_mfma_f32_16x16x32_bf16 v[72:75], a[208:211], v[224:227], v[72:75]
    v_cvt_pk_bf16_f32 v60, v60, v61
    v_mfma_f32_16x16x32_bf16 v[100:103], a[208:211], v[228:231], v[100:103]
    v_cvt_pk_bf16_f32 v61, v62, v63
    v_mfma_f32_16x16x32_bf16 v[128:131], a[208:211], v[232:235], v[128:131]
    v_cvt_pk_bf16_f32 v62, v88, v89
    v_mfma_f32_16x16x32_bf16 v[156:159], a[208:211], v[236:239], v[156:159]
    v_cvt_pk_bf16_f32 v63, v90, v91
    s_waitcnt vmcnt(15)
    s_waitcnt lgkmcnt(0)
    v_mfma_f32_16x16x32_bf16 v[68:71], a[212:215], v[240:243], v[68:71]
    ds_read_b128 v[224:227], v5 offset:0
    buffer_store_dwordx4 v[60:63], v9, s[8:11], s38 offen offset:768 sc1
    v_mfma_f32_16x16x32_bf16 v[96:99], a[212:215], v[244:247], v[96:99]
    ds_read_b128 v[228:231], v5 offset:7168
    s_mov_b64 exec, s[44:45]
    ds_write_b128 v220, v[60:63] offset:768
    s_mov_b64 exec, -1
    v_mfma_f32_16x16x32_bf16 v[124:127], a[212:215], v[248:251], v[124:127]
    ds_read_b128 v[232:235], v5 offset:14336
    v_cvt_pk_bf16_f32 v116, v116, v117
    v_mfma_f32_16x16x32_bf16 v[152:155], a[212:215], v[252:255], v[152:155]
    ds_read_b128 v[236:239], v5 offset:21504
    v_cvt_pk_bf16_f32 v117, v118, v119
    s_waitcnt vmcnt(15)
    v_mfma_f32_16x16x32_bf16 v[72:75], a[216:219], v[240:243], v[72:75]
    v_cvt_pk_bf16_f32 v118, v144, v145
    v_mfma_f32_16x16x32_bf16 v[100:103], a[216:219], v[244:247], v[100:103]
    v_cvt_pk_bf16_f32 v119, v146, v147
    v_mfma_f32_16x16x32_bf16 v[128:131], a[216:219], v[248:251], v[128:131]
    buffer_store_dwordx4 v[116:119], v218, s[8:11], s39 offen offset:768 sc1
    v_mfma_f32_16x16x32_bf16 v[156:159], a[216:219], v[252:255], v[156:159]
    s_mov_b64 exec, s[46:47]
    ds_write_b128 v220, v[116:119] offset:768
    s_mov_b64 exec, -1
    s_waitcnt vmcnt(15)
    s_waitcnt lgkmcnt(1)
    v_mfma_f32_16x16x32_bf16 v[68:71], a[220:223], v[224:227], v[68:71]
    ds_read_b128 v[240:243], v2 offset:4096
    v_cvt_pk_bf16_f32 v64, v64, v65
    v_mfma_f32_16x16x32_bf16 v[96:99], a[220:223], v[228:231], v[96:99]
    ds_read_b128 v[244:247], v2 offset:11264
    v_cvt_pk_bf16_f32 v65, v66, v67
    v_mfma_f32_16x16x32_bf16 v[124:127], a[220:223], v[232:235], v[124:127]
    ds_read_b128 v[248:251], v2 offset:18432
    v_cvt_pk_bf16_f32 v66, v92, v93
    v_mfma_f32_16x16x32_bf16 v[152:155], a[220:223], v[236:239], v[152:155]
    ds_read_b128 v[252:255], v2 offset:25600
    v_cvt_pk_bf16_f32 v67, v94, v95
    s_waitcnt vmcnt(14)
    v_mfma_f32_16x16x32_bf16 v[72:75], a[224:227], v[224:227], v[72:75]
    buffer_store_dwordx4 v[64:67], v9, s[8:11], s38 offen offset:1024 sc1
    v_mfma_f32_16x16x32_bf16 v[100:103], a[224:227], v[228:231], v[100:103]
    s_mov_b64 exec, s[44:45]
    ds_write_b128 v220, v[64:67] offset:1024
    s_mov_b64 exec, -1
    v_mfma_f32_16x16x32_bf16 v[128:131], a[224:227], v[232:235], v[128:131]
    v_cvt_pk_bf16_f32 v120, v120, v121
    v_mfma_f32_16x16x32_bf16 v[156:159], a[224:227], v[236:239], v[156:159]
    v_cvt_pk_bf16_f32 v121, v122, v123
    s_waitcnt vmcnt(14)
    s_waitcnt lgkmcnt(1)
    v_mfma_f32_16x16x32_bf16 v[68:71], a[228:231], v[240:243], v[68:71]
    ds_read_b128 v[224:227], v2 offset:5120
    v_cvt_pk_bf16_f32 v122, v148, v149
    v_mfma_f32_16x16x32_bf16 v[96:99], a[228:231], v[244:247], v[96:99]
    ds_read_b128 v[228:231], v2 offset:12288
    v_cvt_pk_bf16_f32 v123, v150, v151
    v_mfma_f32_16x16x32_bf16 v[124:127], a[228:231], v[248:251], v[124:127]
    ds_read_b128 v[232:235], v2 offset:19456
    buffer_store_dwordx4 v[120:123], v218, s[8:11], s39 offen offset:1024 sc1
    v_mfma_f32_16x16x32_bf16 v[152:155], a[228:231], v[252:255], v[152:155]
    ds_read_b128 v[236:239], v2 offset:26624
    s_mov_b64 exec, s[46:47]
    ds_write_b128 v220, v[120:123] offset:1024
    s_mov_b64 exec, -1
    s_waitcnt vmcnt(14)
    v_mfma_f32_16x16x32_bf16 v[72:75], a[232:235], v[240:243], v[72:75]
    v_mfma_f32_16x16x32_bf16 v[100:103], a[232:235], v[244:247], v[100:103]
    v_mfma_f32_16x16x32_bf16 v[128:131], a[232:235], v[248:251], v[128:131]
    v_mfma_f32_16x16x32_bf16 v[156:159], a[232:235], v[252:255], v[156:159]
    s_waitcnt vmcnt(13)
    s_waitcnt lgkmcnt(1)
    v_mfma_f32_16x16x32_bf16 v[68:71], a[236:239], v[224:227], v[68:71]
    ds_read_b128 v[240:243], v2 offset:6144
    v_mfma_f32_16x16x32_bf16 v[96:99], a[236:239], v[228:231], v[96:99]
    ds_read_b128 v[244:247], v2 offset:13312
    v_mfma_f32_16x16x32_bf16 v[124:127], a[236:239], v[232:235], v[124:127]
    ds_read_b128 v[248:251], v2 offset:20480
    v_mfma_f32_16x16x32_bf16 v[152:155], a[236:239], v[236:239], v[152:155]
    ds_read_b128 v[252:255], v2 offset:27648
    s_waitcnt vmcnt(12)
    v_mfma_f32_16x16x32_bf16 v[72:75], a[240:243], v[224:227], v[72:75]
    v_mfma_f32_16x16x32_bf16 v[100:103], a[240:243], v[228:231], v[100:103]
    v_mfma_f32_16x16x32_bf16 v[128:131], a[240:243], v[232:235], v[128:131]
    v_mfma_f32_16x16x32_bf16 v[156:159], a[240:243], v[236:239], v[156:159]
    s_waitcnt vmcnt(11)
    s_waitcnt lgkmcnt(0)
    v_mfma_f32_16x16x32_bf16 v[68:71], a[244:247], v[240:243], v[68:71]
    v_mfma_f32_16x16x32_bf16 v[96:99], a[244:247], v[244:247], v[96:99]
    v_mfma_f32_16x16x32_bf16 v[124:127], a[244:247], v[248:251], v[124:127]
    v_mfma_f32_16x16x32_bf16 v[152:155], a[244:247], v[252:255], v[152:155]
    s_waitcnt vmcnt(10)
    v_mfma_f32_16x16x32_bf16 v[72:75], a[248:251], v[240:243], v[72:75]
    s_nop 2
    v_cvt_pk_bf16_f32 v68, v68, v69
    v_cvt_pk_bf16_f32 v69, v70, v71
    v_mfma_f32_16x16x32_bf16 v[100:103], a[248:251], v[244:247], v[100:103]
    v_cvt_pk_bf16_f32 v70, v96, v97
    v_cvt_pk_bf16_f32 v71, v98, v99
    v_mfma_f32_16x16x32_bf16 v[128:131], a[248:251], v[248:251], v[128:131]
    buffer_store_dwordx4 v[68:71], v9, s[8:11], s38 offen offset:1280 sc1
    s_mov_b64 exec, s[44:45]
    ds_write_b128 v220, v[68:71] offset:1280
    s_mov_b64 exec, -1
    v_mfma_f32_16x16x32_bf16 v[156:159], a[248:251], v[252:255], v[156:159]
    v_cvt_pk_bf16_f32 v124, v124, v125
    v_cvt_pk_bf16_f32 v125, v126, v127
    v_cvt_pk_bf16_f32 v126, v152, v153
    v_cvt_pk_bf16_f32 v127, v154, v155
    buffer_store_dwordx4 v[124:127], v218, s[8:11], s39 offen offset:1280 sc1
    s_mov_b64 exec, s[46:47]
    ds_write_b128 v220, v[124:127] offset:1280
    s_mov_b64 exec, -1
    v_cvt_pk_bf16_f32 v72, v72, v73
    v_cvt_pk_bf16_f32 v73, v74, v75
    v_cvt_pk_bf16_f32 v74, v100, v101
    v_cvt_pk_bf16_f32 v75, v102, v103
    buffer_store_dwordx4 v[72:75], v9, s[8:11], s38 offen offset:1536 sc1
    s_mov_b64 exec, s[44:45]
    ds_write_b128 v220, v[72:75] offset:1536
    s_mov_b64 exec, -1
    v_cvt_pk_bf16_f32 v128, v128, v129
    v_cvt_pk_bf16_f32 v129, v130, v131
    v_cvt_pk_bf16_f32 v130, v156, v157
    v_cvt_pk_bf16_f32 v131, v158, v159
    buffer_store_dwordx4 v[128:131], v218, s[8:11], s39 offen offset:1536 sc1
    s_mov_b64 exec, s[46:47]
    ds_write_b128 v220, v[128:131] offset:1536
    s_mov_b64 exec, -1
    s_mov_b32 s33, 28672
    s_lshl_b32 s26, s22, 11
    s_add_u32 s26, s26, 146944
    v_lshrrev_b32 v220, 8, v1
    v_lshl_add_u32 v220, v220, 8, v1
    v_add_u32 v220, s26, v220
    s_waitcnt lgkmcnt(0)
    s_barrier
    ds_read_b128 v[104:107], v220 offset:0
    ds_read_b128 v[108:111], v220 offset:256
    s_waitcnt vmcnt(0)
    s_mov_b64 exec, 1
    buffer_store_dword v43, v14, s[8:11], s33 offen offset:0 sc1
    s_mov_b64 exec, -1
    s_waitcnt lgkmcnt(1)
    v_dot2_f32_bf16 v16, v104, s40, v16
    v_dot2_f32_bf16 v17, v104, s41, v17
    v_dot2_f32_bf16 v18, v105, s40, v18
    v_dot2_f32_bf16 v19, v105, s41, v19
    v_dot2_f32_bf16 v24, v106, s40, v24
    v_dot2_f32_bf16 v25, v106, s41, v25
    v_dot2_f32_bf16 v26, v107, s40, v26
    v_dot2_f32_bf16 v27, v107, s41, v27
    s_waitcnt lgkmcnt(0)
    v_dot2_f32_bf16 v20, v108, s40, v20
    v_dot2_f32_bf16 v21, v108, s41, v21
    v_dot2_f32_bf16 v22, v109, s40, v22
    v_dot2_f32_bf16 v23, v109, s41, v23
    v_dot2_f32_bf16 v28, v110, s40, v28
    v_dot2_f32_bf16 v29, v110, s41, v29
    v_dot2_f32_bf16 v30, v111, s40, v30
    v_dot2_f32_bf16 v31, v111, s41, v31
    v_lshlrev_b32 v112, 16, v32
    v_and_b32 v120, 0xffff0000, v32
    v_lshlrev_b32 v113, 16, v33
    v_and_b32 v121, 0xffff0000, v33
    v_lshlrev_b32 v114, 16, v34
    v_and_b32 v122, 0xffff0000, v34
    v_lshlrev_b32 v115, 16, v35
    v_and_b32 v123, 0xffff0000, v35
    v_lshlrev_b32 v116, 16, v36
    v_and_b32 v124, 0xffff0000, v36
    v_lshlrev_b32 v117, 16, v37
    v_and_b32 v125, 0xffff0000, v37
    v_lshlrev_b32 v118, 16, v38
    v_and_b32 v126, 0xffff0000, v38
    v_lshlrev_b32 v119, 16, v39
    v_and_b32 v127, 0xffff0000, v39
    s_mov_b32 s34, 0
    buffer_load_dword v42, v15, s[8:11], s33 offen sc1
L_pp_8:
    buffer_load_dword v47, v15, s[8:11], s33 offen sc1
    s_waitcnt vmcnt(1)
    v_and_b32 v46, -16, v42
    v_cmp_ne_u32 vcc, s42, v46
    s_cbranch_vccz L_pp_8_x
    buffer_load_dword v42, v15, s[8:11], s33 offen sc1
    s_waitcnt vmcnt(1)
    v_and_b32 v46, -16, v47
    v_cmp_ne_u32 vcc, s42, v46
    s_cbranch_vccz L_pp_8_x
    s_add_u32 s34, s34, 1
    s_cmp_lt_u32 s34, 1048576
    s_cbranch_scc1 L_pp_8
L_pp_8_x:
    s_mov_b32 s33, 18874368
    buffer_load_dwordx4 v[48:51], v10, s[8:11], s33 offen offset:0 sc1
    buffer_load_dwordx4 v[52:55], v10, s[8:11], s33 offen offset:256 sc1
    s_mov_b32 s33, 18881536
    buffer_load_dwordx4 v[56:59], v10, s[8:11], s33 offen offset:0 sc1
    buffer_load_dwordx4 v[60:63], v10, s[8:11], s33 offen offset:256 sc1
    s_mov_b32 s33, 18888704
    buffer_load_dwordx4 v[64:67], v10, s[8:11], s33 offen offset:0 sc1
    buffer_load_dwordx4 v[68:71], v10, s[8:11], s33 offen offset:256 sc1
    s_mov_b32 s33, 18895872
    buffer_load_dwordx4 v[72:75], v10, s[8:11], s33 offen offset:0 sc1
    buffer_load_dwordx4 v[76:79], v10, s[8:11], s33 offen offset:256 sc1
    s_mov_b32 s33, 18903040
    buffer_load_dwordx4 v[80:83], v10, s[8:11], s33 offen offset:0 sc1
    buffer_load_dwordx4 v[84:87], v10, s[8:11], s33 offen offset:256 sc1
    s_mov_b32 s33, 18910208
    buffer_load_dwordx4 v[88:91], v10, s[8:11], s33 offen offset:0 sc1
    buffer_load_dwordx4 v[92:95], v10, s[8:11], s33 offen offset:256 sc1
    s_mov_b32 s33, 18917376
    buffer_load_dwordx4 v[96:99], v10, s[8:11], s33 offen offset:0 sc1
    buffer_load_dwordx4 v[100:103], v10, s[8:11], s33 offen offset:256 sc1
    s_waitcnt vmcnt(13)
    v_dot2_f32_bf16 v16, v48, s40, v16
    v_dot2_f32_bf16 v17, v48, s41, v17
    v_dot2_f32_bf16 v18, v49, s40, v18
    v_dot2_f32_bf16 v19, v49, s41, v19
    v_dot2_f32_bf16 v24, v50, s40, v24
    v_dot2_f32_bf16 v25, v50, s41, v25
    v_dot2_f32_bf16 v26, v51, s40, v26
    v_dot2_f32_bf16 v27, v51, s41, v27
    s_waitcnt vmcnt(12)
    v_dot2_f32_bf16 v20, v52, s40, v20
    v_dot2_f32_bf16 v21, v52, s41, v21
    v_dot2_f32_bf16 v22, v53, s40, v22
    v_dot2_f32_bf16 v23, v53, s41, v23
    v_dot2_f32_bf16 v28, v54, s40, v28
    v_dot2_f32_bf16 v29, v54, s41, v29
    v_dot2_f32_bf16 v30, v55, s40, v30
    v_dot2_f32_bf16 v31, v55, s41, v31
    s_waitcnt vmcnt(11)
    v_dot2_f32_bf16 v16, v56, s40, v16
    v_dot2_f32_bf16 v17, v56, s41, v17
    v_dot2_f32_bf16 v18, v57, s40, v18
    v_dot2_f32_bf16 v19, v57, s41, v19
    v_dot2_f32_bf16 v24, v58, s40, v24
    v_dot2_f32_bf16 v25, v58, s41, v25
    v_dot2_f32_bf16 v26, v59, s40, v26
    v_dot2_f32_bf16 v27, v59, s41, v27
    s_waitcnt vmcnt(10)
    v_dot2_f32_bf16 v20, v60, s40, v20
    v_dot2_f32_bf16 v21, v60, s41, v21
    v_dot2_f32_bf16 v22, v61, s40, v22
    v_dot2_f32_bf16 v23, v61, s41, v23
    v_dot2_f32_bf16 v28, v62, s40, v28
    v_dot2_f32_bf16 v29, v62, s41, v29
    v_dot2_f32_bf16 v30, v63, s40, v30
    v_dot2_f32_bf16 v31, v63, s41, v31
    s_waitcnt vmcnt(9)
    v_dot2_f32_bf16 v16, v64, s40, v16
    v_dot2_f32_bf16 v17, v64, s41, v17
    v_dot2_f32_bf16 v18, v65, s40, v18
    v_dot2_f32_bf16 v19, v65, s41, v19
    v_dot2_f32_bf16 v24, v66, s40, v24
    v_dot2_f32_bf16 v25, v66, s41, v25
    v_dot2_f32_bf16 v26, v67, s40, v26
    v_dot2_f32_bf16 v27, v67, s41, v27
    s_waitcnt vmcnt(8)
    v_dot2_f32_bf16 v20, v68, s40, v20
    v_dot2_f32_bf16 v21, v68, s41, v21
    v_dot2_f32_bf16 v22, v69, s40, v22
    v_dot2_f32_bf16 v23, v69, s41, v23
    v_dot2_f32_bf16 v28, v70, s40, v28
    v_dot2_f32_bf16 v29, v70, s41, v29
    v_dot2_f32_bf16 v30, v71, s40, v30
    v_dot2_f32_bf16 v31, v71, s41, v31
    s_waitcnt vmcnt(7)
    v_dot2_f32_bf16 v16, v72, s40, v16
    v_dot2_f32_bf16 v17, v72, s41, v17
    v_dot2_f32_bf16 v18, v73, s40, v18
    v_dot2_f32_bf16 v19, v73, s41, v19
    v_dot2_f32_bf16 v24, v74, s40, v24
    v_dot2_f32_bf16 v25, v74, s41, v25
    v_dot2_f32_bf16 v26, v75, s40, v26
    v_dot2_f32_bf16 v27, v75, s41, v27
    s_waitcnt vmcnt(6)
    v_dot2_f32_bf16 v20, v76, s40, v20
    v_dot2_f32_bf16 v21, v76, s41, v21
    v_dot2_f32_bf16 v22, v77, s40, v22
    v_dot2_f32_bf16 v23, v77, s41, v23
    v_dot2_f32_bf16 v28, v78, s40, v28
    v_dot2_f32_bf16 v29, v78, s41, v29
    v_dot2_f32_bf16 v30, v79, s40, v30
    v_dot2_f32_bf16 v31, v79, s41, v31
    s_waitcnt vmcnt(5)
    v_dot2_f32_bf16 v16, v80, s40, v16
    v_dot2_f32_bf16 v17, v80, s41, v17
    v_dot2_f32_bf16 v18, v81, s40, v18
    v_dot2_f32_bf16 v19, v81, s41, v19
    v_dot2_f32_bf16 v24, v82, s40, v24
    v_dot2_f32_bf16 v25, v82, s41, v25
    v_dot2_f32_bf16 v26, v83, s40, v26
    v_dot2_f32_bf16 v27, v83, s41, v27
    s_waitcnt vmcnt(4)
    v_dot2_f32_bf16 v20, v84, s40, v20
    v_dot2_f32_bf16 v21, v84, s41, v21
    v_dot2_f32_bf16 v22, v85, s40, v22
    v_dot2_f32_bf16 v23, v85, s41, v23
    v_dot2_f32_bf16 v28, v86, s40, v28
    v_dot2_f32_bf16 v29, v86, s41, v29
    v_dot2_f32_bf16 v30, v87, s40, v30
    v_dot2_f32_bf16 v31, v87, s41, v31
    s_waitcnt vmcnt(3)
    v_dot2_f32_bf16 v16, v88, s40, v16
    v_dot2_f32_bf16 v17, v88, s41, v17
    v_dot2_f32_bf16 v18, v89, s40, v18
    v_dot2_f32_bf16 v19, v89, s41, v19
    v_dot2_f32_bf16 v24, v90, s40, v24
    v_dot2_f32_bf16 v25, v90, s41, v25
    v_dot2_f32_bf16 v26, v91, s40, v26
    v_dot2_f32_bf16 v27, v91, s41, v27
    s_waitcnt vmcnt(2)
    v_dot2_f32_bf16 v20, v92, s40, v20
    v_dot2_f32_bf16 v21, v92, s41, v21
    v_dot2_f32_bf16 v22, v93, s40, v22
    v_dot2_f32_bf16 v23, v93, s41, v23
    v_dot2_f32_bf16 v28, v94, s40, v28
    v_dot2_f32_bf16 v29, v94, s41, v29
    v_dot2_f32_bf16 v30, v95, s40, v30
    v_dot2_f32_bf16 v31, v95, s41, v31
    s_waitcnt vmcnt(1)
    v_dot2_f32_bf16 v16, v96, s40, v16
    v_dot2_f32_bf16 v17, v96, s41, v17
    v_dot2_f32_bf16 v18, v97, s40, v18
    v_dot2_f32_bf16 v19, v97, s41, v19
    v_dot2_f32_bf16 v24, v98, s40, v24
    v_dot2_f32_bf16 v25, v98, s41, v25
    v_dot2_f32_bf16 v26, v99, s40, v26
    v_dot2_f32_bf16 v27, v99, s41, v27
    s_waitcnt vmcnt(0)
    v_dot2_f32_bf16 v20, v100, s40, v20
    v_dot2_f32_bf16 v21, v100, s41, v21
    v_dot2_f32_bf16 v22, v101, s40, v22
    v_dot2_f32_bf16 v23, v101, s41, v23
    v_dot2_f32_bf16 v28, v102, s40, v28
    v_dot2_f32_bf16 v29, v102, s41, v29
    v_dot2_f32_bf16 v30, v103, s40, v30
    v_dot2_f32_bf16 v31, v103, s41, v31
    v_pk_add_f32 v[56:57], v[16:17], v[18:19]
    v_pk_mul_f32 v[58:59], v[16:17], v[16:17]
    v_pk_add_f32 v[56:57], v[56:57], v[20:21]
    v_pk_fma_f32 v[58:59], v[18:19], v[18:19], v[58:59]
    v_pk_add_f32 v[56:57], v[56:57], v[22:23]
    v_pk_fma_f32 v[58:59], v[20:21], v[20:21], v[58:59]
    v_add_f32 v56, v56, v57
    v_pk_fma_f32 v[58:59], v[22:23], v[22:23], v[58:59]
    v_pk_add_f32 v[60:61], v[24:25], v[26:27]
    v_pk_mul_f32 v[62:63], v[24:25], v[24:25]
    v_pk_add_f32 v[60:61], v[60:61], v[28:29]
    v_pk_fma_f32 v[62:63], v[26:27], v[26:27], v[62:63]
    v_pk_add_f32 v[60:61], v[60:61], v[30:31]
    v_pk_fma_f32 v[62:63], v[28:29], v[28:29], v[62:63]
    v_add_f32 v60, v60, v61
    v_pk_fma_f32 v[62:63], v[30:31], v[30:31], v[62:63]
    v_add_f32 v58, v58, v59
    v_add_f32 v62, v62, v63
    v_permlane32_swap_b32 v56, v60
    s_nop 0
    v_permlane32_swap_b32 v58, v62
    v_add_f32 v56, v56, v60
    v_add_f32 v58, v58, v62
    s_nop 1
    v_permlane16_swap_b32 v56, v58
    v_add_f32 v56, v56, v58
    s_nop 1
    v_add_f32_dpp v56, v56, v56 row_ror:4 row_mask:0xf bank_mask:0xf
    s_nop 1
    v_add_f32_dpp v56, v56, v56 row_ror:8 row_mask:0xf bank_mask:0xf
    ds_write_b32 v40, v56 offset:512
    s_waitcnt lgkmcnt(0)
    s_barrier
    ds_read_b128 v[56:59], v41 offset:512
    ds_read_b128 v[60:63], v41 offset:528
    ds_read_b128 v[64:67], v41 offset:544
    ds_read_b128 v[68:71], v41 offset:560
    s_waitcnt lgkmcnt(2)
    v_pk_add_f32 v[56:57], v[56:57], v[58:59]
    v_pk_add_f32 v[60:61], v[60:61], v[62:63]
    v_add_f32 v56, v56, v57
    v_add_f32 v60, v60, v61
    s_waitcnt lgkmcnt(0)
    v_pk_add_f32 v[64:65], v[64:65], v[66:67]
    v_pk_add_f32 v[68:69], v[68:69], v[70:71]
    v_add_f32 v64, v64, v65
    v_add_f32 v68, v68, v69
    v_mul_f32 v56, s36, v56
    v_fma_f32 v60, v60, s36, v44
    v_mul_f32 v64, s36, v64
    v_fma_f32 v68, v68, s36, v44
    v_fma_f32 v60, -v56, v56, v60
    v_fma_f32 v68, -v64, v64, v68
    v_max_f32 v60, v60, v44
    v_max_f32 v68, v68, v44
    v_rsq_f32 v48, v60
    v_rsq_f32 v52, v68
    v_mul_f32_e64 v50, -v56, v48
    v_mul_f32_e64 v54, -v64, v52
    v_pk_fma_f32 v[128:129], v[16:17], v[48:49], v[50:51] op_sel_hi:[1,0,0]
    v_pk_fma_f32 v[130:131], v[18:19], v[48:49], v[50:51] op_sel_hi:[1,0,0]
    v_pk_fma_f32 v[132:133], v[20:21], v[48:49], v[50:51] op_sel_hi:[1,0,0]
    v_pk_fma_f32 v[134:135], v[22:23], v[48:49], v[50:51] op_sel_hi:[1,0,0]
    v_pk_fma_f32 v[136:137], v[24:25], v[52:53], v[54:55] op_sel_hi:[1,0,0]
    v_pk_fma_f32 v[138:139], v[26:27], v[52:53], v[54:55] op_sel_hi:[1,0,0]
    v_pk_fma_f32 v[140:141], v[28:29], v[52:53], v[54:55] op_sel_hi:[1,0,0]
    v_pk_fma_f32 v[142:143], v[30:31], v[52:53], v[54:55] op_sel_hi:[1,0,0]
    s_mov_b32 s35, 16121856
    v_pk_fma_f32 v[16:17], v[128:129], v[112:113], v[16:17]
    v_pk_fma_f32 v[18:19], v[130:131], v[114:115], v[18:19]
    v_pk_fma_f32 v[20:21], v[132:133], v[116:117], v[20:21]
    v_pk_fma_f32 v[22:23], v[134:135], v[118:119], v[22:23]
    v_pk_fma_f32 v[24:25], v[136:137], v[120:121], v[24:25]
    v_pk_fma_f32 v[26:27], v[138:139], v[122:123], v[26:27]
    v_pk_fma_f32 v[28:29], v[140:141], v[124:125], v[28:29]
    v_pk_fma_f32 v[30:31], v[142:143], v[126:127], v[30:31]
    v_pk_add_f32 v[56:57], v[16:17], v[18:19]
    v_pk_mul_f32 v[58:59], v[16:17], v[16:17]
    v_pk_add_f32 v[56:57], v[56:57], v[20:21]
    v_pk_fma_f32 v[58:59], v[18:19], v[18:19], v[58:59]
    v_pk_add_f32 v[56:57], v[56:57], v[22:23]
    v_pk_fma_f32 v[58:59], v[20:21], v[20:21], v[58:59]
    v_add_f32 v56, v56, v57
    v_pk_fma_f32 v[58:59], v[22:23], v[22:23], v[58:59]
    v_pk_add_f32 v[60:61], v[24:25], v[26:27]
    v_pk_mul_f32 v[62:63], v[24:25], v[24:25]
    v_pk_add_f32 v[60:61], v[60:61], v[28:29]
    v_pk_fma_f32 v[62:63], v[26:27], v[26:27], v[62:63]
    v_pk_add_f32 v[60:61], v[60:61], v[30:31]
    v_pk_fma_f32 v[62:63], v[28:29], v[28:29], v[62:63]
    v_add_f32 v60, v60, v61
    v_pk_fma_f32 v[62:63], v[30:31], v[30:31], v[62:63]
    v_add_f32 v58, v58, v59
    v_add_f32 v62, v62, v63
    v_permlane32_swap_b32 v56, v60
    s_nop 0
    v_permlane32_swap_b32 v58, v62
    v_add_f32 v56, v56, v60
    v_add_f32 v58, v58, v62
    s_nop 1
    v_permlane16_swap_b32 v56, v58
    v_add_f32 v56, v56, v58
    s_nop 1
    v_add_f32_dpp v56, v56, v56 row_ror:4 row_mask:0xf bank_mask:0xf
    s_nop 1
    v_add_f32_dpp v56, v56, v56 row_ror:8 row_mask:0xf bank_mask:0xf
    ds_write_b32 v40, v56 offset:768
    s_waitcnt lgkmcnt(0)
    s_barrier
    ds_read_b128 v[56:59], v41 offset:768
    ds_read_b128 v[60:63], v41 offset:784
    ds_read_b128 v[64:67], v41 offset:800
    ds_read_b128 v[68:71], v41 offset:816
    s_waitcnt lgkmcnt(2)
    v_pk_add_f32 v[56:57], v[56:57], v[58:59]
    v_pk_add_f32 v[60:61], v[60:61], v[62:63]
    v_add_f32 v56, v56, v57
    v_add_f32 v60, v60, v61
    s_waitcnt lgkmcnt(0)
    v_pk_add_f32 v[64:65], v[64:65], v[66:67]
    v_pk_add_f32 v[68:69], v[68:69], v[70:71]
    v_add_f32 v64, v64, v65
    v_add_f32 v68, v68, v69
    v_mul_f32 v56, s36, v56
    v_fma_f32 v60, v60, s36, v44
    v_mul_f32 v64, s36, v64
    v_fma_f32 v68, v68, s36, v44
    v_fma_f32 v60, -v56, v56, v60
    v_fma_f32 v68, -v64, v64, v68
    v_max_f32 v60, v60, v44
    v_max_f32 v68, v68, v44
    v_rsq_f32 v48, v60
    v_rsq_f32 v52, v68
    v_mul_f32_e64 v50, -v56, v48
    v_mul_f32_e64 v54, -v64, v52
    v_pk_fma_f32 v[128:129], v[16:17], v[48:49], v[50:51] op_sel_hi:[1,0,0]
    v_pk_fma_f32 v[130:131], v[18:19], v[48:49], v[50:51] op_sel_hi:[1,0,0]
    v_pk_fma_f32 v[132:133], v[20:21], v[48:49], v[50:51] op_sel_hi:[1,0,0]
    v_pk_fma_f32 v[134:135], v[22:23], v[48:49], v[50:51] op_sel_hi:[1,0,0]
    v_pk_fma_f32 v[136:137], v[24:25], v[52:53], v[54:55] op_sel_hi:[1,0,0]
    v_pk_fma_f32 v[138:139], v[26:27], v[52:53], v[54:55] op_sel_hi:[1,0,0]
    v_pk_fma_f32 v[140:141], v[28:29], v[52:53], v[54:55] op_sel_hi:[1,0,0]
    v_pk_fma_f32 v[142:143], v[30:31], v[52:53], v[54:55] op_sel_hi:[1,0,0]
    v_cvt_pk_bf16_f32 v144, v128, v129
    v_cvt_pk_bf16_f32 v145, v130, v131
    v_cvt_pk_bf16_f32 v146, v132, v133
    v_cvt_pk_bf16_f32 v147, v134, v135
    s_add_u32 s33, s35, 0
    buffer_store_dwordx4 v[144:147], v11, s[8:11], s33 offen sc1
    v_cvt_pk_bf16_f32 v148, v136, v137
    v_cvt_pk_bf16_f32 v149, v138, v139
    v_cvt_pk_bf16_f32 v150, v140, v141
    v_cvt_pk_bf16_f32 v151, v142, v143
    s_add_u32 s33, s35, 14336
    buffer_store_dwordx4 v[148:151], v11, s[8:11], s33 offen sc1
    s_mov_b32 s33, 36864
    s_waitcnt vmcnt(0)
    s_mov_b64 exec, 1
    buffer_store_dword v43, v14, s[8:11], s33 offen offset:0 sc1
    s_mov_b64 exec, -1
    s_mov_b32 s34, 0
    buffer_load_dword v42, v15, s[8:11], s33 offen sc1
L_px_9:
    buffer_load_dword v47, v15, s[8:11], s33 offen sc1
    s_waitcnt vmcnt(1)
    v_and_b32 v46, -16, v42
    v_cmp_ne_u32 vcc, s42, v46
    s_cbranch_vccz L_px_9_x
    buffer_load_dword v42, v15, s[8:11], s33 offen sc1
    s_waitcnt vmcnt(1)
    v_and_b32 v46, -16, v47
    v_cmp_ne_u32 vcc, s42, v46
    s_cbranch_vccz L_px_9_x
    s_add_u32 s34, s34, 1
    s_cmp_lt_u32 s34, 1048576
    s_cbranch_scc1 L_px_9
L_px_9_x:
    s_mul_i32 s33, s22, 14336
    s_add_u32 s33, s33, 13312
    s_add_u32 s34, s33, s35
    s_mov_b32 m0, s33
    s_sub_u32 s33, s33, 1024
    buffer_load_dwordx4 v45, s[8:11], s34 offen sc1 lds
    s_sub_u32 s34, s34, 1024
    s_mov_b32 m0, s33
    s_sub_u32 s33, s33, 1024
    buffer_load_dwordx4 v45, s[8:11], s34 offen sc1 lds
    s_sub_u32 s34, s34, 1024
    s_mov_b32 m0, s33
    s_sub_u32 s33, s33, 1024
    buffer_load_dwordx4 v45, s[8:11], s34 offen sc1 lds
    s_sub_u32 s34, s34, 1024
    s_mov_b32 m0, s33
    s_sub_u32 s33, s33, 1024
    buffer_load_dwordx4 v45, s[8:11], s34 offen sc1 lds
    s_sub_u32 s34, s34, 1024
    s_mov_b32 m0, s33
    s_sub_u32 s33, s33, 1024
    buffer_load_dwordx4 v45, s[8:11], s34 offen sc1 lds
    s_sub_u32 s34, s34, 1024
    s_mov_b32 m0, s33
    s_sub_u32 s33, s33, 1024
    buffer_load_dwordx4 v45, s[8:11], s34 offen sc1 lds
    s_sub_u32 s34, s34, 1024
    s_mov_b32 m0, s33
    s_sub_u32 s33, s33, 1024
    buffer_load_dwordx4 v45, s[8:11], s34 offen sc1 lds
    s_sub_u32 s34, s34, 1024
    s_mov_b32 m0, s33
    s_sub_u32 s33, s33, 1024
    buffer_load_dwordx4 v45, s[8:11], s34 offen sc1 lds
    s_sub_u32 s34, s34, 1024
    s_mov_b32 m0, s33
    s_sub_u32 s33, s33, 1024
    buffer_load_dwordx4 v45, s[8:11], s34 offen sc1 lds
    s_sub_u32 s34, s34, 1024
    s_mov_b32 m0, s33
    s_sub_u32 s33, s33, 1024
    buffer_load_dwordx4 v45, s[8:11], s34 offen sc1 lds
    s_sub_u32 s34, s34, 1024
    s_mov_b32 m0, s33
    s_sub_u32 s33, s33, 1024
    buffer_load_dwordx4 v45, s[8:11], s34 offen sc1 lds
    s_sub_u32 s34, s34, 1024
    s_mov_b32 m0, s33
    s_sub_u32 s33, s33, 1024
    buffer_load_dwordx4 v45, s[8:11], s34 offen sc1 lds
    s_sub_u32 s34, s34, 1024
    s_mov_b32 m0, s33
    s_sub_u32 s33, s33, 1024
    buffer_load_dwordx4 v45, s[8:11], s34 offen sc1 lds
    s_sub_u32 s34, s34, 1024
    s_mov_b32 m0, s33
    s_sub_u32 s33, s33, 1024
    buffer_load_dwordx4 v45, s[8:11], s34 offen sc1 lds
    s_sub_u32 s34, s34, 1024
    s_waitcnt vmcnt(11)
    s_barrier
    s_mov_b32 s38, 34078720
    s_mov_b32 s39, 34308096
    ds_read_b128 v[224:227], v1 offset:13312
    ds_read_b128 v[228:231], v1 offset:27648
    ds_read_b128 v[232:235], v1 offset:41984
    ds_read_b128 v[236:239], v1 offset:56320
    ds_read_b128 v[220:223], v0 offset:13312
    s_waitcnt lgkmcnt(4)
    v_mfma_f32_16x16x32_bf16 v[48:51], a[52:55], v[224:227], 0
    s_waitcnt lgkmcnt(3)
    v_mfma_f32_16x16x32_bf16 v[76:79], a[52:55], v[228:231], 0
    s_waitcnt lgkmcnt(2)
    v_mfma_f32_16x16x32_bf16 v[104:107], a[52:55], v[232:235], 0
    s_waitcnt lgkmcnt(1)
    v_mfma_f32_16x16x32_bf16 v[132:135], a[52:55], v[236:239], 0
    ds_read_b128 v[240:243], v1 offset:12288
    s_waitcnt lgkmcnt(1)
    v_mfma_f32_16x16x32_bf16 v[52:55], v[220:223], v[224:227], 0
    v_mfma_f32_16x16x32_bf16 v[80:83], v[220:223], v[228:231], 0
    v_mfma_f32_16x16x32_bf16 v[108:111], v[220:223], v[232:235], 0
    v_mfma_f32_16x16x32_bf16 v[136:139], v[220:223], v[236:239], 0
    ds_read_b128 v[244:247], v1 offset:26624
    v_mfma_f32_16x16x32_bf16 v[56:59], v[196:199], v[224:227], 0
    v_mfma_f32_16x16x32_bf16 v[84:87], v[196:199], v[228:231], 0
    ds_read_b128 v[220:223], v0 offset:12288
    v_mfma_f32_16x16x32_bf16 v[112:115], v[196:199], v[232:235], 0
    v_mfma_f32_16x16x32_bf16 v[140:143], v[196:199], v[236:239], 0
    ds_read_b128 v[248:251], v1 offset:40960
    v_mfma_f32_16x16x32_bf16 v[60:63], v[200:203], v[224:227], 0
    v_mfma_f32_16x16x32_bf16 v[88:91], v[200:203], v[228:231], 0
    buffer_load_dwordx4 v[196:199], v13, s[8:11], s71 offen offset:2048
    v_mfma_f32_16x16x32_bf16 v[116:119], v[200:203], v[232:235], 0
    v_mfma_f32_16x16x32_bf16 v[144:147], v[200:203], v[236:239], 0
    ds_read_b128 v[252:255], v1 offset:55296
    v_mfma_f32_16x16x32_bf16 v[64:67], v[204:207], v[224:227], 0
    v_mfma_f32_16x16x32_bf16 v[92:95], v[204:207], v[228:231], 0
    buffer_load_dwordx4 v[200:203], v13, s[8:11], s70 offen offset:2048
    v_mfma_f32_16x16x32_bf16 v[120:123], v[204:207], v[232:235], 0
    v_mfma_f32_16x16x32_bf16 v[148:151], v[204:207], v[236:239], 0
    v_mfma_f32_16x16x32_bf16 v[68:71], v[208:211], v[224:227], 0
    v_mfma_f32_16x16x32_bf16 v[96:99], v[208:211], v[228:231], 0
    buffer_load_dwordx4 v[204:207], v13, s[8:11], s70 offen offset:3072
    v_mfma_f32_16x16x32_bf16 v[124:127], v[208:211], v[232:235], 0
    v_mfma_f32_16x16x32_bf16 v[152:155], v[208:211], v[236:239], 0
    v_mfma_f32_16x16x32_bf16 v[72:75], v[212:215], v[224:227], 0
    v_mfma_f32_16x16x32_bf16 v[100:103], v[212:215], v[228:231], 0
    buffer_load_dwordx4 v[208:211], v219, s[8:11], s70 offen offset:0
    v_mfma_f32_16x16x32_bf16 v[128:131], v[212:215], v[232:235], 0
    v_mfma_f32_16x16x32_bf16 v[156:159], v[212:215], v[236:239], 0
    s_waitcnt lgkmcnt(0)
    v_mfma_f32_16x16x32_bf16 v[48:51], a[48:51], v[240:243], v[48:51]
    v_mfma_f32_16x16x32_bf16 v[76:79], a[48:51], v[244:247], v[76:79]
    buffer_load_dwordx4 v[212:215], v219, s[8:11], s70 offen offset:1024
    v_mfma_f32_16x16x32_bf16 v[104:107], a[48:51], v[248:251], v[104:107]
    v_mfma_f32_16x16x32_bf16 v[132:135], a[48:51], v[252:255], v[132:135]
    ds_read_b128 v[224:227], v1 offset:11264
    v_mfma_f32_16x16x32_bf16 v[52:55], v[220:223], v[240:243], v[52:55]
    v_mfma_f32_16x16x32_bf16 v[80:83], v[220:223], v[244:247], v[80:83]
    v_mfma_f32_16x16x32_bf16 v[108:111], v[220:223], v[248:251], v[108:111]
    v_mfma_f32_16x16x32_bf16 v[136:139], v[220:223], v[252:255], v[136:139]
    ds_read_b128 v[228:231], v1 offset:25600
    v_mfma_f32_16x16x32_bf16 v[56:59], v[176:179], v[240:243], v[56:59]
    v_mfma_f32_16x16x32_bf16 v[84:87], v[176:179], v[244:247], v[84:87]
    ds_read_b128 v[220:223], v0 offset:11264
    v_mfma_f32_16x16x32_bf16 v[112:115], v[176:179], v[248:251], v[112:115]
    v_mfma_f32_16x16x32_bf16 v[140:143], v[176:179], v[252:255], v[140:143]
    ds_read_b128 v[232:235], v1 offset:39936
    v_mfma_f32_16x16x32_bf16 v[60:63], v[180:183], v[240:243], v[60:63]
    v_mfma_f32_16x16x32_bf16 v[88:91], v[180:183], v[244:247], v[88:91]
    buffer_load_dwordx4 v[176:179], v219, s[8:11], s70 offen offset:2048
    v_mfma_f32_16x16x32_bf16 v[116:119], v[180:183], v[248:251], v[116:119]
    v_mfma_f32_16x16x32_bf16 v[144:147], v[180:183], v[252:255], v[144:147]
    ds_read_b128 v[236:239], v1 offset:54272
    v_mfma_f32_16x16x32_bf16 v[64:67], v[184:187], v[240:243], v[64:67]
    v_mfma_f32_16x16x32_bf16 v[92:95], v[184:187], v[244:247], v[92:95]
    buffer_load_dwordx4 v[180:183], v13, s[8:11], s69 offen offset:2048
    v_mfma_f32_16x16x32_bf16 v[120:123], v[184:187], v[248:251], v[120:123]
    v_mfma_f32_16x16x32_bf16 v[148:151], v[184:187], v[252:255], v[148:151]
    v_mfma_f32_16x16x32_bf16 v[68:71], v[188:191], v[240:243], v[68:71]
    v_mfma_f32_16x16x32_bf16 v[96:99], v[188:191], v[244:247], v[96:99]
    buffer_load_dwordx4 v[184:187], v13, s[8:11], s69 offen offset:3072
    v_mfma_f32_16x16x32_bf16 v[124:127], v[188:191], v[248:251], v[124:127]
    v_mfma_f32_16x16x32_bf16 v[152:155], v[188:191], v[252:255], v[152:155]
    v_mfma_f32_16x16x32_bf16 v[72:75], v[192:195], v[240:243], v[72:75]
    v_mfma_f32_16x16x32_bf16 v[100:103], v[192:195], v[244:247], v[100:103]
    buffer_load_dwordx4 v[188:191], v219, s[8:11], s69 offen offset:0
    v_mfma_f32_16x16x32_bf16 v[128:131], v[192:195], v[248:251], v[128:131]
    v_mfma_f32_16x16x32_bf16 v[156:159], v[192:195], v[252:255], v[156:159]
    s_waitcnt lgkmcnt(0)
    v_mfma_f32_16x16x32_bf16 v[48:51], a[44:47], v[224:227], v[48:51]
    v_mfma_f32_16x16x32_bf16 v[76:79], a[44:47], v[228:231], v[76:79]
    buffer_load_dwordx4 v[192:195], v219, s[8:11], s69 offen offset:1024
    v_mfma_f32_16x16x32_bf16 v[104:107], a[44:47], v[232:235], v[104:107]
    s_waitcnt vmcnt(10)
    s_barrier
    v_mfma_f32_16x16x32_bf16 v[132:135], a[44:47], v[236:239], v[132:135]
    ds_read_b128 v[240:243], v1 offset:10240
    v_mfma_f32_16x16x32_bf16 v[52:55], v[220:223], v[224:227], v[52:55]
    v_mfma_f32_16x16x32_bf16 v[80:83], v[220:223], v[228:231], v[80:83]
    v_mfma_f32_16x16x32_bf16 v[108:111], v[220:223], v[232:235], v[108:111]
    v_mfma_f32_16x16x32_bf16 v[136:139], v[220:223], v[236:239], v[136:139]
    ds_read_b128 v[244:247], v1 offset:24576
    v_mfma_f32_16x16x32_bf16 v[60:63], v[160:163], v[224:227], v[60:63]
    v_mfma_f32_16x16x32_bf16 v[88:91], v[160:163], v[228:231], v[88:91]
    ds_read_b128 v[220:223], v0 offset:10240
    v_mfma_f32_16x16x32_bf16 v[116:119], v[160:163], v[232:235], v[116:119]
    v_mfma_f32_16x16x32_bf16 v[144:147], v[160:163], v[236:239], v[144:147]
    ds_read_b128 v[248:251], v1 offset:38912
    v_mfma_f32_16x16x32_bf16 v[64:67], v[164:167], v[224:227], v[64:67]
    v_mfma_f32_16x16x32_bf16 v[92:95], v[164:167], v[228:231], v[92:95]
    buffer_load_dwordx4 v[160:163], v219, s[8:11], s69 offen offset:2048
    v_mfma_f32_16x16x32_bf16 v[120:123], v[164:167], v[232:235], v[120:123]
    v_mfma_f32_16x16x32_bf16 v[148:151], v[164:167], v[236:239], v[148:151]
    ds_read_b128 v[252:255], v1 offset:53248
    v_mfma_f32_16x16x32_bf16 v[68:71], v[168:171], v[224:227], v[68:71]
    v_mfma_f32_16x16x32_bf16 v[96:99], v[168:171], v[228:231], v[96:99]
    buffer_load_dwordx4 v[164:167], v13, s[8:11], s68 offen offset:2048
    v_mfma_f32_16x16x32_bf16 v[124:127], v[168:171], v[232:235], v[124:127]
    v_mfma_f32_16x16x32_bf16 v[152:155], v[168:171], v[236:239], v[152:155]
    v_mfma_f32_16x16x32_bf16 v[72:75], v[172:175], v[224:227], v[72:75]
    v_mfma_f32_16x16x32_bf16 v[100:103], v[172:175], v[228:231], v[100:103]
    buffer_load_dwordx4 v[168:171], v13, s[8:11], s68 offen offset:3072
    v_mfma_f32_16x16x32_bf16 v[128:131], v[172:175], v[232:235], v[128:131]
    v_mfma_f32_16x16x32_bf16 v[156:159], v[172:175], v[236:239], v[156:159]
    s_waitcnt vmcnt(12)
    v_mfma_f32_16x16x32_bf16 v[56:59], v[196:199], v[224:227], v[56:59]
    v_mfma_f32_16x16x32_bf16 v[84:87], v[196:199], v[228:231], v[84:87]
    buffer_load_dwordx4 v[172:175], v219, s[8:11], s68 offen offset:0
    v_mfma_f32_16x16x32_bf16 v[112:115], v[196:199], v[232:235], v[112:115]
    v_mfma_f32_16x16x32_bf16 v[140:143], v[196:199], v[236:239], v[140:143]
    s_waitcnt lgkmcnt(0)
    v_mfma_f32_16x16x32_bf16 v[48:51], a[40:43], v[240:243], v[48:51]
    v_mfma_f32_16x16x32_bf16 v[76:79], a[40:43], v[244:247], v[76:79]
    buffer_load_dwordx4 v[196:199], v219, s[8:11], s68 offen offset:1024
    v_mfma_f32_16x16x32_bf16 v[104:107], a[40:43], v[248:251], v[104:107]
    v_mfma_f32_16x16x32_bf16 v[132:135], a[40:43], v[252:255], v[132:135]
    ds_read_b128 v[224:227], v1 offset:9216
    v_mfma_f32_16x16x32_bf16 v[52:55], v[220:223], v[240:243], v[52:55]
    v_mfma_f32_16x16x32_bf16 v[80:83], v[220:223], v[244:247], v[80:83]
    v_mfma_f32_16x16x32_bf16 v[108:111], v[220:223], v[248:251], v[108:111]
    v_mfma_f32_16x16x32_bf16 v[136:139], v[220:223], v[252:255], v[136:139]
    ds_read_b128 v[228:231], v1 offset:23552
    s_waitcnt vmcnt(12)
    v_mfma_f32_16x16x32_bf16 v[56:59], v[200:203], v[240:243], v[56:59]
    v_mfma_f32_16x16x32_bf16 v[84:87], v[200:203], v[244:247], v[84:87]
    ds_read_b128 v[220:223], v0 offset:9216
    v_mfma_f32_16x16x32_bf16 v[112:115], v[200:203], v[248:251], v[112:115]
    v_mfma_f32_16x16x32_bf16 v[140:143], v[200:203], v[252:255], v[140:143]
    ds_read_b128 v[232:235], v1 offset:37888
    v_mfma_f32_16x16x32_bf16 v[60:63], v[204:207], v[240:243], v[60:63]
    v_mfma_f32_16x16x32_bf16 v[88:91], v[204:207], v[244:247], v[88:91]
    buffer_load_dwordx4 v[200:203], v219, s[8:11], s68 offen offset:2048
    v_mfma_f32_16x16x32_bf16 v[116:119], v[204:207], v[248:251], v[116:119]
    v_mfma_f32_16x16x32_bf16 v[144:147], v[204:207], v[252:255], v[144:147]
    ds_read_b128 v[236:239], v1 offset:52224
    s_waitcnt vmcnt(11)
    v_mfma_f32_16x16x32_bf16 v[64:67], v[208:211], v[240:243], v[64:67]
    v_mfma_f32_16x16x32_bf16 v[92:95], v[208:211], v[244:247], v[92:95]
    buffer_load_dwordx4 v[204:207], v13, s[8:11], s67 offen offset:2048
    v_mfma_f32_16x16x32_bf16 v[120:123], v[208:211], v[248:251], v[120:123]
    v_mfma_f32_16x16x32_bf16 v[148:151], v[208:211], v[252:255], v[148:151]
    v_mfma_f32_16x16x32_bf16 v[68:71], v[212:215], v[240:243], v[68:71]
    v_mfma_f32_16x16x32_bf16 v[96:99], v[212:215], v[244:247], v[96:99]
    buffer_load_dwordx4 v[208:211], v13, s[8:11], s67 offen offset:3072
    v_mfma_f32_16x16x32_bf16 v[124:127], v[212:215], v[248:251], v[124:127]
    v_mfma_f32_16x16x32_bf16 v[152:155], v[212:215], v[252:255], v[152:155]
    s_waitcnt vmcnt(12)
    v_mfma_f32_16x16x32_bf16 v[72:75], v[176:179], v[240:243], v[72:75]
    v_mfma_f32_16x16x32_bf16 v[100:103], v[176:179], v[244:247], v[100:103]
    buffer_load_dwordx4 v[212:215], v219, s[8:11], s67 offen offset:0
    v_mfma_f32_16x16x32_bf16 v[128:131], v[176:179], v[248:251], v[128:131]
    v_mfma_f32_16x16x32_bf16 v[156:159], v[176:179], v[252:255], v[156:159]
    s_waitcnt lgkmcnt(0)
    v_mfma_f32_16x16x32_bf16 v[48:51], a[36:39], v[224:227], v[48:51]
    v_mfma_f32_16x16x32_bf16 v[76:79], a[36:39], v[228:231], v[76:79]
    buffer_load_dwordx4 v[176:179], v219, s[8:11], s67 offen offset:1024
    v_mfma_f32_16x16x32_bf16 v[104:107], a[36:39], v[232:235], v[104:107]
    v_mfma_f32_16x16x32_bf16 v[132:135], a[36:39], v[236:239], v[132:135]
    ds_read_b128 v[240:243], v1 offset:8192
    v_mfma_f32_16x16x32_bf16 v[52:55], v[220:223], v[224:227], v[52:55]
    v_mfma_f32_16x16x32_bf16 v[80:83], v[220:223], v[228:231], v[80:83]
    v_mfma_f32_16x16x32_bf16 v[108:111], v[220:223], v[232:235], v[108:111]
    v_mfma_f32_16x16x32_bf16 v[136:139], v[220:223], v[236:239], v[136:139]
    ds_read_b128 v[244:247], v1 offset:22528
    s_waitcnt vmcnt(12)
    v_mfma_f32_16x16x32_bf16 v[56:59], v[180:183], v[224:227], v[56:59]
    v_mfma_f32_16x16x32_bf16 v[84:87], v[180:183], v[228:231], v[84:87]
    ds_read_b128 v[220:223], v0 offset:8192
    v_mfma_f32_16x16x32_bf16 v[112:115], v[180:183], v[232:235], v[112:115]
    v_mfma_f32_16x16x32_bf16 v[140:143], v[180:183], v[236:239], v[140:143]
    ds_read_b128 v[248:251], v1 offset:36864
    v_mfma_f32_16x16x32_bf16 v[60:63], v[184:187], v[224:227], v[60:63]
    v_mfma_f32_16x16x32_bf16 v[88:91], v[184:187], v[228:231], v[88:91]
    buffer_load_dwordx4 v[180:183], v219, s[8:11], s67 offen offset:2048
    v_mfma_f32_16x16x32_bf16 v[116:119], v[184:187], v[232:235], v[116:119]
    v_mfma_f32_16x16x32_bf16 v[144:147], v[184:187], v[236:239], v[144:147]
    ds_read_b128 v[252:255], v1 offset:51200
    s_waitcnt vmcnt(11)
    v_mfma_f32_16x16x32_bf16 v[64:67], v[188:191], v[224:227], v[64:67]
    v_mfma_f32_16x16x32_bf16 v[92:95], v[188:191], v[228:231], v[92:95]
    buffer_load_dwordx4 v[184:187], v13, s[8:11], s66 offen offset:2048
    v_mfma_f32_16x16x32_bf16 v[120:123], v[188:191], v[232:235], v[120:123]
    v_mfma_f32_16x16x32_bf16 v[148:151], v[188:191], v[236:239], v[148:151]
    v_mfma_f32_16x16x32_bf16 v[68:71], v[192:195], v[224:227], v[68:71]
    v_mfma_f32_16x16x32_bf16 v[96:99], v[192:195], v[228:231], v[96:99]
    buffer_load_dwordx4 v[188:191], v13, s[8:11], s66 offen offset:3072
    v_mfma_f32_16x16x32_bf16 v[124:127], v[192:195], v[232:235], v[124:127]
    v_mfma_f32_16x16x32_bf16 v[152:155], v[192:195], v[236:239], v[152:155]
    s_waitcnt vmcnt(12)
    v_mfma_f32_16x16x32_bf16 v[72:75], v[160:163], v[224:227], v[72:75]
    v_mfma_f32_16x16x32_bf16 v[100:103], v[160:163], v[228:231], v[100:103]
    buffer_load_dwordx4 v[192:195], v219, s[8:11], s66 offen offset:0
    v_mfma_f32_16x16x32_bf16 v[128:131], v[160:163], v[232:235], v[128:131]
    v_mfma_f32_16x16x32_bf16 v[156:159], v[160:163], v[236:239], v[156:159]
    s_waitcnt lgkmcnt(0)
    v_mfma_f32_16x16x32_bf16 v[48:51], a[32:35], v[240:243], v[48:51]
    v_mfma_f32_16x16x32_bf16 v[76:79], a[32:35], v[244:247], v[76:79]
    buffer_load_dwordx4 v[160:163], v219, s[8:11], s66 offen offset:1024
    v_mfma_f32_16x16x32_bf16 v[104:107], a[32:35], v[248:251], v[104:107]
    v_mfma_f32_16x16x32_bf16 v[132:135], a[32:35], v[252:255], v[132:135]
    ds_read_b128 v[224:227], v1 offset:7168
    v_mfma_f32_16x16x32_bf16 v[52:55], v[220:223], v[240:243], v[52:55]
    v_mfma_f32_16x16x32_bf16 v[80:83], v[220:223], v[244:247], v[80:83]
    v_mfma_f32_16x16x32_bf16 v[108:111], v[220:223], v[248:251], v[108:111]
    v_mfma_f32_16x16x32_bf16 v[136:139], v[220:223], v[252:255], v[136:139]
    ds_read_b128 v[228:231], v1 offset:21504
    s_waitcnt vmcnt(12)
    v_mfma_f32_16x16x32_bf16 v[56:59], v[164:167], v[240:243], v[56:59]
    v_mfma_f32_16x16x32_bf16 v[84:87], v[164:167], v[244:247], v[84:87]
    ds_read_b128 v[220:223], v0 offset:7168
    v_mfma_f32_16x16x32_bf16 v[112:115], v[164:167], v[248:251], v[112:115]
    v_mfma_f32_16x16x32_bf16 v[140:143], v[164:167], v[252:255], v[140:143]
    ds_read_b128 v[232:235], v1 offset:35840
    v_mfma_f32_16x16x32_bf16 v[60:63], v[168:171], v[240:243], v[60:63]
    v_mfma_f32_16x16x32_bf16 v[88:91], v[168:171], v[244:247], v[88:91]
    buffer_load_dwordx4 v[164:167], v219, s[8:11], s66 offen offset:2048
    v_mfma_f32_16x16x32_bf16 v[116:119], v[168:171], v[248:251], v[116:119]
    v_mfma_f32_16x16x32_bf16 v[144:147], v[168:171], v[252:255], v[144:147]
    ds_read_b128 v[236:239], v1 offset:50176
    s_waitcnt vmcnt(11)
    v_mfma_f32_16x16x32_bf16 v[64:67], v[172:175], v[240:243], v[64:67]
    v_mfma_f32_16x16x32_bf16 v[92:95], v[172:175], v[244:247], v[92:95]
    buffer_load_dwordx4 v[168:171], v13, s[8:11], s65 offen offset:2048
    v_mfma_f32_16x16x32_bf16 v[120:123], v[172:175], v[248:251], v[120:123]
    v_mfma_f32_16x16x32_bf16 v[148:151], v[172:175], v[252:255], v[148:151]
    v_mfma_f32_16x16x32_bf16 v[68:71], v[196:199], v[240:243], v[68:71]
    v_mfma_f32_16x16x32_bf16 v[96:99], v[196:199], v[244:247], v[96:99]
    buffer_load_dwordx4 v[172:175], v13, s[8:11], s65 offen offset:3072
    v_mfma_f32_16x16x32_bf16 v[124:127], v[196:199], v[248:251], v[124:127]
    v_mfma_f32_16x16x32_bf16 v[152:155], v[196:199], v[252:255], v[152:155]
    s_waitcnt vmcnt(12)
    v_mfma_f32_16x16x32_bf16 v[72:75], v[200:203], v[240:243], v[72:75]
    v_mfma_f32_16x16x32_bf16 v[100:103], v[200:203], v[244:247], v[100:103]
    buffer_load_dwordx4 v[196:199], v219, s[8:11], s65 offen offset:0
    v_mfma_f32_16x16x32_bf16 v[128:131], v[200:203], v[248:251], v[128:131]
    v_mfma_f32_16x16x32_bf16 v[156:159], v[200:203], v[252:255], v[156:159]
    s_waitcnt lgkmcnt(0)
    v_mfma_f32_16x16x32_bf16 v[48:51], a[28:31], v[224:227], v[48:51]
    v_mfma_f32_16x16x32_bf16 v[76:79], a[28:31], v[228:231], v[76:79]
    buffer_load_dwordx4 v[200:203], v219, s[8:11], s65 offen offset:1024
    v_mfma_f32_16x16x32_bf16 v[104:107], a[28:31], v[232:235], v[104:107]
    v_mfma_f32_16x16x32_bf16 v[132:135], a[28:31], v[236:239], v[132:135]
    ds_read_b128 v[240:243], v1 offset:6144
    v_mfma_f32_16x16x32_bf16 v[52:55], v[220:223], v[224:227], v[52:55]
    v_mfma_f32_16x16x32_bf16 v[80:83], v[220:223], v[228:231], v[80:83]
    v_mfma_f32_16x16x32_bf16 v[108:111], v[220:223], v[232:235], v[108:111]
    v_mfma_f32_16x16x32_bf16 v[136:139], v[220:223], v[236:239], v[136:139]
    ds_read_b128 v[244:247], v1 offset:20480
    s_waitcnt vmcnt(12)
    v_mfma_f32_16x16x32_bf16 v[56:59], v[204:207], v[224:227], v[56:59]
    v_mfma_f32_16x16x32_bf16 v[84:87], v[204:207], v[228:231], v[84:87]
    ds_read_b128 v[220:223], v0 offset:6144
    v_mfma_f32_16x16x32_bf16 v[112:115], v[204:207], v[232:235], v[112:115]
    v_mfma_f32_16x16x32_bf16 v[140:143], v[204:207], v[236:239], v[140:143]
    ds_read_b128 v[248:251], v1 offset:34816
    v_mfma_f32_16x16x32_bf16 v[60:63], v[208:211], v[224:227], v[60:63]
    v_mfma_f32_16x16x32_bf16 v[88:91], v[208:211], v[228:231], v[88:91]
    buffer_load_dwordx4 v[204:207], v219, s[8:11], s65 offen offset:2048
    v_mfma_f32_16x16x32_bf16 v[116:119], v[208:211], v[232:235], v[116:119]
    v_mfma_f32_16x16x32_bf16 v[144:147], v[208:211], v[236:239], v[144:147]
    ds_read_b128 v[252:255], v1 offset:49152
    s_waitcnt vmcnt(11)
    v_mfma_f32_16x16x32_bf16 v[64:67], v[212:215], v[224:227], v[64:67]
    v_mfma_f32_16x16x32_bf16 v[92:95], v[212:215], v[228:231], v[92:95]
    buffer_load_dwordx4 v[208:211], v13, s[8:11], s64 offen offset:2048
    v_mfma_f32_16x16x32_bf16 v[120:123], v[212:215], v[232:235], v[120:123]
    v_mfma_f32_16x16x32_bf16 v[148:151], v[212:215], v[236:239], v[148:151]
    v_mfma_f32_16x16x32_bf16 v[68:71], v[176:179], v[224:227], v[68:71]
    v_mfma_f32_16x16x32_bf16 v[96:99], v[176:179], v[228:231], v[96:99]
    buffer_load_dwordx4 v[212:215], v13, s[8:11], s64 offen offset:3072
    v_mfma_f32_16x16x32_bf16 v[124:127], v[176:179], v[232:235], v[124:127]
    v_mfma_f32_16x16x32_bf16 v[152:155], v[176:179], v[236:239], v[152:155]
    s_waitcnt vmcnt(12)
    v_mfma_f32_16x16x32_bf16 v[72:75], v[180:183], v[224:227], v[72:75]
    v_mfma_f32_16x16x32_bf16 v[100:103], v[180:183], v[228:231], v[100:103]
    buffer_load_dwordx4 v[176:179], v219, s[8:11], s64 offen offset:0
    v_mfma_f32_16x16x32_bf16 v[128:131], v[180:183], v[232:235], v[128:131]
    v_mfma_f32_16x16x32_bf16 v[156:159], v[180:183], v[236:239], v[156:159]
    s_waitcnt lgkmcnt(0)
    v_mfma_f32_16x16x32_bf16 v[48:51], a[24:27], v[240:243], v[48:51]
    v_mfma_f32_16x16x32_bf16 v[76:79], a[24:27], v[244:247], v[76:79]
    buffer_load_dwordx4 v[180:183], v219, s[8:11], s64 offen offset:1024
    v_mfma_f32_16x16x32_bf16 v[104:107], a[24:27], v[248:251], v[104:107]
    v_mfma_f32_16x16x32_bf16 v[132:135], a[24:27], v[252:255], v[132:135]
    ds_read_b128 v[224:227], v1 offset:5120
    v_mfma_f32_16x16x32_bf16 v[52:55], v[220:223], v[240:243], v[52:55]
    v_mfma_f32_16x16x32_bf16 v[80:83], v[220:223], v[244:247], v[80:83]
    v_mfma_f32_16x16x32_bf16 v[108:111], v[220:223], v[248:251], v[108:111]
    v_mfma_f32_16x16x32_bf16 v[136:139], v[220:223], v[252:255], v[136:139]
    ds_read_b128 v[228:231], v1 offset:19456
    s_waitcnt vmcnt(12)
    v_mfma_f32_16x16x32_bf16 v[56:59], v[184:187], v[240:243], v[56:59]
    v_mfma_f32_16x16x32_bf16 v[84:87], v[184:187], v[244:247], v[84:87]
    ds_read_b128 v[220:223], v0 offset:5120
    v_mfma_f32_16x16x32_bf16 v[112:115], v[184:187], v[248:251], v[112:115]
    v_mfma_f32_16x16x32_bf16 v[140:143], v[184:187], v[252:255], v[140:143]
    ds_read_b128 v[232:235], v1 offset:33792
    v_mfma_f32_16x16x32_bf16 v[60:63], v[188:191], v[240:243], v[60:63]
    v_mfma_f32_16x16x32_bf16 v[88:91], v[188:191], v[244:247], v[88:91]
    buffer_load_dwordx4 v[184:187], v219, s[8:11], s64 offen offset:2048
    v_mfma_f32_16x16x32_bf16 v[116:119], v[188:191], v[248:251], v[116:119]
    v_mfma_f32_16x16x32_bf16 v[144:147], v[188:191], v[252:255], v[144:147]
    ds_read_b128 v[236:239], v1 offset:48128
    s_waitcnt vmcnt(11)
    v_mfma_f32_16x16x32_bf16 v[64:67], v[192:195], v[240:243], v[64:67]
    v_mfma_f32_16x16x32_bf16 v[92:95], v[192:195], v[244:247], v[92:95]
    buffer_load_dwordx4 v[188:191], v13, s[8:11], s63 offen offset:2048
    v_mfma_f32_16x16x32_bf16 v[120:123], v[192:195], v[248:251], v[120:123]
    v_mfma_f32_16x16x32_bf16 v[148:151], v[192:195], v[252:255], v[148:151]
    v_mfma_f32_16x16x32_bf16 v[68:71], v[160:163], v[240:243], v[68:71]
    v_mfma_f32_16x16x32_bf16 v[96:99], v[160:163], v[244:247], v[96:99]
    buffer_load_dwordx4 v[192:195], v13, s[8:11], s63 offen offset:3072
    v_mfma_f32_16x16x32_bf16 v[124:127], v[160:163], v[248:251], v[124:127]
    v_mfma_f32_16x16x32_bf16 v[152:155], v[160:163], v[252:255], v[152:155]
    s_waitcnt vmcnt(12)
    v_mfma_f32_16x16x32_bf16 v[72:75], v[164:167], v[240:243], v[72:75]
    v_mfma_f32_16x16x32_bf16 v[100:103], v[164:167], v[244:247], v[100:103]
    buffer_load_dwordx4 v[160:163], v219, s[8:11], s63 offen offset:0
    v_mfma_f32_16x16x32_bf16 v[128:131], v[164:167], v[248:251], v[128:131]
    v_mfma_f32_16x16x32_bf16 v[156:159], v[164:167], v[252:255], v[156:159]
    s_waitcnt lgkmcnt(0)
    v_mfma_f32_16x16x32_bf16 v[48:51], a[20:23], v[224:227], v[48:51]
    v_mfma_f32_16x16x32_bf16 v[76:79], a[20:23], v[228:231], v[76:79]
    buffer_load_dwordx4 v[164:167], v219, s[8:11], s63 offen offset:1024
    v_mfma_f32_16x16x32_bf16 v[104:107], a[20:23], v[232:235], v[104:107]
    v_mfma_f32_16x16x32_bf16 v[132:135], a[20:23], v[236:239], v[132:135]
    ds_read_b128 v[240:243], v1 offset:4096
    v_mfma_f32_16x16x32_bf16 v[52:55], v[220:223], v[224:227], v[52:55]
    v_mfma_f32_16x16x32_bf16 v[80:83], v[220:223], v[228:231], v[80:83]
    v_mfma_f32_16x16x32_bf16 v[108:111], v[220:223], v[232:235], v[108:111]
    v_mfma_f32_16x16x32_bf16 v[136:139], v[220:223], v[236:239], v[136:139]
    ds_read_b128 v[244:247], v1 offset:18432
    s_waitcnt vmcnt(12)
    v_mfma_f32_16x16x32_bf16 v[56:59], v[168:171], v[224:227], v[56:59]
    v_mfma_f32_16x16x32_bf16 v[84:87], v[168:171], v[228:231], v[84:87]
    ds_read_b128 v[220:223], v0 offset:4096
    v_mfma_f32_16x16x32_bf16 v[112:115], v[168:171], v[232:235], v[112:115]
    v_mfma_f32_16x16x32_bf16 v[140:143], v[168:171], v[236:239], v[140:143]
    ds_read_b128 v[248:251], v1 offset:32768
    v_mfma_f32_16x16x32_bf16 v[60:63], v[172:175], v[224:227], v[60:63]
    v_mfma_f32_16x16x32_bf16 v[88:91], v[172:175], v[228:231], v[88:91]
    buffer_load_dwordx4 v[168:171], v219, s[8:11], s63 offen offset:2048
    v_mfma_f32_16x16x32_bf16 v[116:119], v[172:175], v[232:235], v[116:119]
    v_mfma_f32_16x16x32_bf16 v[144:147], v[172:175], v[236:239], v[144:147]
    ds_read_b128 v[252:255], v1 offset:47104
    s_waitcnt vmcnt(11)
    v_mfma_f32_16x16x32_bf16 v[64:67], v[196:199], v[224:227], v[64:67]
    v_mfma_f32_16x16x32_bf16 v[92:95], v[196:199], v[228:231], v[92:95]
    buffer_load_dwordx4 v[172:175], v13, s[8:11], s62 offen offset:2048
    v_mfma_f32_16x16x32_bf16 v[120:123], v[196:199], v[232:235], v[120:123]
    v_mfma_f32_16x16x32_bf16 v[148:151], v[196:199], v[236:239], v[148:151]
    v_mfma_f32_16x16x32_bf16 v[68:71], v[200:203], v[224:227], v[68:71]
    v_mfma_f32_16x16x32_bf16 v[96:99], v[200:203], v[228:231], v[96:99]
    buffer_load_dwordx4 v[196:199], v13, s[8:11], s62 offen offset:3072
    v_mfma_f32_16x16x32_bf16 v[124:127], v[200:203], v[232:235], v[124:127]
    v_mfma_f32_16x16x32_bf16 v[152:155], v[200:203], v[236:239], v[152:155]
    s_waitcnt vmcnt(12)
    v_mfma_f32_16x16x32_bf16 v[72:75], v[204:207], v[224:227], v[72:75]
    v_mfma_f32_16x16x32_bf16 v[100:103], v[204:207], v[228:231], v[100:103]
    buffer_load_dwordx4 v[200:203], v219, s[8:11], s62 offen offset:0
    v_mfma_f32_16x16x32_bf16 v[128:131], v[204:207], v[232:235], v[128:131]
    v_mfma_f32_16x16x32_bf16 v[156:159], v[204:207], v[236:239], v[156:159]
    s_waitcnt lgkmcnt(0)
    v_mfma_f32_16x16x32_bf16 v[48:51], a[16:19], v[240:243], v[48:51]
    v_mfma_f32_16x16x32_bf16 v[76:79], a[16:19], v[244:247], v[76:79]
    buffer_load_dwordx4 v[204:207], v219, s[8:11], s62 offen offset:1024
    v_mfma_f32_16x16x32_bf16 v[104:107], a[16:19], v[248:251], v[104:107]
    v_mfma_f32_16x16x32_bf16 v[132:135], a[16:19], v[252:255], v[132:135]
    ds_read_b128 v[224:227], v1 offset:3072
    v_mfma_f32_16x16x32_bf16 v[52:55], v[220:223], v[240:243], v[52:55]
    v_mfma_f32_16x16x32_bf16 v[80:83], v[220:223], v[244:247], v[80:83]
    v_mfma_f32_16x16x32_bf16 v[108:111], v[220:223], v[248:251], v[108:111]
    v_mfma_f32_16x16x32_bf16 v[136:139], v[220:223], v[252:255], v[136:139]
    ds_read_b128 v[228:231], v1 offset:17408
    s_waitcnt vmcnt(12)
    v_mfma_f32_16x16x32_bf16 v[56:59], v[208:211], v[240:243], v[56:59]
    v_mfma_f32_16x16x32_bf16 v[84:87], v[208:211], v[244:247], v[84:87]
    ds_read_b128 v[220:223], v0 offset:3072
    v_mfma_f32_16x16x32_bf16 v[112:115], v[208:211], v[248:251], v[112:115]
    v_mfma_f32_16x16x32_bf16 v[140:143], v[208:211], v[252:255], v[140:143]
    ds_read_b128 v[232:235], v1 offset:31744
    v_mfma_f32_16x16x32_bf16 v[60:63], v[212:215], v[240:243], v[60:63]
    v_mfma_f32_16x16x32_bf16 v[88:91], v[212:215], v[244:247], v[88:91]
    buffer_load_dwordx4 v[208:211], v219, s[8:11], s62 offen offset:2048
    v_mfma_f32_16x16x32_bf16 v[116:119], v[212:215], v[248:251], v[116:119]
    v_mfma_f32_16x16x32_bf16 v[144:147], v[212:215], v[252:255], v[144:147]
    ds_read_b128 v[236:239], v1 offset:46080
    s_waitcnt vmcnt(11)
    v_mfma_f32_16x16x32_bf16 v[64:67], v[176:179], v[240:243], v[64:67]
    v_mfma_f32_16x16x32_bf16 v[92:95], v[176:179], v[244:247], v[92:95]
    buffer_load_dwordx4 v[212:215], v13, s[8:11], s61 offen offset:2048
    v_mfma_f32_16x16x32_bf16 v[120:123], v[176:179], v[248:251], v[120:123]
    v_mfma_f32_16x16x32_bf16 v[148:151], v[176:179], v[252:255], v[148:151]
    v_mfma_f32_16x16x32_bf16 v[68:71], v[180:183], v[240:243], v[68:71]
    v_mfma_f32_16x16x32_bf16 v[96:99], v[180:183], v[244:247], v[96:99]
    buffer_load_dwordx4 v[176:179], v13, s[8:11], s61 offen offset:3072
    v_mfma_f32_16x16x32_bf16 v[124:127], v[180:183], v[248:251], v[124:127]
    v_mfma_f32_16x16x32_bf16 v[152:155], v[180:183], v[252:255], v[152:155]
    s_waitcnt vmcnt(12)
    v_mfma_f32_16x16x32_bf16 v[72:75], v[184:187], v[240:243], v[72:75]
    v_mfma_f32_16x16x32_bf16 v[100:103], v[184:187], v[244:247], v[100:103]
    buffer_load_dwordx4 v[180:183], v219, s[8:11], s61 offen offset:0
    v_mfma_f32_16x16x32_bf16 v[128:131], v[184:187], v[248:251], v[128:131]
    v_mfma_f32_16x16x32_bf16 v[156:159], v[184:187], v[252:255], v[156:159]
    s_waitcnt lgkmcnt(0)
    v_mfma_f32_16x16x32_bf16 v[48:51], a[12:15], v[224:227], v[48:51]
    v_mfma_f32_16x16x32_bf16 v[76:79], a[12:15], v[228:231], v[76:79]
    buffer_load_dwordx4 v[184:187], v219, s[8:11], s61 offen offset:1024
    v_mfma_f32_16x16x32_bf16 v[104:107], a[12:15], v[232:235], v[104:107]
    v_mfma_f32_16x16x32_bf16 v[132:135], a[12:15], v[236:239], v[132:135]
    ds_read_b128 v[240:243], v1 offset:2048
    v_mfma_f32_16x16x32_bf16 v[52:55], v[220:223], v[224:227], v[52:55]
    v_mfma_f32_16x16x32_bf16 v[80:83], v[220:223], v[228:231], v[80:83]
    v_mfma_f32_16x16x32_bf16 v[108:111], v[220:223], v[232:235], v[108:111]
    v_mfma_f32_16x16x32_bf16 v[136:139], v[220:223], v[236:239], v[136:139]
    ds_read_b128 v[244:247], v1 offset:16384
    s_waitcnt vmcnt(12)
    v_mfma_f32_16x16x32_bf16 v[56:59], v[188:191], v[224:227], v[56:59]
    v_mfma_f32_16x16x32_bf16 v[84:87], v[188:191], v[228:231], v[84:87]
    ds_read_b128 v[220:223], v0 offset:2048
    v_mfma_f32_16x16x32_bf16 v[112:115], v[188:191], v[232:235], v[112:115]
    v_mfma_f32_16x16x32_bf16 v[140:143], v[188:191], v[236:239], v[140:143]
    ds_read_b128 v[248:251], v1 offset:30720
    v_mfma_f32_16x16x32_bf16 v[60:63], v[192:195], v[224:227], v[60:63]
    v_mfma_f32_16x16x32_bf16 v[88:91], v[192:195], v[228:231], v[88:91]
    buffer_load_dwordx4 v[188:191], v219, s[8:11], s61 offen offset:2048
    v_mfma_f32_16x16x32_bf16 v[116:119], v[192:195], v[232:235], v[116:119]
    v_mfma_f32_16x16x32_bf16 v[144:147], v[192:195], v[236:239], v[144:147]
    ds_read_b128 v[252:255], v1 offset:45056
    s_waitcnt vmcnt(11)
    v_mfma_f32_16x16x32_bf16 v[64:67], v[160:163], v[224:227], v[64:67]
    v_mfma_f32_16x16x32_bf16 v[92:95], v[160:163], v[228:231], v[92:95]
    buffer_load_dwordx4 v[192:195], v13, s[8:11], s60 offen offset:2048
    v_mfma_f32_16x16x32_bf16 v[120:123], v[160:163], v[232:235], v[120:123]
    v_mfma_f32_16x16x32_bf16 v[148:151], v[160:163], v[236:239], v[148:151]
    v_mfma_f32_16x16x32_bf16 v[68:71], v[164:167], v[224:227], v[68:71]
    v_mfma_f32_16x16x32_bf16 v[96:99], v[164:167], v[228:231], v[96:99]
    buffer_load_dwordx4 v[160:163], v13, s[8:11], s60 offen offset:3072
    v_mfma_f32_16x16x32_bf16 v[124:127], v[164:167], v[232:235], v[124:127]
    v_mfma_f32_16x16x32_bf16 v[152:155], v[164:167], v[236:239], v[152:155]
    s_waitcnt vmcnt(12)
    v_mfma_f32_16x16x32_bf16 v[72:75], v[168:171], v[224:227], v[72:75]
    v_mfma_f32_16x16x32_bf16 v[100:103], v[168:171], v[228:231], v[100:103]
    buffer_load_dwordx4 v[164:167], v219, s[8:11], s60 offen offset:0
    v_mfma_f32_16x16x32_bf16 v[128:131], v[168:171], v[232:235], v[128:131]
    v_mfma_f32_16x16x32_bf16 v[156:159], v[168:171], v[236:239], v[156:159]
    s_waitcnt lgkmcnt(0)
    v_mfma_f32_16x16x32_bf16 v[48:51], a[8:11], v[240:243], v[48:51]
    v_mfma_f32_16x16x32_bf16 v[76:79], a[8:11], v[244:247], v[76:79]
    buffer_load_dwordx4 v[168:171], v219, s[8:11], s60 offen offset:1024
    v_mfma_f32_16x16x32_bf16 v[104:107], a[8:11], v[248:251], v[104:107]
    v_mfma_f32_16x16x32_bf16 v[132:135], a[8:11], v[252:255], v[132:135]
    ds_read_b128 v[224:227], v1 offset:1024
    v_mfma_f32_16x16x32_bf16 v[52:55], v[220:223], v[240:243], v[52:55]
    v_mfma_f32_16x16x32_bf16 v[80:83], v[220:223], v[244:247], v[80:83]
    v_mfma_f32_16x16x32_bf16 v[108:111], v[220:223], v[248:251], v[108:111]
    v_mfma_f32_16x16x32_bf16 v[136:139], v[220:223], v[252:255], v[136:139]
    ds_read_b128 v[228:231], v1 offset:15360
    s_waitcnt vmcnt(12)
    v_mfma_f32_16x16x32_bf16 v[56:59], v[172:175], v[240:243], v[56:59]
    v_mfma_f32_16x16x32_bf16 v[84:87], v[172:175], v[244:247], v[84:87]
    ds_read_b128 v[220:223], v0 offset:1024
    v_mfma_f32_16x16x32_bf16 v[112:115], v[172:175], v[248:251], v[112:115]
    v_mfma_f32_16x16x32_bf16 v[140:143], v[172:175], v[252:255], v[140:143]
    ds_read_b128 v[232:235], v1 offset:29696
    v_mfma_f32_16x16x32_bf16 v[60:63], v[196:199], v[240:243], v[60:63]
    v_mfma_f32_16x16x32_bf16 v[88:91], v[196:199], v[244:247], v[88:91]
    buffer_load_dwordx4 v[172:175], v219, s[8:11], s60 offen offset:2048
    v_mfma_f32_16x16x32_bf16 v[116:119], v[196:199], v[248:251], v[116:119]
    v_mfma_f32_16x16x32_bf16 v[144:147], v[196:199], v[252:255], v[144:147]
    ds_read_b128 v[236:239], v1 offset:44032
    s_waitcnt vmcnt(11)
    v_mfma_f32_16x16x32_bf16 v[64:67], v[200:203], v[240:243], v[64:67]
    v_mfma_f32_16x16x32_bf16 v[92:95], v[200:203], v[244:247], v[92:95]
    v_mfma_f32_16x16x32_bf16 v[120:123], v[200:203], v[248:251], v[120:123]
    v_mfma_f32_16x16x32_bf16 v[148:151], v[200:203], v[252:255], v[148:151]
    v_mfma_f32_16x16x32_bf16 v[68:71], v[204:207], v[240:243], v[68:71]
    v_mfma_f32_16x16x32_bf16 v[96:99], v[204:207], v[244:247], v[96:99]
    v_mfma_f32_16x16x32_bf16 v[124:127], v[204:207], v[248:251], v[124:127]
    v_mfma_f32_16x16x32_bf16 v[152:155], v[204:207], v[252:255], v[152:155]
    s_waitcnt vmcnt(10)
    v_mfma_f32_16x16x32_bf16 v[72:75], v[208:211], v[240:243], v[72:75]
    v_mfma_f32_16x16x32_bf16 v[100:103], v[208:211], v[244:247], v[100:103]
    v_mfma_f32_16x16x32_bf16 v[128:131], v[208:211], v[248:251], v[128:131]
    v_mfma_f32_16x16x32_bf16 v[156:159], v[208:211], v[252:255], v[156:159]
    s_waitcnt lgkmcnt(0)
    v_mfma_f32_16x16x32_bf16 v[48:51], a[4:7], v[224:227], v[48:51]
    v_mfma_f32_16x16x32_bf16 v[76:79], a[4:7], v[228:231], v[76:79]
    v_mfma_f32_16x16x32_bf16 v[104:107], a[4:7], v[232:235], v[104:107]
    v_mfma_f32_16x16x32_bf16 v[132:135], a[4:7], v[236:239], v[132:135]
    ds_read_b128 v[240:243], v1 offset:0
    v_mfma_f32_16x16x32_bf16 v[52:55], v[220:223], v[224:227], v[52:55]
    v_mfma_f32_16x16x32_bf16 v[80:83], v[220:223], v[228:231], v[80:83]
    v_mfma_f32_16x16x32_bf16 v[108:111], v[220:223], v[232:235], v[108:111]
    v_mfma_f32_16x16x32_bf16 v[136:139], v[220:223], v[236:239], v[136:139]
    ds_read_b128 v[244:247], v1 offset:14336
    s_waitcnt vmcnt(8)
    v_mfma_f32_16x16x32_bf16 v[56:59], v[212:215], v[224:227], v[56:59]
    v_mfma_f32_16x16x32_bf16 v[84:87], v[212:215], v[228:231], v[84:87]
    ds_read_b128 v[220:223], v0 offset:0
    v_mfma_f32_16x16x32_bf16 v[112:115], v[212:215], v[232:235], v[112:115]
    v_mfma_f32_16x16x32_bf16 v[140:143], v[212:215], v[236:239], v[140:143]
    ds_read_b128 v[248:251], v1 offset:28672
    v_mfma_f32_16x16x32_bf16 v[60:63], v[176:179], v[224:227], v[60:63]
    v_mfma_f32_16x16x32_bf16 v[88:91], v[176:179], v[228:231], v[88:91]
    v_mfma_f32_16x16x32_bf16 v[116:119], v[176:179], v[232:235], v[116:119]
    v_mfma_f32_16x16x32_bf16 v[144:147], v[176:179], v[236:239], v[144:147]
    ds_read_b128 v[252:255], v1 offset:43008
    s_waitcnt vmcnt(6)
    v_mfma_f32_16x16x32_bf16 v[64:67], v[180:183], v[224:227], v[64:67]
    v_mfma_f32_16x16x32_bf16 v[92:95], v[180:183], v[228:231], v[92:95]
    v_mfma_f32_16x16x32_bf16 v[120:123], v[180:183], v[232:235], v[120:123]
    v_mfma_f32_16x16x32_bf16 v[148:151], v[180:183], v[236:239], v[148:151]
    v_mfma_f32_16x16x32_bf16 v[68:71], v[184:187], v[224:227], v[68:71]
    v_mfma_f32_16x16x32_bf16 v[96:99], v[184:187], v[228:231], v[96:99]
    v_mfma_f32_16x16x32_bf16 v[124:127], v[184:187], v[232:235], v[124:127]
    v_mfma_f32_16x16x32_bf16 v[152:155], v[184:187], v[236:239], v[152:155]
    s_waitcnt vmcnt(5)
    v_mfma_f32_16x16x32_bf16 v[72:75], v[188:191], v[224:227], v[72:75]
    v_mfma_f32_16x16x32_bf16 v[100:103], v[188:191], v[228:231], v[100:103]
    v_mfma_f32_16x16x32_bf16 v[128:131], v[188:191], v[232:235], v[128:131]
    v_mfma_f32_16x16x32_bf16 v[156:159], v[188:191], v[236:239], v[156:159]
    s_waitcnt lgkmcnt(4)
    v_mfma_f32_16x16x32_bf16 v[48:51], a[0:3], v[240:243], v[48:51]
    s_waitcnt lgkmcnt(2)
    v_mfma_f32_16x16x32_bf16 v[52:55], v[220:223], v[240:243], v[52:55]
    s_waitcnt vmcnt(4)
    v_mfma_f32_16x16x32_bf16 v[56:59], v[192:195], v[240:243], v[56:59]
    s_waitcnt vmcnt(3)
    v_mfma_f32_16x16x32_bf16 v[60:63], v[160:163], v[240:243], v[60:63]
    s_waitcnt vmcnt(2)
    v_mfma_f32_16x16x32_bf16 v[64:67], v[164:167], v[240:243], v[64:67]
    s_waitcnt vmcnt(1)
    v_mfma_f32_16x16x32_bf16 v[68:71], v[168:171], v[240:243], v[68:71]
    s_waitcnt vmcnt(0)
    v_mfma_f32_16x16x32_bf16 v[72:75], v[172:175], v[240:243], v[72:75]
    v_mfma_f32_16x16x32_bf16 v[76:79], a[0:3], v[244:247], v[76:79]
    v_mfma_f32_16x16x32_bf16 v[80:83], v[220:223], v[244:247], v[80:83]
    v_mul_f32 v48, v48, v52
    v_mul_f32 v49, v49, v53
    v_mfma_f32_16x16x32_bf16 v[84:87], v[192:195], v[244:247], v[84:87]
    v_mul_f32 v50, v50, v54
    v_mul_f32 v51, v51, v55
    v_cvt_pk_bf16_f32 v240, v48, v49
    v_mfma_f32_16x16x32_bf16 v[88:91], v[160:163], v[244:247], v[88:91]
    v_cvt_pk_bf16_f32 v241, v50, v51
    v_mul_f32 v56, v56, v60
    v_mul_f32 v57, v57, v61
    v_mfma_f32_16x16x32_bf16 v[92:95], v[164:167], v[244:247], v[92:95]
    v_mul_f32 v58, v58, v62
    v_mul_f32 v59, v59, v63
    v_mfma_f32_16x16x32_bf16 v[96:99], v[168:171], v[244:247], v[96:99]
    v_cvt_pk_bf16_f32 v242, v56, v57
    v_cvt_pk_bf16_f32 v243, v58, v59
    ds_write_b128 v6, v[240:243] offset:0
    v_mfma_f32_16x16x32_bf16 v[100:103], v[172:175], v[244:247], v[100:103]
    v_mul_f32 v64, v64, v68
    v_mul_f32 v65, v65, v69
    v_mul_f32 v66, v66, v70
    s_waitcnt lgkmcnt(2)
    v_mfma_f32_16x16x32_bf16 v[104:107], a[0:3], v[248:251], v[104:107]
    v_mul_f32 v67, v67, v71
    v_cvt_pk_bf16_f32 v64, v64, v65
    v_mfma_f32_16x16x32_bf16 v[108:111], v[220:223], v[248:251], v[108:111]
    v_cvt_pk_bf16_f32 v65, v66, v67
    v_permlane32_swap_b32 v72, v74
    v_permlane32_swap_b32 v73, v75
    v_mfma_f32_16x16x32_bf16 v[112:115], v[192:195], v[248:251], v[112:115]
    v_mul_f32 v72, v72, v74
    v_mul_f32 v73, v73, v75
    v_cvt_pk_bf16_f32 v66, v72, v73
    v_mfma_f32_16x16x32_bf16 v[116:119], v[160:163], v[248:251], v[116:119]
    ds_write_b64 v7, v[64:65] offset:0
    ds_write_b32 v8, v66 offset:0
    v_mul_f32 v76, v76, v80
    v_mfma_f32_16x16x32_bf16 v[120:123], v[164:167], v[248:251], v[120:123]
    v_mul_f32 v77, v77, v81
    v_mul_f32 v78, v78, v82
    v_mfma_f32_16x16x32_bf16 v[124:127], v[168:171], v[248:251], v[124:127]
    v_mul_f32 v79, v79, v83
    v_cvt_pk_bf16_f32 v244, v76, v77
    v_cvt_pk_bf16_f32 v245, v78, v79
    v_mfma_f32_16x16x32_bf16 v[128:131], v[172:175], v[248:251], v[128:131]
    v_mul_f32 v84, v84, v88
    v_mul_f32 v85, v85, v89
    v_mul_f32 v86, v86, v90
    s_waitcnt lgkmcnt(3)
    v_mfma_f32_16x16x32_bf16 v[132:135], a[0:3], v[252:255], v[132:135]
    v_mul_f32 v87, v87, v91
    v_cvt_pk_bf16_f32 v246, v84, v85
    v_mfma_f32_16x16x32_bf16 v[136:139], v[220:223], v[252:255], v[136:139]
    v_cvt_pk_bf16_f32 v247, v86, v87
    ds_write_b128 v6, v[244:247] offset:7168
    v_mul_f32 v92, v92, v96
    v_mfma_f32_16x16x32_bf16 v[140:143], v[192:195], v[252:255], v[140:143]
    v_mul_f32 v93, v93, v97
    v_mul_f32 v94, v94, v98
    v_mul_f32 v95, v95, v99
    v_mfma_f32_16x16x32_bf16 v[144:147], v[160:163], v[252:255], v[144:147]
    v_cvt_pk_bf16_f32 v92, v92, v93
    v_cvt_pk_bf16_f32 v93, v94, v95
    v_mfma_f32_16x16x32_bf16 v[148:151], v[164:167], v[252:255], v[148:151]
    v_permlane32_swap_b32 v100, v102
    v_permlane32_swap_b32 v101, v103
    v_mul_f32 v100, v100, v102
    v_mfma_f32_16x16x32_bf16 v[152:155], v[168:171], v[252:255], v[152:155]
    v_mul_f32 v101, v101, v103
    v_cvt_pk_bf16_f32 v94, v100, v101
    ds_write_b64 v7, v[92:93] offset:7168
    v_mfma_f32_16x16x32_bf16 v[156:159], v[172:175], v[252:255], v[156:159]
    ds_write_b32 v8, v94 offset:7168
    v_mul_f32 v104, v104, v108
    v_mul_f32 v105, v105, v109
    v_mfma_f32_16x16x32_bf16 v[48:51], a[56:59], v[240:243], 0
    v_mul_f32 v106, v106, v110
    v_mul_f32 v107, v107, v111
    v_mfma_f32_16x16x32_bf16 v[52:55], a[60:63], v[240:243], 0
    v_cvt_pk_bf16_f32 v248, v104, v105
    v_cvt_pk_bf16_f32 v249, v106, v107
    v_mul_f32 v112, v112, v116
    v_mfma_f32_16x16x32_bf16 v[56:59], a[64:67], v[240:243], 0
    v_mul_f32 v113, v113, v117
    v_mul_f32 v114, v114, v118
    v_mul_f32 v115, v115, v119
    v_mfma_f32_16x16x32_bf16 v[60:63], a[68:71], v[240:243], 0
    v_cvt_pk_bf16_f32 v250, v112, v113
    v_cvt_pk_bf16_f32 v251, v114, v115
    v_mfma_f32_16x16x32_bf16 v[64:67], a[72:75], v[240:243], 0
    ds_write_b128 v6, v[248:251] offset:14336
    v_mul_f32 v120, v120, v124
    v_mul_f32 v121, v121, v125
    v_mfma_f32_16x16x32_bf16 v[68:71], a[76:79], v[240:243], 0
    v_mul_f32 v122, v122, v126
    v_mul_f32 v123, v123, v127
    v_cvt_pk_bf16_f32 v120, v120, v121
    v_mfma_f32_16x16x32_bf16 v[72:75], a[80:83], v[240:243], 0
    v_cvt_pk_bf16_f32 v121, v122, v123
    v_permlane32_swap_b32 v128, v130
    v_mfma_f32_16x16x32_bf16 v[76:79], a[56:59], v[244:247], 0
    v_permlane32_swap_b32 v129, v131
    v_mul_f32 v128, v128, v130
    v_mul_f32 v129, v129, v131
    v_mfma_f32_16x16x32_bf16 v[80:83], a[60:63], v[244:247], 0
    v_cvt_pk_bf16_f32 v122, v128, v129
    ds_write_b64 v7, v[120:121] offset:14336
    ds_write_b32 v8, v122 offset:14336
    v_mfma_f32_16x16x32_bf16 v[84:87], a[64:67], v[244:247], 0
    v_mul_f32 v132, v132, v136
    v_mul_f32 v133, v133, v137
    v_mul_f32 v134, v134, v138
    v_mfma_f32_16x16x32_bf16 v[88:91], a[68:71], v[244:247], 0
    v_mul_f32 v135, v135, v139
    v_cvt_pk_bf16_f32 v252, v132, v133
    v_mfma_f32_16x16x32_bf16 v[92:95], a[72:75], v[244:247], 0
    v_cvt_pk_bf16_f32 v253, v134, v135
    v_mul_f32 v140, v140, v144
    v_mul_f32 v141, v141, v145
    v_mfma_f32_16x16x32_bf16 v[96:99], a[76:79], v[244:247], 0
    v_mul_f32 v142, v142, v146
    v_mul_f32 v143, v143, v147
    v_cvt_pk_bf16_f32 v254, v140, v141
    v_mfma_f32_16x16x32_bf16 v[100:103], a[80:83], v[244:247], 0
    v_cvt_pk_bf16_f32 v255, v142, v143
    ds_write_b128 v6, v[252:255] offset:21504
    v_mfma_f32_16x16x32_bf16 v[104:107], a[56:59], v[248:251], 0
    v_mul_f32 v148, v148, v152
    v_mul_f32 v149, v149, v153
    v_mul_f32 v150, v150, v154
    v_mfma_f32_16x16x32_bf16 v[108:111], a[60:63], v[248:251], 0
    v_mul_f32 v151, v151, v155
    v_cvt_pk_bf16_f32 v148, v148, v149
    v_cvt_pk_bf16_f32 v149, v150, v151
    v_mfma_f32_16x16x32_bf16 v[112:115], a[64:67], v[248:251], 0
    v_permlane32_swap_b32 v156, v158
    v_permlane32_swap_b32 v157, v159
    v_mfma_f32_16x16x32_bf16 v[116:119], a[68:71], v[248:251], 0
    v_mul_f32 v156, v156, v158
    v_mul_f32 v157, v157, v159
    v_cvt_pk_bf16_f32 v150, v156, v157
    v_mfma_f32_16x16x32_bf16 v[120:123], a[72:75], v[248:251], 0
    ds_write_b64 v7, v[148:149] offset:21504
    ds_write_b32 v8, v150 offset:21504
    v_mfma_f32_16x16x32_bf16 v[124:127], a[76:79], v[248:251], 0
    v_mfma_f32_16x16x32_bf16 v[128:131], a[80:83], v[248:251], 0
    s_waitcnt lgkmcnt(0)
    s_barrier
    v_mfma_f32_16x16x32_bf16 v[132:135], a[56:59], v[252:255], 0
    ds_read_b128 v[224:227], v3 offset:0
    v_mfma_f32_16x16x32_bf16 v[136:139], a[60:63], v[252:255], 0
    ds_read_b128 v[228:231], v3 offset:7168
    v_mfma_f32_16x16x32_bf16 v[140:143], a[64:67], v[252:255], 0
    ds_read_b128 v[232:235], v3 offset:14336
    v_mfma_f32_16x16x32_bf16 v[144:147], a[68:71], v[252:255], 0
    ds_read_b128 v[236:239], v3 offset:21504
    v_mfma_f32_16x16x32_bf16 v[148:151], a[72:75], v[252:255], 0
    v_mfma_f32_16x16x32_bf16 v[152:155], a[76:79], v[252:255], 0
    v_mfma_f32_16x16x32_bf16 v[156:159], a[80:83], v[252:255], 0
    s_waitcnt lgkmcnt(3)
    v_mfma_f32_16x16x32_bf16 v[48:51], a[84:87], v[224:227], v[48:51]
    ds_read_b128 v[240:243], v4 offset:0
    s_waitcnt lgkmcnt(3)
    v_mfma_f32_16x16x32_bf16 v[76:79], a[84:87], v[228:231], v[76:79]
    ds_read_b128 v[244:247], v4 offset:7168
    s_waitcnt lgkmcnt(3)
    v_mfma_f32_16x16x32_bf16 v[104:107], a[84:87], v[232:235], v[104:107]
    ds_read_b128 v[248:251], v4 offset:14336
    s_waitcnt lgkmcnt(3)
    v_mfma_f32_16x16x32_bf16 v[132:135], a[84:87], v[236:239], v[132:135]
    ds_read_b128 v[252:255], v4 offset:21504
    v_mfma_f32_16x16x32_bf16 v[52:55], a[88:91], v[224:227], v[52:55]
    s_mul_i32 s26, s22, 1792
    s_add_u32 s26, s26, 146944
    v_mfma_f32_16x16x32_bf16 v[80:83], a[88:91], v[228:231], v[80:83]
    v_and_b32 v220, 48, v1
    v_mfma_f32_16x16x32_bf16 v[108:111], a[88:91], v[232:235], v[108:111]
    v_lshrrev_b32 v221, 8, v1
    v_mfma_f32_16x16x32_bf16 v[136:139], a[88:91], v[236:239], v[136:139]
    v_lshl_add_u32 v220, v221, 6, v220
    v_mfma_f32_16x16x32_bf16 v[56:59], a[92:95], v[224:227], v[56:59]
    v_add_u32 v220, s26, v220
    v_mfma_f32_16x16x32_bf16 v[84:87], a[92:95], v[228:231], v[84:87]
    v_mfma_f32_16x16x32_bf16 v[112:115], a[92:95], v[232:235], v[112:115]
    v_mfma_f32_16x16x32_bf16 v[140:143], a[92:95], v[236:239], v[140:143]
    s_waitcnt lgkmcnt(0)
    v_mfma_f32_16x16x32_bf16 v[48:51], a[96:99], v[240:243], v[48:51]
    ds_read_b128 v[224:227], v5 offset:0
    v_mfma_f32_16x16x32_bf16 v[76:79], a[96:99], v[244:247], v[76:79]
    ds_read_b128 v[228:231], v5 offset:7168
    v_mfma_f32_16x16x32_bf16 v[104:107], a[96:99], v[248:251], v[104:107]
    ds_read_b128 v[232:235], v5 offset:14336
    v_mfma_f32_16x16x32_bf16 v[132:135], a[96:99], v[252:255], v[132:135]
    ds_read_b128 v[236:239], v5 offset:21504
    v_mfma_f32_16x16x32_bf16 v[52:55], a[100:103], v[240:243], v[52:55]
    v_mfma_f32_16x16x32_bf16 v[80:83], a[100:103], v[244:247], v[80:83]
    v_mfma_f32_16x16x32_bf16 v[108:111], a[100:103], v[248:251], v[108:111]
    v_mfma_f32_16x16x32_bf16 v[136:139], a[100:103], v[252:255], v[136:139]
    v_mfma_f32_16x16x32_bf16 v[56:59], a[104:107], v[240:243], v[56:59]
    v_mfma_f32_16x16x32_bf16 v[84:87], a[104:107], v[244:247], v[84:87]
    v_mfma_f32_16x16x32_bf16 v[112:115], a[104:107], v[248:251], v[112:115]
    v_mfma_f32_16x16x32_bf16 v[140:143], a[104:107], v[252:255], v[140:143]
    s_waitcnt lgkmcnt(0)
    v_mfma_f32_16x16x32_bf16 v[48:51], a[108:111], v[224:227], v[48:51]
    ds_read_b128 v[240:243], v2 offset:4096
    v_mfma_f32_16x16x32_bf16 v[76:79], a[108:111], v[228:231], v[76:79]
    ds_read_b128 v[244:247], v2 offset:11264
    v_mfma_f32_16x16x32_bf16 v[104:107], a[108:111], v[232:235], v[104:107]
    ds_read_b128 v[248:251], v2 offset:18432
    v_mfma_f32_16x16x32_bf16 v[132:135], a[108:111], v[236:239], v[132:135]
    ds_read_b128 v[252:255], v2 offset:25600
    v_mfma_f32_16x16x32_bf16 v[52:55], a[112:115], v[224:227], v[52:55]
    v_mfma_f32_16x16x32_bf16 v[80:83], a[112:115], v[228:231], v[80:83]
    v_mfma_f32_16x16x32_bf16 v[108:111], a[112:115], v[232:235], v[108:111]
    v_mfma_f32_16x16x32_bf16 v[136:139], a[112:115], v[236:239], v[136:139]
    v_mfma_f32_16x16x32_bf16 v[56:59], a[116:119], v[224:227], v[56:59]
    v_mfma_f32_16x16x32_bf16 v[84:87], a[116:119], v[228:231], v[84:87]
    v_mfma_f32_16x16x32_bf16 v[112:115], a[116:119], v[232:235], v[112:115]
    v_mfma_f32_16x16x32_bf16 v[140:143], a[116:119], v[236:239], v[140:143]
    s_waitcnt lgkmcnt(0)
    v_mfma_f32_16x16x32_bf16 v[48:51], a[120:123], v[240:243], v[48:51]
    ds_read_b128 v[224:227], v2 offset:5120
    v_mfma_f32_16x16x32_bf16 v[76:79], a[120:123], v[244:247], v[76:79]
    ds_read_b128 v[228:231], v2 offset:12288
    v_mfma_f32_16x16x32_bf16 v[104:107], a[120:123], v[248:251], v[104:107]
    ds_read_b128 v[232:235], v2 offset:19456
    v_mfma_f32_16x16x32_bf16 v[132:135], a[120:123], v[252:255], v[132:135]
    ds_read_b128 v[236:239], v2 offset:26624
    v_mfma_f32_16x16x32_bf16 v[52:55], a[124:127], v[240:243], v[52:55]
    v_mfma_f32_16x16x32_bf16 v[80:83], a[124:127], v[244:247], v[80:83]
    v_mfma_f32_16x16x32_bf16 v[108:111], a[124:127], v[248:251], v[108:111]
    v_mfma_f32_16x16x32_bf16 v[136:139], a[124:127], v[252:255], v[136:139]
    v_mfma_f32_16x16x32_bf16 v[56:59], a[128:131], v[240:243], v[56:59]
    v_mfma_f32_16x16x32_bf16 v[84:87], a[128:131], v[244:247], v[84:87]
    v_mfma_f32_16x16x32_bf16 v[112:115], a[128:131], v[248:251], v[112:115]
    v_mfma_f32_16x16x32_bf16 v[140:143], a[128:131], v[252:255], v[140:143]
    s_waitcnt lgkmcnt(0)
    v_mfma_f32_16x16x32_bf16 v[48:51], a[132:135], v[224:227], v[48:51]
    ds_read_b128 v[240:243], v2 offset:6144
    v_mfma_f32_16x16x32_bf16 v[76:79], a[132:135], v[228:231], v[76:79]
    ds_read_b128 v[244:247], v2 offset:13312
    v_mfma_f32_16x16x32_bf16 v[104:107], a[132:135], v[232:235], v[104:107]
    ds_read_b128 v[248:251], v2 offset:20480
    v_mfma_f32_16x16x32_bf16 v[132:135], a[132:135], v[236:239], v[132:135]
    ds_read_b128 v[252:255], v2 offset:27648
    v_mfma_f32_16x16x32_bf16 v[52:55], a[136:139], v[224:227], v[52:55]
    v_mfma_f32_16x16x32_bf16 v[80:83], a[136:139], v[228:231], v[80:83]
    v_mfma_f32_16x16x32_bf16 v[108:111], a[136:139], v[232:235], v[108:111]
    v_mfma_f32_16x16x32_bf16 v[136:139], a[136:139], v[236:239], v[136:139]
    v_mfma_f32_16x16x32_bf16 v[56:59], a[140:143], v[224:227], v[56:59]
    v_mfma_f32_16x16x32_bf16 v[84:87], a[140:143], v[228:231], v[84:87]
    v_mfma_f32_16x16x32_bf16 v[112:115], a[140:143], v[232:235], v[112:115]
    v_mfma_f32_16x16x32_bf16 v[140:143], a[140:143], v[236:239], v[140:143]
    s_waitcnt lgkmcnt(0)
    v_mfma_f32_16x16x32_bf16 v[48:51], a[144:147], v[240:243], v[48:51]
    ds_read_b128 v[224:227], v3 offset:0
    v_mfma_f32_16x16x32_bf16 v[76:79], a[144:147], v[244:247], v[76:79]
    ds_read_b128 v[228:231], v3 offset:7168
    v_mfma_f32_16x16x32_bf16 v[104:107], a[144:147], v[248:251], v[104:107]
    ds_read_b128 v[232:235], v3 offset:14336
    v_mfma_f32_16x16x32_bf16 v[132:135], a[144:147], v[252:255], v[132:135]
    ds_read_b128 v[236:239], v3 offset:21504
    v_mfma_f32_16x16x32_bf16 v[52:55], a[148:151], v[240:243], v[52:55]
    v_mfma_f32_16x16x32_bf16 v[80:83], a[148:151], v[244:247], v[80:83]
    v_mfma_f32_16x16x32_bf16 v[108:111], a[148:151], v[248:251], v[108:111]
    v_mfma_f32_16x16x32_bf16 v[136:139], a[148:151], v[252:255], v[136:139]
    v_mfma_f32_16x16x32_bf16 v[56:59], a[152:155], v[240:243], v[56:59]
    v_mfma_f32_16x16x32_bf16 v[84:87], a[152:155], v[244:247], v[84:87]
    v_mfma_f32_16x16x32_bf16 v[112:115], a[152:155], v[248:251], v[112:115]
    v_mfma_f32_16x16x32_bf16 v[140:143], a[152:155], v[252:255], v[140:143]
    s_waitcnt lgkmcnt(0)
    v_mfma_f32_16x16x32_bf16 v[60:63], a[156:159], v[224:227], v[60:63]
    ds_read_b128 v[240:243], v4 offset:0
    v_mfma_f32_16x16x32_bf16 v[88:91], a[156:159], v[228:231], v[88:91]
    ds_read_b128 v[244:247], v4 offset:7168
    v_mfma_f32_16x16x32_bf16 v[116:119], a[156:159], v[232:235], v[116:119]
    ds_read_b128 v[248:251], v4 offset:14336
    v_mfma_f32_16x16x32_bf16 v[144:147], a[156:159], v[236:239], v[144:147]
    ds_read_b128 v[252:255], v4 offset:21504
    v_mfma_f32_16x16x32_bf16 v[64:67], a[160:163], v[224:227], v[64:67]
    v_cvt_pk_bf16_f32 v48, v48, v49
    v_mfma_f32_16x16x32_bf16 v[92:95], a[160:163], v[228:231], v[92:95]
    v_cvt_pk_bf16_f32 v49, v50, v51
    v_mfma_f32_16x16x32_bf16 v[120:123], a[160:163], v[232:235], v[120:123]
    v_cvt_pk_bf16_f32 v50, v76, v77
    v_mfma_f32_16x16x32_bf16 v[148:151], a[160:163], v[236:239], v[148:151]
    v_cvt_pk_bf16_f32 v51, v78, v79
    s_waitcnt lgkmcnt(0)
    v_mfma_f32_16x16x32_bf16 v[60:63], a[164:167], v[240:243], v[60:63]
    ds_read_b128 v[224:227], v5 offset:0
    buffer_store_dwordx4 v[48:51], v9, s[8:11], s38 offen offset:0 sc1
    v_mfma_f32_16x16x32_bf16 v[88:91], a[164:167], v[244:247], v[88:91]
    ds_read_b128 v[228:231], v5 offset:7168
    s_mov_b64 exec, s[44:45]
    ds_write_b128 v220, v[48:51] offset:0
    s_mov_b64 exec, -1
    v_mfma_f32_16x16x32_bf16 v[116:119], a[164:167], v[248:251], v[116:119]
    ds_read_b128 v[232:235], v5 offset:14336
    v_cvt_pk_bf16_f32 v104, v104, v105
    v_mfma_f32_16x16x32_bf16 v[144:147], a[164:167], v[252:255], v[144:147]
    ds_read_b128 v[236:239], v5 offset:21504
    v_cvt_pk_bf16_f32 v105, v106, v107
    v_mfma_f32_16x16x32_bf16 v[64:67], a[168:171], v[240:243], v[64:67]
    v_cvt_pk_bf16_f32 v106, v132, v133
    v_mfma_f32_16x16x32_bf16 v[92:95], a[168:171], v[244:247], v[92:95]
    v_cvt_pk_bf16_f32 v107, v134, v135
    v_mfma_f32_16x16x32_bf16 v[120:123], a[168:171], v[248:251], v[120:123]
    buffer_store_dwordx4 v[104:107], v218, s[8:11], s39 offen offset:0 sc1
    v_mfma_f32_16x16x32_bf16 v[148:151], a[168:171], v[252:255], v[148:151]
    s_mov_b64 exec, s[46:47]
    ds_write_b128 v220, v[104:107] offset:0
    s_mov_b64 exec, -1
    s_waitcnt lgkmcnt(1)
    v_mfma_f32_16x16x32_bf16 v[60:63], a[172:175], v[224:227], v[60:63]
    ds_read_b128 v[240:243], v2 offset:4096
    v_cvt_pk_bf16_f32 v52, v52, v53
    v_mfma_f32_16x16x32_bf16 v[88:91], a[172:175], v[228:231], v[88:91]
    ds_read_b128 v[244:247], v2 offset:11264
    v_cvt_pk_bf16_f32 v53, v54, v55
    v_mfma_f32_16x16x32_bf16 v[116:119], a[172:175], v[232:235], v[116:119]
    ds_read_b128 v[248:251], v2 offset:18432
    v_cvt_pk_bf16_f32 v54, v80, v81
    v_mfma_f32_16x16x32_bf16 v[144:147], a[172:175], v[236:239], v[144:147]
    ds_read_b128 v[252:255], v2 offset:25600
    v_cvt_pk_bf16_f32 v55, v82, v83
    v_mfma_f32_16x16x32_bf16 v[64:67], a[176:179], v[224:227], v[64:67]
    buffer_store_dwordx4 v[52:55], v9, s[8:11], s38 offen offset:256 sc1
    v_mfma_f32_16x16x32_bf16 v[92:95], a[176:179], v[228:231], v[92:95]
    s_mov_b64 exec, s[44:45]
    ds_write_b128 v220, v[52:55] offset:256
    s_mov_b64 exec, -1
    v_mfma_f32_16x16x32_bf16 v[120:123], a[176:179], v[232:235], v[120:123]
    v_cvt_pk_bf16_f32 v108, v108, v109
    v_mfma_f32_16x16x32_bf16 v[148:151], a[176:179], v[236:239], v[148:151]
    v_cvt_pk_bf16_f32 v109, v110, v111
    s_waitcnt lgkmcnt(1)
    v_mfma_f32_16x16x32_bf16 v[60:63], a[180:183], v[240:243], v[60:63]
    ds_read_b128 v[224:227], v2 offset:5120
    v_cvt_pk_bf16_f32 v110, v136, v137
    v_mfma_f32_16x16x32_bf16 v[88:91], a[180:183], v[244:247], v[88:91]
    ds_read_b128 v[228:231], v2 offset:12288
    v_cvt_pk_bf16_f32 v111, v138, v139
    v_mfma_f32_16x16x32_bf16 v[116:119], a[180:183], v[248:251], v[116:119]
    ds_read_b128 v[232:235], v2 offset:19456
    buffer_store_dwordx4 v[108:111], v218, s[8:11], s39 offen offset:256 sc1
    v_mfma_f32_16x16x32_bf16 v[144:147], a[180:183], v[252:255], v[144:147]
    ds_read_b128 v[236:239], v2 offset:26624
    s_mov_b64 exec, s[46:47]
    ds_write_b128 v220, v[108:111] offset:256
    s_mov_b64 exec, -1
    v_mfma_f32_16x16x32_bf16 v[64:67], a[184:187], v[240:243], v[64:67]
    v_cvt_pk_bf16_f32 v56, v56, v57
    v_mfma_f32_16x16x32_bf16 v[92:95], a[184:187], v[244:247], v[92:95]
    v_cvt_pk_bf16_f32 v57, v58, v59
    v_mfma_f32_16x16x32_bf16 v[120:123], a[184:187], v[248:251], v[120:123]
    v_cvt_pk_bf16_f32 v58, v84, v85
    v_mfma_f32_16x16x32_bf16 v[148:151], a[184:187], v[252:255], v[148:151]
    v_cvt_pk_bf16_f32 v59, v86, v87
    s_waitcnt lgkmcnt(1)
    v_mfma_f32_16x16x32_bf16 v[60:63], a[188:191], v[224:227], v[60:63]
    ds_read_b128 v[240:243], v2 offset:6144
    buffer_store_dwordx4 v[56:59], v9, s[8:11], s38 offen offset:512 sc1
    v_mfma_f32_16x16x32_bf16 v[88:91], a[188:191], v[228:231], v[88:91]
    ds_read_b128 v[244:247], v2 offset:13312
    s_mov_b64 exec, s[44:45]
    ds_write_b128 v220, v[56:59] offset:512
    s_mov_b64 exec, -1
    v_mfma_f32_16x16x32_bf16 v[116:119], a[188:191], v[232:235], v[116:119]
    ds_read_b128 v[248:251], v2 offset:20480
    v_cvt_pk_bf16_f32 v112, v112, v113
    v_mfma_f32_16x16x32_bf16 v[144:147], a[188:191], v[236:239], v[144:147]
    ds_read_b128 v[252:255], v2 offset:27648
    v_cvt_pk_bf16_f32 v113, v114, v115
    v_mfma_f32_16x16x32_bf16 v[64:67], a[192:195], v[224:227], v[64:67]
    v_cvt_pk_bf16_f32 v114, v140, v141
    v_mfma_f32_16x16x32_bf16 v[92:95], a[192:195], v[228:231], v[92:95]
    v_cvt_pk_bf16_f32 v115, v142, v143
    v_mfma_f32_16x16x32_bf16 v[120:123], a[192:195], v[232:235], v[120:123]
    buffer_store_dwordx4 v[112:115], v218, s[8:11], s39 offen offset:512 sc1
    v_mfma_f32_16x16x32_bf16 v[148:151], a[192:195], v[236:239], v[148:151]
    s_mov_b64 exec, s[46:47]
    ds_write_b128 v220, v[112:115] offset:512
    s_mov_b64 exec, -1
    s_waitcnt lgkmcnt(1)
    v_mfma_f32_16x16x32_bf16 v[60:63], a[196:199], v[240:243], v[60:63]
    ds_read_b128 v[224:227], v3 offset:0
    v_mfma_f32_16x16x32_bf16 v[88:91], a[196:199], v[244:247], v[88:91]
    ds_read_b128 v[228:231], v3 offset:7168
    v_mfma_f32_16x16x32_bf16 v[116:119], a[196:199], v[248:251], v[116:119]
    ds_read_b128 v[232:235], v3 offset:14336
    v_mfma_f32_16x16x32_bf16 v[144:147], a[196:199], v[252:255], v[144:147]
    ds_read_b128 v[236:239], v3 offset:21504
    v_mfma_f32_16x16x32_bf16 v[64:67], a[200:203], v[240:243], v[64:67]
    v_mfma_f32_16x16x32_bf16 v[92:95], a[200:203], v[244:247], v[92:95]
    v_mfma_f32_16x16x32_bf16 v[120:123], a[200:203], v[248:251], v[120:123]
    v_mfma_f32_16x16x32_bf16 v[148:151], a[200:203], v[252:255], v[148:151]
    s_waitcnt lgkmcnt(0)
    v_mfma_f32_16x16x32_bf16 v[68:71], a[204:207], v[224:227], v[68:71]
    ds_read_b128 v[240:243], v4 offset:0
    v_mfma_f32_16x16x32_bf16 v[96:99], a[204:207], v[228:231], v[96:99]
    ds_read_b128 v[244:247], v4 offset:7168
    v_mfma_f32_16x16x32_bf16 v[124:127], a[204:207], v[232:235], v[124:127]
    ds_read_b128 v[248:251], v4 offset:14336
    v_mfma_f32_16x16x32_bf16 v[152:155], a[204:207], v[236:239], v[152:155]
    ds_read_b128 v[252:255], v4 offset:21504
    v_mfma_f32_16x16x32_bf16 v[72:75], a[208:211], v[224:227], v[72:75]
    v_cvt_pk_bf16_f32 v60, v60, v61
    v_mfma_f32_16x16x32_bf16 v[100:103], a[208:211], v[228:231], v[100:103]
    v_cvt_pk_bf16_f32 v61, v62, v63
    v_mfma_f32_16x16x32_bf16 v[128:131], a[208:211], v[232:235], v[128:131]
    v_cvt_pk_bf16_f32 v62, v88, v89
    v_mfma_f32_16x16x32_bf16 v[156:159], a[208:211], v[236:239], v[156:159]
    v_cvt_pk_bf16_f32 v63, v90, v91
    s_waitcnt lgkmcnt(0)
    v_mfma_f32_16x16x32_bf16 v[68:71], a[212:215], v[240:243], v[68:71]
    ds_read_b128 v[224:227], v5 offset:0
    buffer_store_dwordx4 v[60:63], v9, s[8:11], s38 offen offset:768 sc1
    v_mfma_f32_16x16x32_bf16 v[96:99], a[212:215], v[244:247], v[96:99]
    ds_read_b128 v[228:231], v5 offset:7168
    s_mov_b64 exec, s[44:45]
    ds_write_b128 v220, v[60:63] offset:768
    s_mov_b64 exec, -1
    v_mfma_f32_16x16x32_bf16 v[124:127], a[212:215], v[248:251], v[124:127]
    ds_read_b128 v[232:235], v5 offset:14336
    v_cvt_pk_bf16_f32 v116, v116, v117
    v_mfma_f32_16x16x32_bf16 v[152:155], a[212:215], v[252:255], v[152:155]
    ds_read_b128 v[236:239], v5 offset:21504
    v_cvt_pk_bf16_f32 v117, v118, v119
    v_mfma_f32_16x16x32_bf16 v[72:75], a[216:219], v[240:243], v[72:75]
    v_cvt_pk_bf16_f32 v118, v144, v145
    v_mfma_f32_16x16x32_bf16 v[100:103], a[216:219], v[244:247], v[100:103]
    v_cvt_pk_bf16_f32 v119, v146, v147
    v_mfma_f32_16x16x32_bf16 v[128:131], a[216:219], v[248:251], v[128:131]
    buffer_store_dwordx4 v[116:119], v218, s[8:11], s39 offen offset:768 sc1
    v_mfma_f32_16x16x32_bf16 v[156:159], a[216:219], v[252:255], v[156:159]
    s_mov_b64 exec, s[46:47]
    ds_write_b128 v220, v[116:119] offset:768
    s_mov_b64 exec, -1
    s_waitcnt lgkmcnt(1)
    v_mfma_f32_16x16x32_bf16 v[68:71], a[220:223], v[224:227], v[68:71]
    ds_read_b128 v[240:243], v2 offset:4096
    v_cvt_pk_bf16_f32 v64, v64, v65
    v_mfma_f32_16x16x32_bf16 v[96:99], a[220:223], v[228:231], v[96:99]
    ds_read_b128 v[244:247], v2 offset:11264
    v_cvt_pk_bf16_f32 v65, v66, v67
    v_mfma_f32_16x16x32_bf16 v[124:127], a[220:223], v[232:235], v[124:127]
    ds_read_b128 v[248:251], v2 offset:18432
    v_cvt_pk_bf16_f32 v66, v92, v93
    v_mfma_f32_16x16x32_bf16 v[152:155], a[220:223], v[236:239], v[152:155]
    ds_read_b128 v[252:255], v2 offset:25600
    v_cvt_pk_bf16_f32 v67, v94, v95
    v_mfma_f32_16x16x32_bf16 v[72:75], a[224:227], v[224:227], v[72:75]
    buffer_store_dwordx4 v[64:67], v9, s[8:11], s38 offen offset:1024 sc1
    v_mfma_f32_16x16x32_bf16 v[100:103], a[224:227], v[228:231], v[100:103]
    s_mov_b64 exec, s[44:45]
    ds_write_b128 v220, v[64:67] offset:1024
    s_mov_b64 exec, -1
    v_mfma_f32_16x16x32_bf16 v[128:131], a[224:227], v[232:235], v[128:131]
    v_cvt_pk_bf16_f32 v120, v120, v121
    v_mfma_f32_16x16x32_bf16 v[156:159], a[224:227], v[236:239], v[156:159]
    v_cvt_pk_bf16_f32 v121, v122, v123
    s_waitcnt lgkmcnt(1)
    v_mfma_f32_16x16x32_bf16 v[68:71], a[228:231], v[240:243], v[68:71]
    ds_read_b128 v[224:227], v2 offset:5120
    v_cvt_pk_bf16_f32 v122, v148, v149
    v_mfma_f32_16x16x32_bf16 v[96:99], a[228:231], v[244:247], v[96:99]
    ds_read_b128 v[228:231], v2 offset:12288
    v_cvt_pk_bf16_f32 v123, v150, v151
    v_mfma_f32_16x16x32_bf16 v[124:127], a[228:231], v[248:251], v[124:127]
    ds_read_b128 v[232:235], v2 offset:19456
    buffer_store_dwordx4 v[120:123], v218, s[8:11], s39 offen offset:1024 sc1
    v_mfma_f32_16x16x32_bf16 v[152:155], a[228:231], v[252:255], v[152:155]
    ds_read_b128 v[236:239], v2 offset:26624
    s_mov_b64 exec, s[46:47]
    ds_write_b128 v220, v[120:123] offset:1024
    s_mov_b64 exec, -1
    v_mfma_f32_16x16x32_bf16 v[72:75], a[232:235], v[240:243], v[72:75]
    v_mfma_f32_16x16x32_bf16 v[100:103], a[232:235], v[244:247], v[100:103]
    v_mfma_f32_16x16x32_bf16 v[128:131], a[232:235], v[248:251], v[128:131]
    v_mfma_f32_16x16x32_bf16 v[156:159], a[232:235], v[252:255], v[156:159]
    s_waitcnt lgkmcnt(1)
    v_mfma_f32_16x16x32_bf16 v[68:71], a[236:239], v[224:227], v[68:71]
    ds_read_b128 v[240:243], v2 offset:6144
    v_mfma_f32_16x16x32_bf16 v[96:99], a[236:239], v[228:231], v[96:99]
    ds_read_b128 v[244:247], v2 offset:13312
    v_mfma_f32_16x16x32_bf16 v[124:127], a[236:239], v[232:235], v[124:127]
    ds_read_b128 v[248:251], v2 offset:20480
    v_mfma_f32_16x16x32_bf16 v[152:155], a[236:239], v[236:239], v[152:155]
    ds_read_b128 v[252:255], v2 offset:27648
    v_mfma_f32_16x16x32_bf16 v[72:75], a[240:243], v[224:227], v[72:75]
    v_mfma_f32_16x16x32_bf16 v[100:103], a[240:243], v[228:231], v[100:103]
    v_mfma_f32_16x16x32_bf16 v[128:131], a[240:243], v[232:235], v[128:131]
    v_mfma_f32_16x16x32_bf16 v[156:159], a[240:243], v[236:239], v[156:159]
    s_waitcnt lgkmcnt(0)
    v_mfma_f32_16x16x32_bf16 v[68:71], a[244:247], v[240:243], v[68:71]
    v_mfma_f32_16x16x32_bf16 v[96:99], a[244:247], v[244:247], v[96:99]
    v_mfma_f32_16x16x32_bf16 v[124:127], a[244:247], v[248:251], v[124:127]
    v_mfma_f32_16x16x32_bf16 v[152:155], a[244:247], v[252:255], v[152:155]
    v_mfma_f32_16x16x32_bf16 v[72:75], a[248:251], v[240:243], v[72:75]
    s_nop 3
    v_cvt_pk_bf16_f32 v68, v68, v69
    v_cvt_pk_bf16_f32 v69, v70, v71
    v_mfma_f32_16x16x32_bf16 v[100:103], a[248:251], v[244:247], v[100:103]
    v_cvt_pk_bf16_f32 v70, v96, v97
    v_cvt_pk_bf16_f32 v71, v98, v99
    v_mfma_f32_16x16x32_bf16 v[128:131], a[248:251], v[248:251], v[128:131]
    buffer_store_dwordx4 v[68:71], v9, s[8:11], s38 offen offset:1280 sc1
    s_mov_b64 exec, s[44:45]
    ds_write_b128 v220, v[68:71] offset:1280
    s_mov_b64 exec, -1
    v_mfma_f32_16x16x32_bf16 v[156:159], a[248:251], v[252:255], v[156:159]
    v_cvt_pk_bf16_f32 v124, v124, v125
    v_cvt_pk_bf16_f32 v125, v126, v127
    v_cvt_pk_bf16_f32 v126, v152, v153
    v_cvt_pk_bf16_f32 v127, v154, v155
    buffer_store_dwordx4 v[124:127], v218, s[8:11], s39 offen offset:1280 sc1
    s_mov_b64 exec, s[46:47]
    ds_write_b128 v220, v[124:127] offset:1280
    s_mov_b64 exec, -1
    v_cvt_pk_bf16_f32 v72, v72, v73
    v_cvt_pk_bf16_f32 v73, v74, v75
    v_cvt_pk_bf16_f32 v74, v100, v101
    v_cvt_pk_bf16_f32 v75, v102, v103
    buffer_store_dwordx4 v[72:75], v9, s[8:11], s38 offen offset:1536 sc1
    s_mov_b64 exec, s[44:45]
    ds_write_b128 v220, v[72:75] offset:1536
    s_mov_b64 exec, -1
    v_cvt_pk_bf16_f32 v128, v128, v129
    v_cvt_pk_bf16_f32 v129, v130, v131
    v_cvt_pk_bf16_f32 v130, v156, v157
    v_cvt_pk_bf16_f32 v131, v158, v159
    buffer_store_dwordx4 v[128:131], v218, s[8:11], s39 offen offset:1536 sc1
    s_mov_b64 exec, s[46:47]
    ds_write_b128 v220, v[128:131] offset:1536
    s_mov_b64 exec, -1
    s_mov_b32 s33, 32768
    s_lshl_b32 s26, s22, 11
    s_add_u32 s26, s26, 146944
    v_lshrrev_b32 v220, 8, v1
    v_lshl_add_u32 v220, v220, 8, v1
    v_add_u32 v220, s26, v220
    s_waitcnt lgkmcnt(0)
    s_barrier
    ds_read_b128 v[104:107], v220 offset:0
    ds_read_b128 v[108:111], v220 offset:256
    s_waitcnt vmcnt(0)
    s_mov_b64 exec, 1
    buffer_store_dword v43, v14, s[8:11], s33 offen offset:0 sc1
    s_mov_b64 exec, -1
    s_waitcnt lgkmcnt(1)
    v_dot2_f32_bf16 v16, v104, s40, v16
    v_dot2_f32_bf16 v17, v104, s41, v17
    v_dot2_f32_bf16 v18, v105, s40, v18
    v_dot2_f32_bf16 v19, v105, s41, v19
    v_dot2_f32_bf16 v24, v106, s40, v24
    v_dot2_f32_bf16 v25, v106, s41, v25
    v_dot2_f32_bf16 v26, v107, s40, v26
    v_dot2_f32_bf16 v27, v107, s41, v27
    s_waitcnt lgkmcnt(0)
    v_dot2_f32_bf16 v20, v108, s40, v20
    v_dot2_f32_bf16 v21, v108, s41, v21
    v_dot2_f32_bf16 v22, v109, s40, v22
    v_dot2_f32_bf16 v23, v109, s41, v23
    v_dot2_f32_bf16 v28, v110, s40, v28
    v_dot2_f32_bf16 v29, v110, s41, v29
    v_dot2_f32_bf16 v30, v111, s40, v30
    v_dot2_f32_bf16 v31, v111, s41, v31
    s_lshl_b32 s26, s22, 11
    s_add_u32 s26, s26, 155136
    v_add_u32 v222, s26, v1
    v_lshrrev_b32 v221, 2, v1
    v_and_b32 v221, 0xf0, v221
    v_and_b32 v223, 48, v1
    v_lshl_add_u32 v221, v223, 4, v221
    v_add_u32 v221, s26, v221
    s_mov_b32 s34, 0
    buffer_load_dword v42, v15, s[8:11], s33 offen sc1
L_pp_10:
    buffer_load_dword v47, v15, s[8:11], s33 offen sc1
    s_waitcnt vmcnt(1)
    v_and_b32 v46, -16, v42
    v_cmp_ne_u32 vcc, s42, v46
    s_cbranch_vccz L_pp_10_x
    buffer_load_dword v42, v15, s[8:11], s33 offen sc1
    s_waitcnt vmcnt(1)
    v_and_b32 v46, -16, v47
    v_cmp_ne_u32 vcc, s42, v46
    s_cbranch_vccz L_pp_10_x
    s_add_u32 s34, s34, 1
    s_cmp_lt_u32 s34, 1048576
    s_cbranch_scc1 L_pp_10
L_pp_10_x:
    s_mov_b32 s33, 34078720
    buffer_load_dwordx4 v[48:51], v10, s[8:11], s33 offen offset:0 sc1
    buffer_load_dwordx4 v[52:55], v10, s[8:11], s33 offen offset:256 sc1
    s_mov_b32 s33, 34085888
    buffer_load_dwordx4 v[56:59], v10, s[8:11], s33 offen offset:0 sc1
    buffer_load_dwordx4 v[60:63], v10, s[8:11], s33 offen offset:256 sc1
    s_mov_b32 s33, 34093056
    buffer_load_dwordx4 v[64:67], v10, s[8:11], s33 offen offset:0 sc1
    buffer_load_dwordx4 v[68:71], v10, s[8:11], s33 offen offset:256 sc1
    s_mov_b32 s33, 34100224
    buffer_load_dwordx4 v[72:75], v10, s[8:11], s33 offen offset:0 sc1
    buffer_load_dwordx4 v[76:79], v10, s[8:11], s33 offen offset:256 sc1
    s_mov_b32 s33, 34107392
    buffer_load_dwordx4 v[80:83], v10, s[8:11], s33 offen offset:0 sc1
    buffer_load_dwordx4 v[84:87], v10, s[8:11], s33 offen offset:256 sc1
    s_mov_b32 s33, 34114560
    buffer_load_dwordx4 v[88:91], v10, s[8:11], s33 offen offset:0 sc1
    buffer_load_dwordx4 v[92:95], v10, s[8:11], s33 offen offset:256 sc1
    s_mov_b32 s33, 34121728
    buffer_load_dwordx4 v[96:99], v10, s[8:11], s33 offen offset:0 sc1
    buffer_load_dwordx4 v[100:103], v10, s[8:11], s33 offen offset:256 sc1
    s_waitcnt vmcnt(13)
    v_dot2_f32_bf16 v16, v48, s40, v16
    v_dot2_f32_bf16 v17, v48, s41, v17
    v_dot2_f32_bf16 v18, v49, s40, v18
    v_dot2_f32_bf16 v19, v49, s41, v19
    v_dot2_f32_bf16 v24, v50, s40, v24
    v_dot2_f32_bf16 v25, v50, s41, v25
    v_dot2_f32_bf16 v26, v51, s40, v26
    v_dot2_f32_bf16 v27, v51, s41, v27
    s_waitcnt vmcnt(12)
    v_dot2_f32_bf16 v20, v52, s40, v20
    v_dot2_f32_bf16 v21, v52, s41, v21
    v_dot2_f32_bf16 v22, v53, s40, v22
    v_dot2_f32_bf16 v23, v53, s41, v23
    v_dot2_f32_bf16 v28, v54, s40, v28
    v_dot2_f32_bf16 v29, v54, s41, v29
    v_dot2_f32_bf16 v30, v55, s40, v30
    v_dot2_f32_bf16 v31, v55, s41, v31
    s_waitcnt vmcnt(11)
    v_dot2_f32_bf16 v16, v56, s40, v16
    v_dot2_f32_bf16 v17, v56, s41, v17
    v_dot2_f32_bf16 v18, v57, s40, v18
    v_dot2_f32_bf16 v19, v57, s41, v19
    v_dot2_f32_bf16 v24, v58, s40, v24
    v_dot2_f32_bf16 v25, v58, s41, v25
    v_dot2_f32_bf16 v26, v59, s40, v26
    v_dot2_f32_bf16 v27, v59, s41, v27
    s_waitcnt vmcnt(10)
    v_dot2_f32_bf16 v20, v60, s40, v20
    v_dot2_f32_bf16 v21, v60, s41, v21
    v_dot2_f32_bf16 v22, v61, s40, v22
    v_dot2_f32_bf16 v23, v61, s41, v23
    v_dot2_f32_bf16 v28, v62, s40, v28
    v_dot2_f32_bf16 v29, v62, s41, v29
    v_dot2_f32_bf16 v30, v63, s40, v30
    v_dot2_f32_bf16 v31, v63, s41, v31
    s_waitcnt vmcnt(9)
    v_dot2_f32_bf16 v16, v64, s40, v16
    v_dot2_f32_bf16 v17, v64, s41, v17
    v_dot2_f32_bf16 v18, v65, s40, v18
    v_dot2_f32_bf16 v19, v65, s41, v19
    v_dot2_f32_bf16 v24, v66, s40, v24
    v_dot2_f32_bf16 v25, v66, s41, v25
    v_dot2_f32_bf16 v26, v67, s40, v26
    v_dot2_f32_bf16 v27, v67, s41, v27
    s_waitcnt vmcnt(8)
    v_dot2_f32_bf16 v20, v68, s40, v20
    v_dot2_f32_bf16 v21, v68, s41, v21
    v_dot2_f32_bf16 v22, v69, s40, v22
    v_dot2_f32_bf16 v23, v69, s41, v23
    v_dot2_f32_bf16 v28, v70, s40, v28
    v_dot2_f32_bf16 v29, v70, s41, v29
    v_dot2_f32_bf16 v30, v71, s40, v30
    v_dot2_f32_bf16 v31, v71, s41, v31
    s_waitcnt vmcnt(7)
    v_dot2_f32_bf16 v16, v72, s40, v16
    v_dot2_f32_bf16 v17, v72, s41, v17
    v_dot2_f32_bf16 v18, v73, s40, v18
    v_dot2_f32_bf16 v19, v73, s41, v19
    v_dot2_f32_bf16 v24, v74, s40, v24
    v_dot2_f32_bf16 v25, v74, s41, v25
    v_dot2_f32_bf16 v26, v75, s40, v26
    v_dot2_f32_bf16 v27, v75, s41, v27
    s_waitcnt vmcnt(6)
    v_dot2_f32_bf16 v20, v76, s40, v20
    v_dot2_f32_bf16 v21, v76, s41, v21
    v_dot2_f32_bf16 v22, v77, s40, v22
    v_dot2_f32_bf16 v23, v77, s41, v23
    v_dot2_f32_bf16 v28, v78, s40, v28
    v_dot2_f32_bf16 v29, v78, s41, v29
    v_dot2_f32_bf16 v30, v79, s40, v30
    v_dot2_f32_bf16 v31, v79, s41, v31
    s_waitcnt vmcnt(5)
    v_dot2_f32_bf16 v16, v80, s40, v16
    v_dot2_f32_bf16 v17, v80, s41, v17
    v_dot2_f32_bf16 v18, v81, s40, v18
    v_dot2_f32_bf16 v19, v81, s41, v19
    v_dot2_f32_bf16 v24, v82, s40, v24
    v_dot2_f32_bf16 v25, v82, s41, v25
    v_dot2_f32_bf16 v26, v83, s40, v26
    v_dot2_f32_bf16 v27, v83, s41, v27
    s_waitcnt vmcnt(4)
    v_dot2_f32_bf16 v20, v84, s40, v20
    v_dot2_f32_bf16 v21, v84, s41, v21
    v_dot2_f32_bf16 v22, v85, s40, v22
    v_dot2_f32_bf16 v23, v85, s41, v23
    v_dot2_f32_bf16 v28, v86, s40, v28
    v_dot2_f32_bf16 v29, v86, s41, v29
    v_dot2_f32_bf16 v30, v87, s40, v30
    v_dot2_f32_bf16 v31, v87, s41, v31
    s_waitcnt vmcnt(3)
    v_dot2_f32_bf16 v16, v88, s40, v16
    v_dot2_f32_bf16 v17, v88, s41, v17
    v_dot2_f32_bf16 v18, v89, s40, v18
    v_dot2_f32_bf16 v19, v89, s41, v19
    v_dot2_f32_bf16 v24, v90, s40, v24
    v_dot2_f32_bf16 v25, v90, s41, v25
    v_dot2_f32_bf16 v26, v91, s40, v26
    v_dot2_f32_bf16 v27, v91, s41, v27
    s_waitcnt vmcnt(2)
    v_dot2_f32_bf16 v20, v92, s40, v20
    v_dot2_f32_bf16 v21, v92, s41, v21
    v_dot2_f32_bf16 v22, v93, s40, v22
    v_dot2_f32_bf16 v23, v93, s41, v23
    v_dot2_f32_bf16 v28, v94, s40, v28
    v_dot2_f32_bf16 v29, v94, s41, v29
    v_dot2_f32_bf16 v30, v95, s40, v30
    v_dot2_f32_bf16 v31, v95, s41, v31
    s_waitcnt vmcnt(1)
    v_dot2_f32_bf16 v16, v96, s40, v16
    v_dot2_f32_bf16 v17, v96, s41, v17
    v_dot2_f32_bf16 v18, v97, s40, v18
    v_dot2_f32_bf16 v19, v97, s41, v19
    v_dot2_f32_bf16 v24, v98, s40, v24
    v_dot2_f32_bf16 v25, v98, s41, v25
    v_dot2_f32_bf16 v26, v99, s40, v26
    v_dot2_f32_bf16 v27, v99, s41, v27
    s_waitcnt vmcnt(0)
    v_dot2_f32_bf16 v20, v100, s40, v20
    v_dot2_f32_bf16 v21, v100, s41, v21
    v_dot2_f32_bf16 v22, v101, s40, v22
    v_dot2_f32_bf16 v23, v101, s41, v23
    v_dot2_f32_bf16 v28, v102, s40, v28
    v_dot2_f32_bf16 v29, v102, s41, v29
    v_dot2_f32_bf16 v30, v103, s40, v30
    v_dot2_f32_bf16 v31, v103, s41, v31
    v_cvt_pk_bf16_f32 v144, v16, v17
    v_cvt_pk_bf16_f32 v145, v18, v19
    v_cvt_pk_bf16_f32 v146, v20, v21
    v_cvt_pk_bf16_f32 v147, v22, v23
    ds_write_b128 v221, v[144:147] offset:0
    v_cvt_pk_bf16_f32 v148, v24, v25
    v_cvt_pk_bf16_f32 v149, v26, v27
    v_cvt_pk_bf16_f32 v150, v28, v29
    v_cvt_pk_bf16_f32 v151, v30, v31
    ds_write_b128 v221, v[148:151] offset:1024
    ds_read_b128 v[144:147], v222 offset:0
    ds_read_b128 v[148:151], v222 offset:1024
    s_waitcnt lgkmcnt(1)
    buffer_store_dwordx4 v[144:147], v12, s[52:55], 0 offen offset:0
    s_waitcnt lgkmcnt(0)
    buffer_store_dwordx4 v[148:151], v12, s[52:55], 0 offen offset:896
    s_add_u32 s43, s43, 1
    v_mov_b32 v43, s43
    s_cmp_eq_u32 s2, 0
    s_cselect_b32 s26, 0, 2147483648
    s_mov_b64 exec, 1
    buffer_store_dword v43, off, s[8:11], s26
    s_mov_b64 exec, -1
    s_endpgm
.section .rodata,"a"
.p2align 6
.amdhsa_kernel interleave_layers__ssm_conv_h3__glu_gated_bilinear__prompt_kernel
  .amdhsa_next_free_vgpr 512
  .amdhsa_next_free_sgpr 102
  .amdhsa_accum_offset 256
  .amdhsa_group_segment_fixed_size 0
  .amdhsa_kernarg_size 104
  .amdhsa_user_sgpr_count 2
  .amdhsa_user_sgpr_kernarg_segment_ptr 1
  .amdhsa_system_sgpr_workgroup_id_x 1
  .amdhsa_float_denorm_mode_32 3
.end_amdhsa_kernel
```
